```python
import torch

def _softmax(x, axis=-1):
    return torch.softmax(x, dim=axis)
def _gelu(x):
    return torch.nn.functional.gelu(x, approximate="tanh")
def _silu(x):
    return torch.nn.functional.silu(x)
def _sigmoid(x):
    return torch.sigmoid(x)
def _layernorm(x, axis=-1, eps=1e-5):
    m = x.mean(dim=axis, keepdim=True)
    v = x.var(dim=axis, keepdim=True, unbiased=False)
    return (x - m) / torch.sqrt(v + eps)
def _scatter_add(tgt, idx, src, axis=0):
    return tgt.clone().index_add_(axis, idx, src)
def _segment_sum(src, seg, n):
    out = torch.zeros((n,) + src.shape[1:], dtype=src.dtype)
    return out.index_add_(0, seg, src)
def _pad(x, pw):
    flat = tuple(v for pair in reversed(pw) for v in pair)
    return torch.nn.functional.pad(x, flat)

kernel_name = 'concat_heads__sliding_local_dilated__linear_attn_block__prompt'

def setup_inputs():

    _w = (lambda a: (lambda t: t.to(torch.bfloat16) if t.is_floating_point() else t)(torch.as_tensor(a)))
    def _A_setup():
        B, S, D = 1, 2048, 576
        return {
            "x": _w((lambda *s: torch.randn(*s, dtype=torch.bfloat16) * 0.2)(B, S, D)),
            "wqkv": _w((lambda *s: torch.randn(*s, dtype=torch.bfloat16) * 0.2)(D, 3 * D)),
            "wo": _w((lambda *s: torch.randn(*s, dtype=torch.bfloat16) * 0.05)(D, D)),
        }
    _A_in = _A_setup()

    def _B_setup():
        B, S, D = 1, 2048, 576
        return {
            "x": _w((lambda *s: torch.randn(*s, dtype=torch.bfloat16) * 0.05)(B, S, D)),
            "wqkv": _w((lambda *s: torch.randn(*s, dtype=torch.bfloat16) * 0.8)(D, 3 * D)),
            "wo": _w((lambda *s: torch.randn(*s, dtype=torch.bfloat16) * 0.8)(D, D)),
        }
    _B_in = _B_setup()

    return {
        "A_x": _A_in["x"],
        "A_wqkv": _A_in["wqkv"],
        "A_wo": _A_in["wo"],
        "B_x": _B_in["x"],
        "B_wqkv": _B_in["wqkv"],
        "B_wo": _B_in["wo"],
    }

def reference(A_x, A_wqkv, A_wo, B_x, B_wqkv, B_wo):
    def _A_ref(x, wqkv, wo):
        B, S, D = x.shape
        H = 32; Dh = D // H
        W, dil = 8, 2
        qkv = (lambda x, *d: x.permute(*d))((x @ wqkv).reshape(B, S, 3, H, Dh), 2, 0, 3, 1, 4)
        q, k, v = qkv[0], qkv[1], qkv[2]
        scale = Dh ** -0.5
        pos = torch.arange(S)
        off = torch.arange(W) * dil
        idx = pos[:, None] - off[None, :]
        mask = idx >= 0
        idx_c = torch.where(mask, idx, 0).reshape(-1)
        kg = k[:, :, idx_c, :].reshape(B, H, S, W, Dh)
        vg = v[:, :, idx_c, :].reshape(B, H, S, W, Dh)
        logits = torch.einsum("bhsd,bhswd->bhsw", q, kg) * scale
        logits = torch.where(mask[None, None, :, :], logits, -1e9)
        attn = _softmax(logits, axis=-1)
        o = torch.einsum("bhsw,bhswd->bhsd", attn, vg)
        return (lambda x, *d: x.permute(*d))(o, 0, 2, 1, 3).reshape(B, S, D) @ wo

    def _B_ref(x, wqkv, wo):
        B, S, D = x.shape
        H = 32; Dh = D // H
        qkv = (lambda x, *d: x.permute(*d))((x @ wqkv).reshape(B, S, 3, H, Dh), 2, 0, 3, 1, 4)
        q, k, v = qkv[0], qkv[1], qkv[2]
        phi = lambda t: torch.where(t > 0, t + 1, torch.exp(t)) + 1e-6
        pq, pk = phi(q), phi(k)
        kv = torch.einsum("bhsd,bhse->bhde", pk, v)
        z = torch.einsum("bhsd->bhd", pk)
        num = torch.einsum("bhqd,bhde->bhqe", pq, kv)
        den = torch.einsum("bhqd,bhd->bhq", pq, z)[..., None] + 1e-6
        o = num / den
        return (lambda x, *d: x.permute(*d))(o, 0, 2, 1, 3).reshape(B, S, D) @ wo

    a = _A_ref(A_x, A_wqkv, A_wo)
    b = _B_ref(B_x, B_wqkv, B_wo)
    return torch.concatenate([a, b], axis=-1)
```

```asm
; @launch grid=(256,1,1) block=(512,1,1) lds=163840
.amdgcn_target "amdgcn-amd-amdhsa--gfx950"
.text
.globl concat_heads__sliding_local_dilated__linear_attn_block__prompt_kernel
.p2align 8
.type concat_heads__sliding_local_dilated__linear_attn_block__prompt_kernel,@function
concat_heads__sliding_local_dilated__linear_attn_block__prompt_kernel:
    s_load_dwordx16 s[64:79], s[0:1], 0

    v_readfirstlane_b32 s40, v0
    s_cmp_ge_u32 s2, 256
    s_cbranch_scc1 L_end
    v_and_b32 v0, 63, v0
    s_cmp_lt_u32 s40, 256
    s_cbranch_scc0 L_q
    s_getpc_b64 s[50:51]
L_pc:
    s_and_b32 s3, s2, 0xf8
    s_lshr_b32 s4, s40, 5
    s_add_u32 s3, s3, s4
    s_lshr_b32 s4, s3, 1
    s_add_u32 s3, s3, s4
    v_add_lshl_u32 v1, s3, v0, 7
    v_min_u32 v1, L_last - L_pc - 4, v1
    s_mov_b64 exec, 7
    global_load_dword v230, v1, s[50:51]
    s_mov_b64 exec, -1
    s_branch L_k
L_q:
    s_setprio 2
    v_lshrrev_b32 v2, 3, v0
    v_mul_u32_u24 v3, 2304, v2
    v_and_b32 v4, 7, v0
    v_lshrrev_b32 v5, 4, v0
    v_xor_b32 v4, v4, v5
    v_lshl_add_u32 v10, v4, 4, v3
    v_xor_b32 v11, 64, v10
    s_lshr_b32 s4, s2, 3
    s_bfe_u32 s36, s2, 0x10002
    s_xor_b32 s36, s36, 1
    s_and_b32 s5, s4, 7
    s_lshr_b32 s6, s4, 3
    s_and_b32 s3, s2, 1
    s_lshl3_add_u32 s37, s3, s5
    s_lshl1_add_u32 s39, s6, s5
    s_sub_u32 s3, s39, 9
    s_cselect_b32 s39, s39, s3
    s_bfe_u32 s41, s40, 0x20006
    s_lshr_b32 s3, s41, 1
    s_lshl1_add_u32 s3, s37, s3
    s_lshl_b32 s3, s3, 6
    s_and_b32 s4, s41, 1
    s_add_u32 s3, s3, s4
    s_mul_i32 s54, s3, 1152
    s_lshl_b32 s61, s41, 12
    s_mul_i32 s3, s36, 110592
    s_add_u32 s50, s61, s3
    s_mov_b32 s10, 2359296
    s_mov_b32 s11, 0x20000
    s_cmp_eq_u32 s36, 0
    s_waitcnt lgkmcnt(0)
    s_cselect_b32 s8, s64, s70
    s_cselect_b32 s9, s65, s71
    s_lshl_b32 s56, s39, 7
    s_add_u32 s56, s56, s54
    s_add_u32 m0, s50, 0
    s_nop 0
    buffer_load_dwordx4 v10, s[8:11], s56 offen lds
    s_add_u32 m0, s50, 1024
    s_add_u32 s42, s56, 18432
    buffer_load_dwordx4 v11, s[8:11], s42 offen lds
    s_add_u32 m0, s50, 2048
    s_add_u32 s42, s56, 36864
    buffer_load_dwordx4 v10, s[8:11], s42 offen lds
    s_add_u32 m0, s50, 3072
    s_add_u32 s42, s56, 55296
    buffer_load_dwordx4 v11, s[8:11], s42 offen lds
    s_load_dwordx2 s[80:81], s[0:1], 64
    s_bfe_u32 s4, s2, 0x10001
    s_lshl2_add_u32 s38, s4, s6
    s_lshr_b32 s40, s40, 6
    s_mov_b32 s63, s39
    s_lshl_b32 s62, s41, 11
    s_cmp_eq_u32 s5, 7
    s_cselect_b32 s5, 0, s5
    s_lshl_b32 s6, s5, 1
    s_mov_b32 s7, s2
    s_cmp_eq_u32 s36, 0
    s_cselect_b32 s12, s66, s72
    s_cselect_b32 s13, s67, s73
    s_mov_b32 s14, 1990656
    s_mov_b32 s15, 0x20000
    s_mov_b32 s35, 0x20000
    s_add_u32 s51, s62, s3
    s_mul_i32 s43, s38, 144
    s_add_u32 s43, s43, 1152
    s_lshl_b32 s42, s41, 7
    v_add_u32 v1, s42, v0
    v_mul_u32_u24 v2, 3641, v1
    v_lshrrev_b32 v2, 16, v2
    v_mul_u32_u24 v3, 18, v2
    v_sub_u32 v3, v1, v3
    v_and_b32 v4, 0x13, v2
    v_and_b32 v5, 4, v2
    v_lshl_or_b32 v4, v5, 1, v4
    v_bfe_u32 v5, v2, 3, 1
    v_lshl_or_b32 v4, v5, 2, v4
    v_mul_u32_u24 v4, 3456, v4
    v_lshl_add_u32 v4, v3, 4, v4
    v_mul_u32_u24 v5, 57, v3
    v_lshrrev_b32 v5, 9, v5
    v_mul_u32_u24 v5, 1008, v5
    v_add3_u32 v12, v4, v5, s43
    v_add_u32 v1, 64, v1
    v_mul_u32_u24 v2, 3641, v1
    v_lshrrev_b32 v2, 16, v2
    v_mul_u32_u24 v3, 18, v2
    v_sub_u32 v3, v1, v3
    v_and_b32 v4, 0x13, v2
    v_and_b32 v5, 4, v2
    v_lshl_or_b32 v4, v5, 1, v4
    v_bfe_u32 v5, v2, 3, 1
    v_lshl_or_b32 v4, v5, 2, v4
    v_mul_u32_u24 v4, 3456, v4
    v_lshl_add_u32 v4, v3, 4, v4
    v_mul_u32_u24 v5, 57, v3
    v_lshrrev_b32 v5, 9, v5
    v_mul_u32_u24 v5, 1008, v5
    v_add3_u32 v13, v4, v5, s43
    s_cmp_eq_u32 s36, 0
    s_cbranch_scc1 L_q_nw
    s_mul_i32 s55, s39, 221184
    s_add_u32 m0, s51, 18432
    s_nop 0
    buffer_load_dwordx4 v12, s[12:15], s55 offen lds
    s_add_u32 m0, s51, 19456
    s_nop 0
    buffer_load_dwordx4 v13, s[12:15], s55 offen lds
    s_add_u32 s52, s55, 110592
    s_add_u32 m0, s51, 27648
    s_nop 0
    buffer_load_dwordx4 v12, s[12:15], s52 offen lds
    s_add_u32 m0, s51, 28672
    s_nop 0
    buffer_load_dwordx4 v13, s[12:15], s52 offen lds
L_q_nw:
    s_cmp_eq_u32 s36, 0
    s_cselect_b32 s16, s68, s74
    s_cselect_b32 s17, s69, s75
    s_mov_b32 s18, 663552
    s_mov_b32 s19, 0x20000
    s_mov_b32 s20, s76
    s_mov_b32 s21, s77
    s_mov_b32 s22, 4718592
    s_mov_b32 s23, 0x20000
    s_waitcnt lgkmcnt(0)
    s_mov_b32 s24, s80
    s_mov_b32 s25, s81
    s_mov_b32 s26, 0x10000000
    s_mov_b32 s27, 0x20000
    s_mov_b32 s28, s78
    s_mov_b32 s29, s79
    s_mov_b32 s30, 256
    s_mov_b32 s31, 0x20000
    s_cmp_lt_u32 s41, 2
    s_cselect_b32 s32, s12, s8
    s_cselect_b32 s33, s13, s9
    s_cselect_b32 s34, s14, s10
    s_mov_b32 s44, 0xffff0000
    s_mov_b32 s45, -1
    s_mov_b32 s46, 0
    s_mov_b32 s47, -1
    s_mov_b32 s48, 0
    s_mov_b32 s49, 0xffff0000
    s_mul_i32 s43, s38, 144
    s_add_u32 s43, s43, 1152
    v_add_u32 v1, 512, v0
    v_mul_u32_u24 v2, 3641, v1
    v_lshrrev_b32 v2, 16, v2
    v_mul_u32_u24 v3, 18, v2
    v_sub_u32 v3, v1, v3
    v_and_b32 v4, 0x13, v2
    v_and_b32 v5, 4, v2
    v_lshl_or_b32 v4, v5, 1, v4
    v_bfe_u32 v5, v2, 3, 1
    v_lshl_or_b32 v4, v5, 2, v4
    v_mul_u32_u24 v4, 3456, v4
    v_lshl_add_u32 v4, v3, 4, v4
    v_mul_u32_u24 v5, 57, v3
    v_lshrrev_b32 v5, 9, v5
    v_mul_u32_u24 v5, 1008, v5
    v_add3_u32 v14, v4, v5, s43
    s_mul_i32 s58, s41, 110592
    s_mov_b32 s59, 221184
    s_mul_i32 s60, s41, 9216
    s_add_u32 s60, s60, 26624
    s_cmp_lt_u32 s41, 2
    s_cbranch_scc1 L_q_e
    s_lshl_b32 s42, s37, 7
    s_sub_u32 s42, s42, 13
    s_sub_u32 s42, s42, s41
    s_mul_i32 s58, s42, 1152
    s_movk_i32 s59, 128
    s_lshl_b32 s60, s41, 10
    s_add_u32 s60, s60, 14336
    s_cmp_eq_u32 s41, 2
    s_cselect_b64 vcc, -1, 0
    v_cndmask_b32 v14, v11, v10, vcc
    s_cmp_eq_u32 s37, 0
    s_cselect_b32 s58, 1073741824, s58
    s_cmp_eq_u32 s36, 1
    s_cselect_b32 s58, 1073741824, s58
    L_q_e:
    s_add_u32 s53, s60, s3
    s_cmp_eq_u32 s36, 0
    s_cbranch_scc0 L_bq
    s_mul_i32 s43, s38, 144
    v_mov_b32 v9, 1073741824
    s_and_b32 s42, s41, 1
    s_mul_i32 s70, s42, 192
    s_mul_i32 s4, s42, 3072
    s_lshr_b32 s42, s41, 1
    s_mul_i32 s5, s42, 110592
    s_mul_i32 s42, s42, 5120
    s_add_u32 s4, s4, s42
    v_add_u32 v1, s70, v0
    v_mul_u32_u24 v2, 6554, v1
    v_lshrrev_b32 v2, 16, v2
    v_mul_u32_u24 v3, 10, v2
    v_sub_u32 v3, v1, v3
    v_and_b32 v4, 0x13, v2
    v_and_b32 v5, 4, v2
    v_lshl_or_b32 v4, v5, 1, v4
    v_bfe_u32 v5, v2, 3, 1
    v_lshl_or_b32 v4, v5, 2, v4
    v_mul_u32_u24 v15, 3456, v4
    v_lshl_add_u32 v15, v3, 4, v15
    v_add_u32 v15, s43, v15
    v_cmp_eq_u32 vcc, 9, v3
    s_nop 1
    v_cndmask_b32 v15, v15, v9, vcc
    s_add_u32 s70, s70, 64
    v_add_u32 v1, s70, v0
    v_mul_u32_u24 v2, 6554, v1
    v_lshrrev_b32 v2, 16, v2
    v_mul_u32_u24 v3, 10, v2
    v_sub_u32 v3, v1, v3
    v_and_b32 v4, 0x13, v2
    v_and_b32 v5, 4, v2
    v_lshl_or_b32 v4, v5, 1, v4
    v_bfe_u32 v5, v2, 3, 1
    v_lshl_or_b32 v4, v5, 2, v4
    v_mul_u32_u24 v16, 3456, v4
    v_lshl_add_u32 v16, v3, 4, v16
    v_add_u32 v16, s43, v16
    v_cmp_eq_u32 vcc, 9, v3
    s_nop 1
    v_cndmask_b32 v16, v16, v9, vcc
    s_add_u32 s70, s70, 64
    v_add_u32 v1, s70, v0
    v_mul_u32_u24 v2, 6554, v1
    v_lshrrev_b32 v2, 16, v2
    v_mul_u32_u24 v3, 10, v2
    v_sub_u32 v3, v1, v3
    v_and_b32 v4, 0x13, v2
    v_and_b32 v5, 4, v2
    v_lshl_or_b32 v4, v5, 1, v4
    v_bfe_u32 v5, v2, 3, 1
    v_lshl_or_b32 v4, v5, 2, v4
    v_mul_u32_u24 v17, 3456, v4
    v_lshl_add_u32 v17, v3, 4, v17
    v_add_u32 v17, s43, v17
    v_cmp_eq_u32 vcc, 9, v3
    s_nop 1
    v_cndmask_b32 v17, v17, v9, vcc
    s_mul_i32 s55, s39, 221184
    s_add_u32 m0, s51, 18432
    s_nop 0
    buffer_load_dwordx4 v12, s[12:15], s55 offen lds
    s_add_u32 m0, s51, 19456
    s_nop 0
    buffer_load_dwordx4 v13, s[12:15], s55 offen lds
    s_add_u32 s52, s55, 110592
    s_add_u32 m0, s51, 27648
    s_nop 0
    buffer_load_dwordx4 v12, s[12:15], s52 offen lds
    s_add_u32 m0, s51, 28672
    s_nop 0
    buffer_load_dwordx4 v13, s[12:15], s52 offen lds
    s_mul_i32 s57, s39, s59
    s_add_u32 m0, s53, 0
    s_add_u32 s57, s57, s58
    buffer_load_dwordx4 v14, s[32:35], s57 offen lds
    s_add_u32 s39, s39, 1
    s_cmp_eq_u32 s39, 9
    s_cselect_b32 s39, 0, s39
    s_add_u32 s65, s55, s5
    s_add_u32 m0, s4, 36864
    s_nop 0
    buffer_load_dwordx4 v15, s[12:15], s65 offen lds
    s_add_u32 m0, s4, 37888
    s_nop 0
    buffer_load_dwordx4 v16, s[12:15], s65 offen lds
    s_bitcmp1_b32 s41, 0
    s_cbranch_scc1 L_aq0
    s_add_u32 m0, s4, 38912
    s_nop 0
    buffer_load_dwordx4 v17, s[12:15], s65 offen lds
L_aq0:
    s_mul_i32 s43, s38, 144
    v_mov_b32 v9, 1073741824
    v_add_u32 v1, 0, v0
    v_mul_u32_u24 v2, 6554, v1
    v_lshrrev_b32 v2, 16, v2
    v_mul_u32_u24 v3, 10, v2
    v_sub_u32 v3, v1, v3
    v_lshrrev_b32 v4, 4, v2
    v_bfe_u32 v5, v2, 2, 1
    v_lshl_add_u32 v4, v4, 1, v5
    v_bfe_u32 v5, v2, 3, 1
    v_and_b32 v6, 3, v2
    v_mul_u32_u24 v7, 16, v5
    v_lshl_add_u32 v7, v4, 2, v7
    v_add_u32 v7, v7, v6
    v_mul_u32_u24 v20, 1152, v7
    v_lshl_add_u32 v20, v3, 4, v20
    v_add_u32 v20, s43, v20
    v_cmp_eq_u32 vcc, 9, v3
    s_nop 1
    v_cndmask_b32 v20, v20, v9, vcc
    v_lshl_add_u32 v5, v5, 2, v6
    v_add_u32 v7, 64, v5
    v_mul_u32_u24 v4, 72, v4
    v_add_u32 v7, v7, v4
    v_mul_u32_u24 v25, 1152, v7
    v_lshl_add_u32 v25, v3, 4, v25
    v_add_u32 v25, s43, v25
    v_cmp_eq_u32 vcc, 9, v3
    s_nop 1
    v_cndmask_b32 v25, v25, v9, vcc
    v_add_u32 v1, 64, v0
    v_mul_u32_u24 v2, 6554, v1
    v_lshrrev_b32 v2, 16, v2
    v_mul_u32_u24 v3, 10, v2
    v_sub_u32 v3, v1, v3
    v_lshrrev_b32 v4, 4, v2
    v_bfe_u32 v5, v2, 2, 1
    v_lshl_add_u32 v4, v4, 1, v5
    v_bfe_u32 v5, v2, 3, 1
    v_and_b32 v6, 3, v2
    v_mul_u32_u24 v7, 16, v5
    v_lshl_add_u32 v7, v4, 2, v7
    v_add_u32 v7, v7, v6
    v_mul_u32_u24 v21, 1152, v7
    v_lshl_add_u32 v21, v3, 4, v21
    v_add_u32 v21, s43, v21
    v_cmp_eq_u32 vcc, 9, v3
    s_nop 1
    v_cndmask_b32 v21, v21, v9, vcc
    v_lshl_add_u32 v5, v5, 2, v6
    v_add_u32 v7, 64, v5
    v_mul_u32_u24 v4, 72, v4
    v_add_u32 v7, v7, v4
    v_mul_u32_u24 v26, 1152, v7
    v_lshl_add_u32 v26, v3, 4, v26
    v_add_u32 v26, s43, v26
    v_cmp_eq_u32 vcc, 9, v3
    s_nop 1
    v_cndmask_b32 v26, v26, v9, vcc
    v_add_u32 v1, 128, v0
    v_mul_u32_u24 v2, 6554, v1
    v_lshrrev_b32 v2, 16, v2
    v_mul_u32_u24 v3, 10, v2
    v_sub_u32 v3, v1, v3
    v_lshrrev_b32 v4, 4, v2
    v_bfe_u32 v5, v2, 2, 1
    v_lshl_add_u32 v4, v4, 1, v5
    v_bfe_u32 v5, v2, 3, 1
    v_and_b32 v6, 3, v2
    v_mul_u32_u24 v7, 16, v5
    v_lshl_add_u32 v7, v4, 2, v7
    v_add_u32 v7, v7, v6
    v_mul_u32_u24 v22, 1152, v7
    v_lshl_add_u32 v22, v3, 4, v22
    v_add_u32 v22, s43, v22
    v_cmp_eq_u32 vcc, 9, v3
    s_nop 1
    v_cndmask_b32 v22, v22, v9, vcc
    v_lshl_add_u32 v5, v5, 2, v6
    v_add_u32 v7, 64, v5
    v_mul_u32_u24 v4, 72, v4
    v_add_u32 v7, v7, v4
    v_mul_u32_u24 v27, 1152, v7
    v_lshl_add_u32 v27, v3, 4, v27
    v_add_u32 v27, s43, v27
    v_cmp_eq_u32 vcc, 9, v3
    s_nop 1
    v_cndmask_b32 v27, v27, v9, vcc
    v_add_u32 v1, 192, v0
    v_mul_u32_u24 v2, 6554, v1
    v_lshrrev_b32 v2, 16, v2
    v_mul_u32_u24 v3, 10, v2
    v_sub_u32 v3, v1, v3
    v_lshrrev_b32 v4, 4, v2
    v_bfe_u32 v5, v2, 2, 1
    v_lshl_add_u32 v4, v4, 1, v5
    v_bfe_u32 v5, v2, 3, 1
    v_and_b32 v6, 3, v2
    v_mul_u32_u24 v7, 16, v5
    v_lshl_add_u32 v7, v4, 2, v7
    v_add_u32 v7, v7, v6
    v_mul_u32_u24 v23, 1152, v7
    v_lshl_add_u32 v23, v3, 4, v23
    v_add_u32 v23, s43, v23
    v_cmp_eq_u32 vcc, 9, v3
    s_nop 1
    v_cndmask_b32 v23, v23, v9, vcc
    v_lshl_add_u32 v5, v5, 2, v6
    v_add_u32 v7, 64, v5
    v_mul_u32_u24 v4, 72, v4
    v_add_u32 v7, v7, v4
    v_mul_u32_u24 v28, 1152, v7
    v_lshl_add_u32 v28, v3, 4, v28
    v_add_u32 v28, s43, v28
    v_cmp_eq_u32 vcc, 9, v3
    s_nop 1
    v_cndmask_b32 v28, v28, v9, vcc
    v_add_u32 v1, 256, v0
    v_mul_u32_u24 v2, 6554, v1
    v_lshrrev_b32 v2, 16, v2
    v_mul_u32_u24 v3, 10, v2
    v_sub_u32 v3, v1, v3
    v_lshrrev_b32 v4, 4, v2
    v_bfe_u32 v5, v2, 2, 1
    v_lshl_add_u32 v4, v4, 1, v5
    v_bfe_u32 v5, v2, 3, 1
    v_and_b32 v6, 3, v2
    v_mul_u32_u24 v7, 16, v5
    v_lshl_add_u32 v7, v4, 2, v7
    v_add_u32 v7, v7, v6
    v_mul_u32_u24 v24, 1152, v7
    v_lshl_add_u32 v24, v3, 4, v24
    v_add_u32 v24, s43, v24
    v_cmp_eq_u32 vcc, 9, v3
    s_nop 1
    v_cndmask_b32 v24, v24, v9, vcc
    v_lshl_add_u32 v5, v5, 2, v6
    v_add_u32 v7, 64, v5
    v_mul_u32_u24 v4, 72, v4
    v_add_u32 v7, v7, v4
    v_mul_u32_u24 v29, 1152, v7
    v_lshl_add_u32 v29, v3, 4, v29
    v_add_u32 v29, s43, v29
    v_cmp_eq_u32 vcc, 9, v3
    s_nop 1
    v_cndmask_b32 v29, v29, v9, vcc
    v_lshlrev_b32 v31, 2, v0
    v_add_u32 v31, 162816, v31
    v_mov_b32 v9, 163712
    v_cmp_eq_u32 vcc, 0, v0
    s_nop 1
    v_cndmask_b32 v31, v31, v9, vcc
    v_mov_b32 v9, 1
    s_lshl_b32 s56, s39, 7
    s_add_u32 s56, s56, s54
    s_add_u32 m0, s61, 47104
    s_nop 0
    buffer_load_dwordx4 v10, s[8:11], s56 offen lds
    s_add_u32 m0, s61, 48128
    s_add_u32 s42, s56, 18432
    buffer_load_dwordx4 v11, s[8:11], s42 offen lds
    s_add_u32 m0, s61, 49152
    s_add_u32 s42, s56, 36864
    buffer_load_dwordx4 v10, s[8:11], s42 offen lds
    s_add_u32 m0, s61, 50176
    s_add_u32 s42, s56, 55296
    buffer_load_dwordx4 v11, s[8:11], s42 offen lds
    s_mul_i32 s55, s39, 221184
    s_add_u32 m0, s62, 65536
    s_nop 0
    buffer_load_dwordx4 v12, s[12:15], s55 offen lds
    s_add_u32 m0, s62, 66560
    s_nop 0
    buffer_load_dwordx4 v13, s[12:15], s55 offen lds
    s_mul_i32 s57, s39, s59
    s_add_u32 m0, s60, 47104
    s_add_u32 s57, s57, s58
    buffer_load_dwordx4 v14, s[32:35], s57 offen lds
    s_add_u32 s39, s39, 1
    s_cmp_eq_u32 s39, 9
    s_cselect_b32 s39, 0, s39
    s_add_u32 s65, s55, s5
    s_add_u32 m0, s4, 83968
    s_nop 0
    buffer_load_dwordx4 v15, s[12:15], s65 offen lds
    s_add_u32 m0, s4, 84992
    s_nop 0
    buffer_load_dwordx4 v16, s[12:15], s65 offen lds
    s_bitcmp1_b32 s41, 0
    s_cbranch_scc1 L_aq1
    s_add_u32 m0, s4, 86016
    s_nop 0
    buffer_load_dwordx4 v17, s[12:15], s65 offen lds
L_aq1:
    s_add_u32 s65, s55, 110592
    s_add_u32 m0, s62, 74752
    s_nop 0
    buffer_load_dwordx4 v12, s[12:15], s65 offen lds
    s_add_u32 m0, s62, 75776
    s_nop 0
    buffer_load_dwordx4 v13, s[12:15], s65 offen lds
    s_mov_b32 s67, 94208
    s_mov_b32 s66, 0
L_aloop:
    s_waitcnt vmcnt(12)
    s_bitcmp1_b32 s41, 0
    s_cbranch_scc0 L_awl
    s_waitcnt vmcnt(11)
L_awl:
    s_barrier
    s_add_u32 s68, s61, s67
    s_add_u32 s69, s62, s67
    s_add_u32 s70, s60, s67
    s_add_u32 s71, s4, s67
    s_lshl_b32 s79, s66, 2
    s_lshl_b32 s56, s39, 7
    s_add_u32 s56, s56, s54
    s_add_u32 m0, s68, 0
    s_nop 0
    buffer_load_dwordx4 v10, s[8:11], s56 offen lds
    s_add_u32 m0, s68, 1024
    s_add_u32 s42, s56, 18432
    buffer_load_dwordx4 v11, s[8:11], s42 offen lds
    s_add_u32 m0, s68, 2048
    s_add_u32 s42, s56, 36864
    buffer_load_dwordx4 v10, s[8:11], s42 offen lds
    s_add_u32 m0, s68, 3072
    s_add_u32 s42, s56, 55296
    buffer_load_dwordx4 v11, s[8:11], s42 offen lds
    s_mul_i32 s55, s39, 221184
    s_add_u32 m0, s69, 18432
    s_nop 0
    buffer_load_dwordx4 v12, s[12:15], s55 offen lds
    s_add_u32 m0, s69, 19456
    s_nop 0
    buffer_load_dwordx4 v13, s[12:15], s55 offen lds
    s_mul_i32 s57, s39, s59
    s_add_u32 m0, s70, 0
    s_add_u32 s57, s57, s58
    buffer_load_dwordx4 v14, s[32:35], s57 offen lds
    s_add_u32 s39, s39, 1
    s_cmp_eq_u32 s39, 9
    s_cselect_b32 s39, 0, s39
    s_add_u32 s65, s55, s5
    s_add_u32 m0, s71, 36864
    s_nop 0
    buffer_load_dwordx4 v15, s[12:15], s65 offen lds
    s_add_u32 m0, s71, 37888
    s_nop 0
    buffer_load_dwordx4 v16, s[12:15], s65 offen lds
    s_bitcmp1_b32 s41, 0
    s_cbranch_scc1 L_aql
    s_add_u32 m0, s71, 38912
    s_nop 0
    buffer_load_dwordx4 v17, s[12:15], s65 offen lds
L_aql:
    s_add_u32 s65, s55, 110592
    s_add_u32 m0, s69, 27648
    s_nop 0
    buffer_load_dwordx4 v12, s[12:15], s65 offen lds
    s_add_u32 m0, s69, 28672
    s_nop 0
    buffer_load_dwordx4 v13, s[12:15], s65 offen lds
    s_add_u32 s67, s67, 47104
    s_cmp_eq_u32 s67, 141312
    s_cselect_b32 s67, 0, s67
    s_add_u32 s66, s66, 1
    s_cmp_lt_u32 s66, 7
    s_cbranch_scc1 L_aloop
    s_waitcnt vmcnt(12)
    s_bitcmp1_b32 s41, 0
    s_cbranch_scc0 L_aw7
    s_waitcnt vmcnt(11)
L_aw7:
    s_barrier
    buffer_load_dword v30, off, s[28:31], 0 sc1
    s_add_u32 s42, s41, 0
    s_cmp_lt_u32 s41, 2
    s_cselect_b32 s43, 0, s6
    s_add_u32 s42, s42, s43
    s_cmp_ge_u32 s42, 16
    s_cselect_b32 s43, 14, 0
    s_sub_u32 s42, s42, s43
    s_lshl_b32 s43, s38, 1
    s_add_u32 s42, s42, s43
    s_and_b32 s42, s42, 15
    s_lshr_b32 s43, s42, 1
    s_mul_i32 s43, s43, 82944
    s_and_b32 s42, s42, 1
    s_mul_i32 s42, s42, 36864
    s_add_u32 s55, s42, s43
    s_mul_i32 s43, s41, 5120
    s_add_u32 m0, s43, 0
    s_nop 0
    buffer_load_dwordx4 v20, s[16:19], s55 offen lds
    s_add_u32 m0, s43, 1024
    s_nop 0
    buffer_load_dwordx4 v21, s[16:19], s55 offen lds
    s_add_u32 m0, s43, 2048
    s_nop 0
    buffer_load_dwordx4 v22, s[16:19], s55 offen lds
    s_add_u32 m0, s43, 3072
    s_nop 0
    buffer_load_dwordx4 v23, s[16:19], s55 offen lds
    s_add_u32 m0, s43, 4096
    s_nop 0
    buffer_load_dwordx4 v24, s[16:19], s55 offen lds
    s_add_u32 s42, s41, 4
    s_add_u32 s42, s42, s6
    s_cmp_ge_u32 s42, 16
    s_cselect_b32 s43, 14, 0
    s_sub_u32 s42, s42, s43
    s_lshl_b32 s43, s38, 1
    s_add_u32 s42, s42, s43
    s_and_b32 s42, s42, 15
    s_lshr_b32 s43, s42, 1
    s_mul_i32 s43, s43, 82944
    s_and_b32 s42, s42, 1
    s_mul_i32 s42, s42, 36864
    s_add_u32 s55, s42, s43
    s_mul_i32 s43, s41, 5120
    s_add_u32 m0, s43, 20480
    s_nop 0
    buffer_load_dwordx4 v20, s[16:19], s55 offen lds
    s_add_u32 m0, s43, 21504
    s_nop 0
    buffer_load_dwordx4 v21, s[16:19], s55 offen lds
    s_add_u32 m0, s43, 22528
    s_nop 0
    buffer_load_dwordx4 v22, s[16:19], s55 offen lds
    s_add_u32 m0, s43, 23552
    s_nop 0
    buffer_load_dwordx4 v23, s[16:19], s55 offen lds
    s_add_u32 m0, s43, 24576
    s_nop 0
    buffer_load_dwordx4 v24, s[16:19], s55 offen lds
    s_waitcnt vmcnt(10)
    v_readfirstlane_b32 s42, v30
    s_cmp_ge_u32 s42, 34
    s_cbranch_scc1 L_rdy_a
    s_mov_b32 s66, 0
    L_rsp_a:
    buffer_load_dword v30, off, s[28:31], 0 sc1
    s_add_u32 s66, s66, 1
    s_waitcnt vmcnt(0)
    v_readfirstlane_b32 s42, v30
    s_cmp_ge_u32 s66, 1000000
    s_cbranch_scc1 L_rdy_a
    s_cmp_ge_u32 s42, 34
    s_cbranch_scc0 L_rsp_a
    L_rdy_a:
    s_barrier
    s_add_u32 s42, s41, 8
    s_add_u32 s42, s42, s6
    s_cmp_ge_u32 s42, 16
    s_cselect_b32 s43, 14, 0
    s_sub_u32 s42, s42, s43
    s_lshl_b32 s43, s38, 1
    s_add_u32 s42, s42, s43
    s_and_b32 s42, s42, 15
    s_lshr_b32 s43, s42, 1
    s_mul_i32 s43, s43, 82944
    s_and_b32 s42, s42, 1
    s_mul_i32 s42, s42, 36864
    s_add_u32 s55, s42, s43
    s_mul_i32 s43, s41, 5120
    s_add_u32 m0, s43, 47104
    s_nop 0
    buffer_load_dwordx4 v20, s[16:19], s55 offen lds
    s_add_u32 m0, s43, 48128
    s_nop 0
    buffer_load_dwordx4 v21, s[16:19], s55 offen lds
    s_add_u32 m0, s43, 49152
    s_nop 0
    buffer_load_dwordx4 v22, s[16:19], s55 offen lds
    s_add_u32 m0, s43, 50176
    s_nop 0
    buffer_load_dwordx4 v23, s[16:19], s55 offen lds
    s_add_u32 m0, s43, 51200
    s_nop 0
    buffer_load_dwordx4 v24, s[16:19], s55 offen lds
    s_add_u32 s42, s41, 12
    s_add_u32 s42, s42, s6
    s_cmp_ge_u32 s42, 16
    s_cselect_b32 s43, 14, 0
    s_sub_u32 s42, s42, s43
    s_lshl_b32 s43, s38, 1
    s_add_u32 s42, s42, s43
    s_and_b32 s42, s42, 15
    s_lshr_b32 s43, s42, 1
    s_mul_i32 s43, s43, 82944
    s_and_b32 s42, s42, 1
    s_mul_i32 s42, s42, 36864
    s_add_u32 s55, s42, s43
    s_mul_i32 s43, s41, 5120
    s_add_u32 m0, s43, 67584
    s_nop 0
    buffer_load_dwordx4 v20, s[16:19], s55 offen lds
    s_add_u32 m0, s43, 68608
    s_nop 0
    buffer_load_dwordx4 v21, s[16:19], s55 offen lds
    s_add_u32 m0, s43, 69632
    s_nop 0
    buffer_load_dwordx4 v22, s[16:19], s55 offen lds
    s_add_u32 m0, s43, 70656
    s_nop 0
    buffer_load_dwordx4 v23, s[16:19], s55 offen lds
    s_add_u32 m0, s43, 71680
    s_nop 0
    buffer_load_dwordx4 v24, s[16:19], s55 offen lds
    s_mov_b32 s55, 0
    s_cmp_eq_u32 s41, 0
    s_cbranch_scc0 L_wla00
    s_mov_b32 m0, 40960
    s_nop 0
    buffer_load_dwordx4 v25, s[16:19], s55 offen lds
    s_mov_b32 m0, 45056
    s_nop 0
    buffer_load_dwordx4 v29, s[16:19], s55 offen lds
L_wla00:
    s_cmp_eq_u32 s41, 1
    s_cbranch_scc0 L_wla01
    s_mov_b32 m0, 41984
    s_nop 0
    buffer_load_dwordx4 v26, s[16:19], s55 offen lds
L_wla01:
    s_cmp_eq_u32 s41, 2
    s_cbranch_scc0 L_wla02
    s_mov_b32 m0, 43008
    s_nop 0
    buffer_load_dwordx4 v27, s[16:19], s55 offen lds
L_wla02:
    s_cmp_eq_u32 s41, 3
    s_cbranch_scc0 L_wla03
    s_mov_b32 m0, 44032
    s_nop 0
    buffer_load_dwordx4 v28, s[16:19], s55 offen lds
L_wla03:
    s_mov_b32 s55, 331776
    s_cmp_eq_u32 s41, 0
    s_cbranch_scc0 L_wla10
    s_mov_b32 m0, 88064
    s_nop 0
    buffer_load_dwordx4 v25, s[16:19], s55 offen lds
    s_mov_b32 m0, 92160
    s_nop 0
    buffer_load_dwordx4 v29, s[16:19], s55 offen lds
L_wla10:
    s_cmp_eq_u32 s41, 1
    s_cbranch_scc0 L_wla11
    s_mov_b32 m0, 89088
    s_nop 0
    buffer_load_dwordx4 v26, s[16:19], s55 offen lds
L_wla11:
    s_cmp_eq_u32 s41, 2
    s_cbranch_scc0 L_wla12
    s_mov_b32 m0, 90112
    s_nop 0
    buffer_load_dwordx4 v27, s[16:19], s55 offen lds
L_wla12:
    s_cmp_eq_u32 s41, 3
    s_cbranch_scc0 L_wla13
    s_mov_b32 m0, 91136
    s_nop 0
    buffer_load_dwordx4 v28, s[16:19], s55 offen lds
L_wla13:
    s_waitcnt vmcnt(0)
    s_barrier
    s_branch L_end
L_bq:
    s_mul_i32 s57, s39, s59
    s_add_u32 m0, s53, 0
    s_add_u32 s57, s57, s58
    buffer_load_dwordx4 v14, s[32:35], s57 offen lds
    s_add_u32 s39, s39, 1
    s_cmp_eq_u32 s39, 9
    s_cselect_b32 s39, 0, s39
    s_lshl_b32 s56, s39, 7
    s_add_u32 s56, s56, s54
    s_add_u32 m0, s61, 0
    s_nop 0
    buffer_load_dwordx4 v10, s[8:11], s56 offen lds
    s_add_u32 m0, s61, 1024
    s_add_u32 s42, s56, 18432
    buffer_load_dwordx4 v11, s[8:11], s42 offen lds
    s_mul_i32 s43, s38, 144
    v_mov_b32 v9, 1073741824
    v_add_u32 v1, 0, v0
    v_mul_u32_u24 v2, 6554, v1
    v_lshrrev_b32 v2, 16, v2
    v_mul_u32_u24 v3, 10, v2
    v_sub_u32 v3, v1, v3
    v_and_b32 v4, 0x13, v2
    v_and_b32 v5, 4, v2
    v_lshl_or_b32 v4, v5, 1, v4
    v_bfe_u32 v5, v2, 3, 1
    v_lshl_or_b32 v4, v5, 2, v4
    v_mul_u32_u24 v15, 3456, v4
    v_lshl_add_u32 v15, v3, 4, v15
    v_add_u32 v15, s43, v15
    v_cmp_eq_u32 vcc, 9, v3
    s_nop 1
    v_cndmask_b32 v15, v15, v9, vcc
    v_add_u32 v1, 64, v0
    v_mul_u32_u24 v2, 6554, v1
    v_lshrrev_b32 v2, 16, v2
    v_mul_u32_u24 v3, 10, v2
    v_sub_u32 v3, v1, v3
    v_and_b32 v4, 0x13, v2
    v_and_b32 v5, 4, v2
    v_lshl_or_b32 v4, v5, 1, v4
    v_bfe_u32 v5, v2, 3, 1
    v_lshl_or_b32 v4, v5, 2, v4
    v_mul_u32_u24 v16, 3456, v4
    v_lshl_add_u32 v16, v3, 4, v16
    v_add_u32 v16, s43, v16
    v_cmp_eq_u32 vcc, 9, v3
    s_nop 1
    v_cndmask_b32 v16, v16, v9, vcc
    v_add_u32 v1, 128, v0
    v_mul_u32_u24 v2, 6554, v1
    v_lshrrev_b32 v2, 16, v2
    v_mul_u32_u24 v3, 10, v2
    v_sub_u32 v3, v1, v3
    v_and_b32 v4, 0x13, v2
    v_and_b32 v5, 4, v2
    v_lshl_or_b32 v4, v5, 1, v4
    v_bfe_u32 v5, v2, 3, 1
    v_lshl_or_b32 v4, v5, 2, v4
    v_mul_u32_u24 v17, 3456, v4
    v_lshl_add_u32 v17, v3, 4, v17
    v_add_u32 v17, s43, v17
    v_cmp_eq_u32 vcc, 9, v3
    s_nop 1
    v_cndmask_b32 v17, v17, v9, vcc
    v_add_u32 v1, 192, v0
    v_mul_u32_u24 v2, 6554, v1
    v_lshrrev_b32 v2, 16, v2
    v_mul_u32_u24 v3, 10, v2
    v_sub_u32 v3, v1, v3
    v_and_b32 v4, 0x13, v2
    v_and_b32 v5, 4, v2
    v_lshl_or_b32 v4, v5, 1, v4
    v_bfe_u32 v5, v2, 3, 1
    v_lshl_or_b32 v4, v5, 2, v4
    v_mul_u32_u24 v18, 3456, v4
    v_lshl_add_u32 v18, v3, 4, v18
    v_add_u32 v18, s43, v18
    v_cmp_eq_u32 vcc, 9, v3
    s_nop 1
    v_cndmask_b32 v18, v18, v9, vcc
    v_add_u32 v1, 256, v0
    v_mul_u32_u24 v2, 6554, v1
    v_lshrrev_b32 v2, 16, v2
    v_mul_u32_u24 v3, 10, v2
    v_sub_u32 v3, v1, v3
    v_and_b32 v4, 0x13, v2
    v_and_b32 v5, 4, v2
    v_lshl_or_b32 v4, v5, 1, v4
    v_bfe_u32 v5, v2, 3, 1
    v_lshl_or_b32 v4, v5, 2, v4
    v_mul_u32_u24 v19, 3456, v4
    v_lshl_add_u32 v19, v3, 4, v19
    v_add_u32 v19, s43, v19
    v_cmp_eq_u32 vcc, 9, v3
    s_nop 1
    v_cndmask_b32 v19, v19, v9, vcc
    v_and_b32 v1, 15, v0
    v_lshrrev_b32 v2, 4, v0
    v_lshrrev_b32 v3, 1, v1
    v_xor_b32 v2, v2, v3
    v_lshlrev_b32 v2, 4, v2
    v_lshl_add_u32 v20, v1, 7, v2
    v_add_u32 v20, s61, v20
    v_xor_b32 v21, 64, v20
    v_add_u32 v22, 73728, v20
    v_add_u32 v23, 73728, v21
    v_lshrrev_b32 v1, 5, v0
    v_bfe_u32 v29, v0, 2, 3
    v_lshl_add_u32 v1, v1, 4, v29
    v_mul_u32_u24 v1, 160, v1
    v_and_b32 v29, 3, v0
    v_lshl_add_u32 v29, v29, 3, v1
    v_add_u32 v30, 46080, v29
    v_and_b32 v1, 15, v0
    v_lshrrev_b32 v2, 4, v0
    v_mul_u32_u24 v4, 80, v1
    v_lshl_add_u32 v4, v2, 4, v4
    v_add_u32 v92, 153600, v4
    v_and_b32 v4, 3, v0
    v_min_u32 v4, 2, v4
    v_mul_u32_u24 v4, 80, v4
    v_lshl_add_u32 v4, v2, 4, v4
    v_add_u32 v93, 154880, v4
    v_mov_b32 v96, 0
    v_mov_b32 v97, 0
    v_mov_b32 v98, 0x358637bd
    v_mov_b32 v99, 0x358637bd
    v_mov_b32 v108, 0x358637bd
    v_mov_b32 v109, 0x358637bd
    v_mov_b32 v110, 0x358637bd
    v_mov_b32 v111, 0x358637bd
    s_mov_b32 s74, 0x3fb8aa3b
    s_mov_b32 s75, 0x3fb8aa3b
    s_mov_b32 s68, 0x358637bd
    v_mov_b32 v8, 0xb5c1a2a0
    s_add_u32 m0, s61, 2048
    s_add_u32 s42, s56, 36864
    buffer_load_dwordx4 v10, s[8:11], s42 offen lds
    s_add_u32 m0, s61, 3072
    s_add_u32 s42, s56, 55296
    buffer_load_dwordx4 v11, s[8:11], s42 offen lds
    s_mul_i32 s55, s39, 221184
    s_add_u32 m0, s62, 18432
    s_nop 0
    buffer_load_dwordx4 v12, s[12:15], s55 offen lds
    s_add_u32 m0, s62, 19456
    s_nop 0
    buffer_load_dwordx4 v13, s[12:15], s55 offen lds
    s_mul_i32 s57, s39, s59
    s_add_u32 m0, s60, 0
    s_add_u32 s57, s57, s58
    buffer_load_dwordx4 v14, s[32:35], s57 offen lds
    s_add_u32 s39, s39, 1
    s_cmp_eq_u32 s39, 9
    s_cselect_b32 s39, 0, s39
    s_add_u32 s65, s55, 110592
    s_add_u32 m0, s62, 27648
    s_nop 0
    buffer_load_dwordx4 v12, s[12:15], s65 offen lds
    s_add_u32 m0, s62, 28672
    s_nop 0
    buffer_load_dwordx4 v13, s[12:15], s65 offen lds
    v_lshlrev_b32 v31, 2, v0
    v_add_u32 v31, 162816, v31
    v_mov_b32 v9, 163712
    v_cmp_eq_u32 vcc, 0, v0
    s_nop 1
    v_cndmask_b32 v31, v31, v9, vcc
    v_mov_b32 v9, 1
    s_waitcnt vmcnt(9)
    s_barrier
    s_lshl_b32 s56, s39, 7
    s_add_u32 s56, s56, s54
    s_add_u32 m0, s61, 36864
    s_nop 0
    buffer_load_dwordx4 v10, s[8:11], s56 offen lds
    ds_read_b128 v[112:115], v22 offset:36864
    s_add_u32 m0, s61, 37888
    s_add_u32 s42, s56, 18432
    buffer_load_dwordx4 v11, s[8:11], s42 offen lds
    s_add_u32 m0, s61, 38912
    s_add_u32 s42, s56, 36864
    buffer_load_dwordx4 v10, s[8:11], s42 offen lds
    ds_read_b128 v[116:119], v22 offset:38912
    s_add_u32 m0, s61, 39936
    s_add_u32 s42, s56, 55296
    buffer_load_dwordx4 v11, s[8:11], s42 offen lds
    s_mul_i32 s55, s39, 221184
    s_add_u32 m0, s62, 55296
    s_nop 0
    buffer_load_dwordx4 v12, s[12:15], s55 offen lds
    ds_read_b128 v[120:123], v23 offset:36864
    s_add_u32 m0, s62, 56320
    s_nop 0
    buffer_load_dwordx4 v13, s[12:15], s55 offen lds
    s_mul_i32 s57, s39, s59
    s_add_u32 m0, s60, 36864
    s_add_u32 s57, s57, s58
    buffer_load_dwordx4 v14, s[32:35], s57 offen lds
    s_add_u32 s39, s39, 1
    s_cmp_eq_u32 s39, 9
    s_cselect_b32 s39, 0, s39
    ds_read_b128 v[124:127], v23 offset:38912
    s_add_u32 s65, s55, 110592
    s_add_u32 m0, s62, 64512
    s_nop 0
    buffer_load_dwordx4 v12, s[12:15], s65 offen lds
    s_add_u32 m0, s62, 65536
    s_nop 0
    buffer_load_dwordx4 v13, s[12:15], s65 offen lds
    s_waitcnt lgkmcnt(0)
    s_waitcnt vmcnt(9)
    s_barrier
    s_lshl_b32 s56, s39, 7
    s_add_u32 s56, s56, s54
    s_add_u32 m0, s61, 73728
    s_nop 0
    buffer_load_dwordx4 v10, s[8:11], s56 offen lds
    ds_read_b128 v[128:131], v20 offset:0
    s_add_u32 m0, s61, 74752
    s_add_u32 s42, s56, 18432
    buffer_load_dwordx4 v11, s[8:11], s42 offen lds
    s_add_u32 m0, s61, 75776
    s_add_u32 s42, s56, 36864
    buffer_load_dwordx4 v10, s[8:11], s42 offen lds
    ds_read_b128 v[132:135], v20 offset:2048
    s_add_u32 m0, s61, 76800
    s_add_u32 s42, s56, 55296
    buffer_load_dwordx4 v11, s[8:11], s42 offen lds
    s_mul_i32 s55, s39, 221184
    s_add_u32 m0, s62, 92160
    s_nop 0
    buffer_load_dwordx4 v12, s[12:15], s55 offen lds
    ds_read_b128 v[136:139], v21 offset:0
    s_add_u32 m0, s62, 93184
    s_nop 0
    buffer_load_dwordx4 v13, s[12:15], s55 offen lds
    s_mul_i32 s57, s39, s59
    s_add_u32 m0, s60, 73728
    s_add_u32 s57, s57, s58
    buffer_load_dwordx4 v14, s[32:35], s57 offen lds
    s_add_u32 s39, s39, 1
    s_cmp_eq_u32 s39, 9
    s_cselect_b32 s39, 0, s39
    ds_read_b128 v[140:143], v21 offset:2048
    s_add_u32 s65, s55, 110592
    s_add_u32 m0, s62, 101376
    s_nop 0
    buffer_load_dwordx4 v12, s[12:15], s65 offen lds
    s_add_u32 m0, s62, 102400
    s_nop 0
    buffer_load_dwordx4 v13, s[12:15], s65 offen lds
    s_waitcnt lgkmcnt(0)
    s_waitcnt vmcnt(9)
    s_barrier
    s_lshl_b32 s56, s39, 7
    s_add_u32 s56, s56, s54
    s_add_u32 m0, s61, 110592
    s_nop 0
    buffer_load_dwordx4 v10, s[8:11], s56 offen lds
    ds_read_b128 v[144:147], v20 offset:36864
    s_add_u32 m0, s61, 111616
    s_add_u32 s42, s56, 18432
    buffer_load_dwordx4 v11, s[8:11], s42 offen lds
    s_add_u32 m0, s61, 112640
    s_add_u32 s42, s56, 36864
    buffer_load_dwordx4 v10, s[8:11], s42 offen lds
    ds_read_b128 v[148:151], v20 offset:38912
    s_add_u32 m0, s61, 113664
    s_add_u32 s42, s56, 55296
    buffer_load_dwordx4 v11, s[8:11], s42 offen lds
    s_mul_i32 s55, s39, 221184
    s_add_u32 m0, s62, 129024
    s_nop 0
    buffer_load_dwordx4 v12, s[12:15], s55 offen lds
    ds_read_b128 v[152:155], v21 offset:36864
    s_add_u32 m0, s62, 130048
    s_nop 0
    buffer_load_dwordx4 v13, s[12:15], s55 offen lds
    s_mul_i32 s57, s39, s59
    s_add_u32 m0, s60, 110592
    s_add_u32 s57, s57, s58
    buffer_load_dwordx4 v14, s[32:35], s57 offen lds
    s_add_u32 s39, s39, 1
    s_cmp_eq_u32 s39, 9
    s_cselect_b32 s39, 0, s39
    ds_read_b128 v[156:159], v21 offset:38912
    s_add_u32 s65, s55, 110592
    s_add_u32 m0, s62, 138240
    s_nop 0
    buffer_load_dwordx4 v12, s[12:15], s65 offen lds
    s_add_u32 m0, s62, 139264
    s_nop 0
    buffer_load_dwordx4 v13, s[12:15], s65 offen lds
    s_waitcnt lgkmcnt(0)
    s_waitcnt vmcnt(9)
    s_barrier
    s_lshl_b32 s56, s39, 7
    s_add_u32 s56, s56, s54
    s_add_u32 m0, s61, 0
    s_nop 0
    buffer_load_dwordx4 v10, s[8:11], s56 offen lds
    ds_read_b128 v[160:163], v22 offset:0
    s_add_u32 m0, s61, 1024
    s_add_u32 s42, s56, 18432
    buffer_load_dwordx4 v11, s[8:11], s42 offen lds
    s_add_u32 m0, s61, 2048
    s_add_u32 s42, s56, 36864
    buffer_load_dwordx4 v10, s[8:11], s42 offen lds
    ds_read_b128 v[164:167], v22 offset:2048
    s_add_u32 m0, s61, 3072
    s_add_u32 s42, s56, 55296
    buffer_load_dwordx4 v11, s[8:11], s42 offen lds
    s_mul_i32 s55, s39, 221184
    s_add_u32 m0, s62, 18432
    s_nop 0
    buffer_load_dwordx4 v12, s[12:15], s55 offen lds
    ds_read_b128 v[168:171], v23 offset:0
    s_add_u32 m0, s62, 19456
    s_nop 0
    buffer_load_dwordx4 v13, s[12:15], s55 offen lds
    s_mul_i32 s57, s39, s59
    s_add_u32 m0, s60, 0
    s_add_u32 s57, s57, s58
    buffer_load_dwordx4 v14, s[32:35], s57 offen lds
    s_add_u32 s39, s39, 1
    s_cmp_eq_u32 s39, 9
    s_cselect_b32 s39, 0, s39
    ds_read_b128 v[172:175], v23 offset:2048
    s_add_u32 s65, s55, 110592
    s_add_u32 m0, s62, 27648
    s_nop 0
    buffer_load_dwordx4 v12, s[12:15], s65 offen lds
    s_add_u32 m0, s62, 28672
    s_nop 0
    buffer_load_dwordx4 v13, s[12:15], s65 offen lds
    s_waitcnt lgkmcnt(0)
    s_waitcnt vmcnt(9)
    s_barrier
    s_lshl_b32 s56, s39, 7
    s_add_u32 s56, s56, s54
    s_add_u32 m0, s61, 36864
    s_nop 0
    buffer_load_dwordx4 v10, s[8:11], s56 offen lds
    ds_read_b128 v[176:179], v22 offset:36864
    s_add_u32 m0, s61, 37888
    s_add_u32 s42, s56, 18432
    buffer_load_dwordx4 v11, s[8:11], s42 offen lds
    s_add_u32 m0, s61, 38912
    s_add_u32 s42, s56, 36864
    buffer_load_dwordx4 v10, s[8:11], s42 offen lds
    ds_read_b128 v[180:183], v22 offset:38912
    s_add_u32 m0, s61, 39936
    s_add_u32 s42, s56, 55296
    buffer_load_dwordx4 v11, s[8:11], s42 offen lds
    s_mul_i32 s55, s39, 221184
    s_add_u32 m0, s62, 55296
    s_nop 0
    buffer_load_dwordx4 v12, s[12:15], s55 offen lds
    ds_read_b128 v[184:187], v23 offset:36864
    s_add_u32 m0, s62, 56320
    s_nop 0
    buffer_load_dwordx4 v13, s[12:15], s55 offen lds
    s_mul_i32 s57, s39, s59
    s_add_u32 m0, s60, 36864
    s_add_u32 s57, s57, s58
    buffer_load_dwordx4 v14, s[32:35], s57 offen lds
    s_add_u32 s39, s39, 1
    s_cmp_eq_u32 s39, 9
    s_cselect_b32 s39, 0, s39
    ds_read_b128 v[188:191], v23 offset:38912
    s_add_u32 s65, s55, 110592
    s_add_u32 m0, s62, 64512
    s_nop 0
    buffer_load_dwordx4 v12, s[12:15], s65 offen lds
    s_add_u32 m0, s62, 65536
    s_nop 0
    buffer_load_dwordx4 v13, s[12:15], s65 offen lds
    s_waitcnt lgkmcnt(0)
    s_waitcnt vmcnt(9)
    s_barrier
    s_lshl_b32 s56, s39, 7
    s_add_u32 s56, s56, s54
    s_add_u32 m0, s61, 73728
    s_nop 0
    buffer_load_dwordx4 v10, s[8:11], s56 offen lds
    ds_read_b128 v[192:195], v20 offset:0
    s_add_u32 m0, s61, 74752
    s_add_u32 s42, s56, 18432
    buffer_load_dwordx4 v11, s[8:11], s42 offen lds
    s_add_u32 m0, s61, 75776
    s_add_u32 s42, s56, 36864
    buffer_load_dwordx4 v10, s[8:11], s42 offen lds
    ds_read_b128 v[196:199], v20 offset:2048
    s_add_u32 m0, s61, 76800
    s_add_u32 s42, s56, 55296
    buffer_load_dwordx4 v11, s[8:11], s42 offen lds
    s_mul_i32 s55, s39, 221184
    s_add_u32 m0, s62, 92160
    s_nop 0
    buffer_load_dwordx4 v12, s[12:15], s55 offen lds
    ds_read_b128 v[200:203], v21 offset:0
    s_add_u32 m0, s62, 93184
    s_nop 0
    buffer_load_dwordx4 v13, s[12:15], s55 offen lds
    s_mul_i32 s57, s39, s59
    s_add_u32 m0, s60, 73728
    s_add_u32 s57, s57, s58
    buffer_load_dwordx4 v14, s[32:35], s57 offen lds
    s_add_u32 s39, s39, 1
    s_cmp_eq_u32 s39, 9
    s_cselect_b32 s39, 0, s39
    ds_read_b128 v[204:207], v21 offset:2048
    s_add_u32 s65, s55, 110592
    s_add_u32 m0, s62, 101376
    s_nop 0
    buffer_load_dwordx4 v12, s[12:15], s65 offen lds
    s_add_u32 m0, s62, 102400
    s_nop 0
    buffer_load_dwordx4 v13, s[12:15], s65 offen lds
    s_waitcnt lgkmcnt(0)
    s_waitcnt vmcnt(9)
    s_barrier
    s_lshl_b32 s56, s39, 7
    s_add_u32 s56, s56, s54
    s_add_u32 m0, s61, 110592
    s_nop 0
    buffer_load_dwordx4 v10, s[8:11], s56 offen lds
    ds_read_b128 v[208:211], v20 offset:36864
    s_add_u32 m0, s61, 111616
    s_add_u32 s42, s56, 18432
    buffer_load_dwordx4 v11, s[8:11], s42 offen lds
    s_add_u32 m0, s61, 112640
    s_add_u32 s42, s56, 36864
    buffer_load_dwordx4 v10, s[8:11], s42 offen lds
    ds_read_b128 v[212:215], v20 offset:38912
    s_add_u32 m0, s61, 113664
    s_add_u32 s42, s56, 55296
    buffer_load_dwordx4 v11, s[8:11], s42 offen lds
    s_mul_i32 s55, s39, 221184
    s_add_u32 m0, s62, 129024
    s_nop 0
    buffer_load_dwordx4 v12, s[12:15], s55 offen lds
    ds_read_b128 v[216:219], v21 offset:36864
    s_add_u32 m0, s62, 130048
    s_nop 0
    buffer_load_dwordx4 v13, s[12:15], s55 offen lds
    s_mul_i32 s57, s39, s59
    s_add_u32 m0, s60, 110592
    s_add_u32 s57, s57, s58
    buffer_load_dwordx4 v14, s[32:35], s57 offen lds
    s_add_u32 s39, s39, 1
    s_cmp_eq_u32 s39, 9
    s_cselect_b32 s39, 0, s39
    ds_read_b128 v[220:223], v21 offset:38912
    s_add_u32 s65, s55, 110592
    s_add_u32 m0, s62, 138240
    s_nop 0
    buffer_load_dwordx4 v12, s[12:15], s65 offen lds
    s_add_u32 m0, s62, 139264
    s_nop 0
    buffer_load_dwordx4 v13, s[12:15], s65 offen lds
    s_waitcnt lgkmcnt(0)
    s_waitcnt vmcnt(9)
    s_barrier
    buffer_load_dword v12, off, s[28:31], 0 sc1
    ds_read_b128 v[224:227], v22 offset:0
    ds_read_b128 v[228:231], v22 offset:2048
    ds_read_b128 v[232:235], v23 offset:0
    ds_read_b128 v[236:239], v23 offset:2048
    s_lshl_b32 s42, s37, 2
    s_add_u32 s42, s42, s41
    s_add_u32 s42, s42, 64
    s_mul_i32 s54, s42, 36864
    s_lshl_b32 s71, s42, 7
    s_add_u32 s71, s71, 6291456
    s_lshl_b32 s56, s38, 11
    s_add_u32 s56, s56, s54
    s_lshl_b32 s57, s38, 8
    s_add_u32 s57, s57, s54
    s_add_u32 s57, s57, 16384
    s_mov_b32 s76, 92160
    s_mov_b32 s77, 0
    v_lshlrev_b32 v10, 4, v0
    v_and_b32 v1, 15, v0
    v_lshrrev_b32 v2, 4, v0
    v_lshlrev_b32 v3, 4, v1
    v_lshl_add_u32 v11, v2, 2, v3
    s_waitcnt lgkmcnt(0)
    s_waitcnt vmcnt(3)
    s_barrier
    ds_read_b128 v[240:243], v22 offset:36864
    ds_read_b128 v[244:247], v22 offset:38912
    ds_read_b128 v[248:251], v23 offset:36864
    ds_read_b128 v[252:255], v23 offset:38912
    s_lshr_b32 s42, s41, 1
    s_add_u32 s42, s42, s63
    s_add_u32 s42, s42, 0
    s_cmp_ge_u32 s42, 9
    s_cselect_b32 s43, 9, 0
    s_sub_u32 s42, s42, s43
    s_lshl_b32 s42, s42, 1
    s_and_b32 s43, s41, 1
    s_add_u32 s42, s42, s43
    s_mul_i32 s55, s42, 110592
    s_mul_i32 s43, s41, 5120
    s_add_u32 m0, s43, 0
    s_nop 0
    buffer_load_dwordx4 v15, s[12:15], s55 offen lds
    s_add_u32 m0, s43, 1024
    s_nop 0
    buffer_load_dwordx4 v16, s[12:15], s55 offen lds
    s_add_u32 m0, s43, 2048
    s_nop 0
    buffer_load_dwordx4 v17, s[12:15], s55 offen lds
    s_add_u32 m0, s43, 3072
    s_nop 0
    buffer_load_dwordx4 v18, s[12:15], s55 offen lds
    s_add_u32 m0, s43, 4096
    s_nop 0
    buffer_load_dwordx4 v19, s[12:15], s55 offen lds
    s_waitcnt vmcnt(6)
    s_barrier
    s_waitcnt lgkmcnt(0)
    s_waitcnt vmcnt(5)
    v_readfirstlane_b32 s42, v12
    s_cmp_ge_u32 s42, 34
    s_cbranch_scc1 L_rdy_b
    s_mov_b32 s66, 0
    L_rsp_b:
    buffer_load_dword v12, off, s[28:31], 0 sc1
    s_add_u32 s66, s66, 1
    s_waitcnt vmcnt(0)
    v_readfirstlane_b32 s42, v12
    s_cmp_ge_u32 s66, 1000000
    s_cbranch_scc1 L_rdy_b
    s_cmp_ge_u32 s42, 34
    s_cbranch_scc0 L_rsp_b
    L_rdy_b:
    s_barrier
    s_setprio 1
    s_lshr_b32 s42, s41, 1
    s_add_u32 s42, s42, s63
    s_add_u32 s42, s42, 2
    s_cmp_ge_u32 s42, 9
    s_cselect_b32 s43, 9, 0
    s_sub_u32 s42, s42, s43
    s_lshl_b32 s42, s42, 1
    s_and_b32 s43, s41, 1
    s_add_u32 s42, s42, s43
    s_mul_i32 s55, s42, 110592
    s_mul_i32 s43, s41, 5120
    s_add_u32 m0, s43, 20480
    s_nop 0
    buffer_load_dwordx4 v15, s[12:15], s55 offen lds
    s_add_u32 m0, s43, 21504
    s_nop 0
    buffer_load_dwordx4 v16, s[12:15], s55 offen lds
    s_add_u32 m0, s43, 22528
    s_nop 0
    buffer_load_dwordx4 v17, s[12:15], s55 offen lds
    s_add_u32 m0, s43, 23552
    s_nop 0
    buffer_load_dwordx4 v18, s[12:15], s55 offen lds
    s_add_u32 m0, s43, 24576
    s_nop 0
    buffer_load_dwordx4 v19, s[12:15], s55 offen lds
    s_lshr_b32 s42, s41, 1
    s_add_u32 s42, s42, s63
    s_add_u32 s42, s42, 8
    s_cmp_ge_u32 s42, 9
    s_cselect_b32 s43, 9, 0
    s_sub_u32 s42, s42, s43
    s_lshl_b32 s42, s42, 1
    s_and_b32 s43, s41, 1
    s_add_u32 s42, s42, s43
    s_mul_i32 s55, s42, 110592
    s_mul_i32 s43, s41, 5120
    s_cmp_lt_u32 s41, 2
    s_cbranch_scc0 L_nq4
    s_add_u32 m0, s43, 81920
    s_nop 0
    buffer_load_dwordx4 v15, s[12:15], s55 offen lds
    s_add_u32 m0, s43, 82944
    s_nop 0
    buffer_load_dwordx4 v16, s[12:15], s55 offen lds
    s_add_u32 m0, s43, 83968
    s_nop 0
    buffer_load_dwordx4 v17, s[12:15], s55 offen lds
    s_add_u32 m0, s43, 84992
    s_nop 0
    buffer_load_dwordx4 v18, s[12:15], s55 offen lds
    s_add_u32 m0, s43, 86016
    s_nop 0
    buffer_load_dwordx4 v19, s[12:15], s55 offen lds
L_nq4:
    s_lshr_b32 s42, s41, 1
    s_add_u32 s42, s42, s63
    s_add_u32 s42, s42, 4
    s_cmp_ge_u32 s42, 9
    s_cselect_b32 s43, 9, 0
    s_sub_u32 s42, s42, s43
    s_lshl_b32 s42, s42, 1
    s_and_b32 s43, s41, 1
    s_add_u32 s42, s42, s43
    s_mul_i32 s55, s42, 110592
    s_mul_i32 s43, s41, 5120
    s_add_u32 m0, s43, 40960
    s_nop 0
    buffer_load_dwordx4 v15, s[12:15], s55 offen lds
    s_add_u32 m0, s43, 41984
    s_nop 0
    buffer_load_dwordx4 v16, s[12:15], s55 offen lds
    s_add_u32 m0, s43, 43008
    s_nop 0
    buffer_load_dwordx4 v17, s[12:15], s55 offen lds
    s_add_u32 m0, s43, 44032
    s_nop 0
    buffer_load_dwordx4 v18, s[12:15], s55 offen lds
    s_add_u32 m0, s43, 45056
    s_nop 0
    buffer_load_dwordx4 v19, s[12:15], s55 offen lds
    s_lshr_b32 s42, s41, 1
    s_add_u32 s42, s42, s63
    s_add_u32 s42, s42, 6
    s_cmp_ge_u32 s42, 9
    s_cselect_b32 s43, 9, 0
    s_sub_u32 s42, s42, s43
    s_lshl_b32 s42, s42, 1
    s_and_b32 s43, s41, 1
    s_add_u32 s42, s42, s43
    s_mul_i32 s55, s42, 110592
    s_mul_i32 s43, s41, 5120
    s_add_u32 m0, s43, 61440
    s_nop 0
    buffer_load_dwordx4 v15, s[12:15], s55 offen lds
    s_add_u32 m0, s43, 62464
    s_nop 0
    buffer_load_dwordx4 v16, s[12:15], s55 offen lds
    s_add_u32 m0, s43, 63488
    s_nop 0
    buffer_load_dwordx4 v17, s[12:15], s55 offen lds
    s_add_u32 m0, s43, 64512
    s_nop 0
    buffer_load_dwordx4 v18, s[12:15], s55 offen lds
    s_add_u32 m0, s43, 65536
    s_nop 0
    buffer_load_dwordx4 v19, s[12:15], s55 offen lds
    v_mul_u32_u24 v2, 52, v0
    v_lshrrev_b32 v2, 8, v2
    v_mul_u32_u24 v3, 5, v2
    v_sub_u32 v3, v0, v3
    s_lshr_b32 s42, s2, 3
    s_mul_i32 s42, s42, 18
    s_mul_i32 s43, s41, 5
    s_add_u32 s42, s42, s43
    v_add_u32 v2, s42, v2
    v_mul_u32_u24 v2, 1152, v2
    v_lshl_add_u32 v2, v3, 7, v2
    s_lshr_b32 s42, s38, 2
    s_lshl_b32 s42, s42, 9
    s_mov_b64 exec, 0x1ffffff
    buffer_load_dword v4, v2, s[16:19], s42 offen
    s_mov_b64 exec, -1
    s_waitcnt vmcnt(16)
    ds_add_u32 v31, v9 offset:0
    s_mov_b32 s78, 0
    s_branch L_s0_hold
L_sp_hold:
    s_sleep 3
L_s0_hold:
    ds_read_b32 v1, v31 offset:48
    s_add_u32 s78, s78, 0x100
    s_cbranch_scc1 L_ok_hold
    s_waitcnt lgkmcnt(0)
    v_readfirstlane_b32 s42, v1
    s_cmp_ge_u32 s42, 4
    s_cbranch_scc0 L_sp_hold
    L_ok_hold:
    s_mov_b32 s78, 0
L_sp_q00:
    ds_read_b32 v1, v31 offset:0
    s_add_u32 s78, s78, 0x100
    s_cbranch_scc1 L_ok_q00
    s_waitcnt lgkmcnt(0)
    v_readfirstlane_b32 s42, v1
    s_cmp_ge_u32 s42, 4
    s_cbranch_scc0 L_sp_q00
    L_ok_q00:
    ds_read_b64_tr_b16 v[72:73], v29 offset:0
    ds_read_b64_tr_b16 v[74:75], v29 offset:1280
    ds_read_b64_tr_b16 v[76:77], v29 offset:32
    ds_read_b64_tr_b16 v[78:79], v29 offset:1312
    ds_read_b64_tr_b16 v[80:81], v29 offset:64
    ds_read_b64_tr_b16 v[82:83], v29 offset:1344
    ds_read_b64_tr_b16 v[84:85], v29 offset:96
    ds_read_b64_tr_b16 v[86:87], v29 offset:1376
    ds_read_b64_tr_b16 v[88:89], v29 offset:128
    s_waitcnt lgkmcnt(7)
    v_mfma_f32_16x16x32_bf16 v[32:35], v[72:75], v[112:115], v[108:111]
    ds_read_b64_tr_b16 v[90:91], v29 offset:1408
    v_mfma_f32_16x16x32_bf16 v[52:55], v[72:75], v[116:119], v[108:111]
    ds_read_b64_tr_b16 v[72:73], v29 offset:5120
    s_waitcnt lgkmcnt(7)
    v_mfma_f32_16x16x32_bf16 v[36:39], v[76:79], v[112:115], v[108:111]
    ds_read_b64_tr_b16 v[74:75], v29 offset:6400
    v_mfma_f32_16x16x32_bf16 v[56:59], v[76:79], v[116:119], v[108:111]
    ds_read_b64_tr_b16 v[76:77], v29 offset:5152
    s_waitcnt lgkmcnt(7)
    v_mfma_f32_16x16x32_bf16 v[40:43], v[80:83], v[112:115], v[108:111]
    ds_read_b64_tr_b16 v[78:79], v29 offset:6432
    v_mfma_f32_16x16x32_bf16 v[60:63], v[80:83], v[116:119], v[108:111]
    ds_read_b64_tr_b16 v[80:81], v29 offset:5184
    s_waitcnt lgkmcnt(7)
    v_mfma_f32_16x16x32_bf16 v[44:47], v[84:87], v[112:115], v[108:111]
    ds_read_b64_tr_b16 v[82:83], v29 offset:6464
    v_mfma_f32_16x16x32_bf16 v[64:67], v[84:87], v[116:119], v[108:111]
    ds_read_b64_tr_b16 v[84:85], v29 offset:5216
    s_waitcnt lgkmcnt(7)
    v_mfma_f32_16x16x32_bf16 v[48:51], v[88:91], v[112:115], v[108:111]
    ds_read_b64_tr_b16 v[86:87], v29 offset:6496
    v_mfma_f32_16x16x32_bf16 v[68:71], v[88:91], v[116:119], v[108:111]
    ds_read_b64_tr_b16 v[88:89], v29 offset:5248
    s_waitcnt lgkmcnt(7)
    v_mfma_f32_16x16x32_bf16 v[32:35], v[72:75], v[120:123], v[32:35]
    ds_read_b64_tr_b16 v[90:91], v29 offset:6528
    s_waitcnt vmcnt(11)
    v_mfma_f32_16x16x32_bf16 v[52:55], v[72:75], v[124:127], v[52:55]
    ds_read_b64_tr_b16 v[72:73], v29 offset:10240
    s_waitcnt lgkmcnt(7)
    v_mfma_f32_16x16x32_bf16 v[36:39], v[76:79], v[120:123], v[36:39]
    ds_read_b64_tr_b16 v[74:75], v29 offset:11520
    ds_add_u32 v31, v9 offset:4
    v_mfma_f32_16x16x32_bf16 v[56:59], v[76:79], v[124:127], v[56:59]
    ds_read_b64_tr_b16 v[76:77], v29 offset:10272
    s_waitcnt lgkmcnt(7)
    v_mfma_f32_16x16x32_bf16 v[40:43], v[80:83], v[120:123], v[40:43]
    ds_read_b64_tr_b16 v[78:79], v29 offset:11552
    v_mfma_f32_16x16x32_bf16 v[60:63], v[80:83], v[124:127], v[60:63]
    ds_read_b64_tr_b16 v[80:81], v29 offset:10304
    s_waitcnt lgkmcnt(7)
    v_mfma_f32_16x16x32_bf16 v[44:47], v[84:87], v[120:123], v[44:47]
    ds_read_b64_tr_b16 v[82:83], v29 offset:11584
    ds_read_b32 v1, v31 offset:4
    v_mfma_f32_16x16x32_bf16 v[64:67], v[84:87], v[124:127], v[64:67]
    ds_read_b64_tr_b16 v[84:85], v29 offset:10336
    s_waitcnt lgkmcnt(8)
    v_mfma_f32_16x16x32_bf16 v[48:51], v[88:91], v[120:123], v[48:51]
    ds_read_b64_tr_b16 v[86:87], v29 offset:11616
    v_mfma_f32_16x16x32_bf16 v[68:71], v[88:91], v[124:127], v[68:71]
    ds_read_b64_tr_b16 v[88:89], v29 offset:10368
    s_waitcnt lgkmcnt(8)
    v_mfma_f32_16x16x32_bf16 v[32:35], v[72:75], v[128:131], v[32:35]
    ds_read_b64_tr_b16 v[90:91], v29 offset:11648
    v_mfma_f32_16x16x32_bf16 v[52:55], v[72:75], v[132:135], v[52:55]
    ds_read_b64_tr_b16 v[72:73], v29 offset:15360
    s_waitcnt lgkmcnt(8)
    v_mfma_f32_16x16x32_bf16 v[36:39], v[76:79], v[128:131], v[36:39]
    ds_read_b64_tr_b16 v[74:75], v29 offset:16640
    v_mfma_f32_16x16x32_bf16 v[56:59], v[76:79], v[132:135], v[56:59]
    ds_read_b64_tr_b16 v[76:77], v29 offset:15392
    s_waitcnt lgkmcnt(8)
    v_mfma_f32_16x16x32_bf16 v[40:43], v[80:83], v[128:131], v[40:43]
    ds_read_b64_tr_b16 v[78:79], v29 offset:16672
    v_mfma_f32_16x16x32_bf16 v[60:63], v[80:83], v[132:135], v[60:63]
    ds_read_b64_tr_b16 v[80:81], v29 offset:15424
    s_waitcnt lgkmcnt(7)
    v_mfma_f32_16x16x32_bf16 v[44:47], v[84:87], v[128:131], v[44:47]
    ds_read_b64_tr_b16 v[82:83], v29 offset:16704
    v_readfirstlane_b32 s70, v1
    v_mfma_f32_16x16x32_bf16 v[64:67], v[84:87], v[132:135], v[64:67]
    ds_read_b64_tr_b16 v[84:85], v29 offset:15456
    s_waitcnt lgkmcnt(7)
    v_mfma_f32_16x16x32_bf16 v[48:51], v[88:91], v[128:131], v[48:51]
    ds_read_b64_tr_b16 v[86:87], v29 offset:16736
    s_cmp_ge_u32 s70, 4
    v_mfma_f32_16x16x32_bf16 v[68:71], v[88:91], v[132:135], v[68:71]
    ds_read_b64_tr_b16 v[88:89], v29 offset:15488
    s_waitcnt lgkmcnt(7)
    v_mfma_f32_16x16x32_bf16 v[32:35], v[72:75], v[136:139], v[32:35]
    ds_read_b64_tr_b16 v[90:91], v29 offset:16768
    s_cbranch_scc1 L_ok_q0
    s_mov_b32 s78, 0
L_sp_q0:
    ds_read_b32 v1, v31 offset:4
    s_add_u32 s78, s78, 0x100
    s_cbranch_scc1 L_ok_q0
    s_waitcnt lgkmcnt(0)
    v_readfirstlane_b32 s42, v1
    s_cmp_ge_u32 s42, 4
    s_cbranch_scc0 L_sp_q0
    L_ok_q0:
    v_mfma_f32_16x16x32_bf16 v[52:55], v[72:75], v[140:143], v[52:55]
    ds_read_b64_tr_b16 v[72:73], v29 offset:20480
    s_waitcnt lgkmcnt(7)
    v_mfma_f32_16x16x32_bf16 v[36:39], v[76:79], v[136:139], v[36:39]
    ds_read_b64_tr_b16 v[74:75], v29 offset:21760
    v_mfma_f32_16x16x32_bf16 v[56:59], v[76:79], v[140:143], v[56:59]
    ds_read_b64_tr_b16 v[76:77], v29 offset:20512
    s_waitcnt lgkmcnt(7)
    v_mfma_f32_16x16x32_bf16 v[40:43], v[80:83], v[136:139], v[40:43]
    ds_read_b64_tr_b16 v[78:79], v29 offset:21792
    v_mfma_f32_16x16x32_bf16 v[60:63], v[80:83], v[140:143], v[60:63]
    ds_read_b64_tr_b16 v[80:81], v29 offset:20544
    s_waitcnt lgkmcnt(7)
    v_mfma_f32_16x16x32_bf16 v[44:47], v[84:87], v[136:139], v[44:47]
    ds_read_b64_tr_b16 v[82:83], v29 offset:21824
    v_mfma_f32_16x16x32_bf16 v[64:67], v[84:87], v[140:143], v[64:67]
    ds_read_b64_tr_b16 v[84:85], v29 offset:20576
    s_waitcnt lgkmcnt(7)
    v_mfma_f32_16x16x32_bf16 v[48:51], v[88:91], v[136:139], v[48:51]
    ds_read_b64_tr_b16 v[86:87], v29 offset:21856
    v_mfma_f32_16x16x32_bf16 v[68:71], v[88:91], v[140:143], v[68:71]
    ds_read_b64_tr_b16 v[88:89], v29 offset:20608
    s_waitcnt lgkmcnt(7)
    v_mfma_f32_16x16x32_bf16 v[32:35], v[72:75], v[144:147], v[32:35]
    ds_read_b64_tr_b16 v[90:91], v29 offset:21888
    v_mfma_f32_16x16x32_bf16 v[52:55], v[72:75], v[148:151], v[52:55]
    ds_read_b64_tr_b16 v[72:73], v29 offset:25600
    s_waitcnt lgkmcnt(7)
    v_mfma_f32_16x16x32_bf16 v[36:39], v[76:79], v[144:147], v[36:39]
    ds_read_b64_tr_b16 v[74:75], v29 offset:26880
    v_mfma_f32_16x16x32_bf16 v[56:59], v[76:79], v[148:151], v[56:59]
    ds_read_b64_tr_b16 v[76:77], v29 offset:25632
    s_waitcnt lgkmcnt(7)
    v_mfma_f32_16x16x32_bf16 v[40:43], v[80:83], v[144:147], v[40:43]
    ds_read_b64_tr_b16 v[78:79], v29 offset:26912
    v_mfma_f32_16x16x32_bf16 v[60:63], v[80:83], v[148:151], v[60:63]
    ds_read_b64_tr_b16 v[80:81], v29 offset:25664
    s_waitcnt lgkmcnt(7)
    v_mfma_f32_16x16x32_bf16 v[44:47], v[84:87], v[144:147], v[44:47]
    ds_read_b64_tr_b16 v[82:83], v29 offset:26944
    v_mfma_f32_16x16x32_bf16 v[64:67], v[84:87], v[148:151], v[64:67]
    ds_read_b64_tr_b16 v[84:85], v29 offset:25696
    s_waitcnt lgkmcnt(7)
    v_mfma_f32_16x16x32_bf16 v[48:51], v[88:91], v[144:147], v[48:51]
    ds_read_b64_tr_b16 v[86:87], v29 offset:26976
    v_mfma_f32_16x16x32_bf16 v[68:71], v[88:91], v[148:151], v[68:71]
    ds_read_b64_tr_b16 v[88:89], v29 offset:25728
    s_waitcnt lgkmcnt(7)
    v_mfma_f32_16x16x32_bf16 v[32:35], v[72:75], v[152:155], v[32:35]
    ds_read_b64_tr_b16 v[90:91], v29 offset:27008
    s_waitcnt vmcnt(6)
    v_mfma_f32_16x16x32_bf16 v[52:55], v[72:75], v[156:159], v[52:55]
    ds_read_b64_tr_b16 v[72:73], v29 offset:30720
    s_waitcnt lgkmcnt(7)
    v_mfma_f32_16x16x32_bf16 v[36:39], v[76:79], v[152:155], v[36:39]
    ds_read_b64_tr_b16 v[74:75], v29 offset:32000
    ds_add_u32 v31, v9 offset:8
    v_mfma_f32_16x16x32_bf16 v[56:59], v[76:79], v[156:159], v[56:59]
    ds_read_b64_tr_b16 v[76:77], v29 offset:30752
    s_waitcnt lgkmcnt(7)
    v_mfma_f32_16x16x32_bf16 v[40:43], v[80:83], v[152:155], v[40:43]
    ds_read_b64_tr_b16 v[78:79], v29 offset:32032
    v_mfma_f32_16x16x32_bf16 v[60:63], v[80:83], v[156:159], v[60:63]
    ds_read_b64_tr_b16 v[80:81], v29 offset:30784
    s_waitcnt lgkmcnt(7)
    v_mfma_f32_16x16x32_bf16 v[44:47], v[84:87], v[152:155], v[44:47]
    ds_read_b64_tr_b16 v[82:83], v29 offset:32064
    ds_read_b32 v1, v31 offset:8
    v_mfma_f32_16x16x32_bf16 v[64:67], v[84:87], v[156:159], v[64:67]
    ds_read_b64_tr_b16 v[84:85], v29 offset:30816
    s_waitcnt lgkmcnt(8)
    v_mfma_f32_16x16x32_bf16 v[48:51], v[88:91], v[152:155], v[48:51]
    ds_read_b64_tr_b16 v[86:87], v29 offset:32096
    v_mfma_f32_16x16x32_bf16 v[68:71], v[88:91], v[156:159], v[68:71]
    ds_read_b64_tr_b16 v[88:89], v29 offset:30848
    s_waitcnt lgkmcnt(8)
    v_mfma_f32_16x16x32_bf16 v[32:35], v[72:75], v[160:163], v[32:35]
    ds_read_b64_tr_b16 v[90:91], v29 offset:32128
    v_mfma_f32_16x16x32_bf16 v[52:55], v[72:75], v[164:167], v[52:55]
    ds_read_b64_tr_b16 v[72:73], v29 offset:35840
    s_waitcnt lgkmcnt(8)
    v_mfma_f32_16x16x32_bf16 v[36:39], v[76:79], v[160:163], v[36:39]
    ds_read_b64_tr_b16 v[74:75], v29 offset:37120
    v_mfma_f32_16x16x32_bf16 v[56:59], v[76:79], v[164:167], v[56:59]
    ds_read_b64_tr_b16 v[76:77], v29 offset:35872
    s_waitcnt lgkmcnt(8)
    v_mfma_f32_16x16x32_bf16 v[40:43], v[80:83], v[160:163], v[40:43]
    ds_read_b64_tr_b16 v[78:79], v29 offset:37152
    v_mfma_f32_16x16x32_bf16 v[60:63], v[80:83], v[164:167], v[60:63]
    ds_read_b64_tr_b16 v[80:81], v29 offset:35904
    s_waitcnt lgkmcnt(7)
    v_mfma_f32_16x16x32_bf16 v[44:47], v[84:87], v[160:163], v[44:47]
    ds_read_b64_tr_b16 v[82:83], v29 offset:37184
    v_readfirstlane_b32 s70, v1
    v_mfma_f32_16x16x32_bf16 v[64:67], v[84:87], v[164:167], v[64:67]
    ds_read_b64_tr_b16 v[84:85], v29 offset:35936
    s_waitcnt lgkmcnt(7)
    v_mfma_f32_16x16x32_bf16 v[48:51], v[88:91], v[160:163], v[48:51]
    ds_read_b64_tr_b16 v[86:87], v29 offset:37216
    s_cmp_ge_u32 s70, 4
    v_mfma_f32_16x16x32_bf16 v[68:71], v[88:91], v[164:167], v[68:71]
    ds_read_b64_tr_b16 v[88:89], v29 offset:35968
    s_waitcnt lgkmcnt(7)
    v_mfma_f32_16x16x32_bf16 v[32:35], v[72:75], v[168:171], v[32:35]
    ds_read_b64_tr_b16 v[90:91], v29 offset:37248
    s_cbranch_scc1 L_ok_q1
    s_mov_b32 s78, 0
L_sp_q1:
    ds_read_b32 v1, v31 offset:8
    s_add_u32 s78, s78, 0x100
    s_cbranch_scc1 L_ok_q1
    s_waitcnt lgkmcnt(0)
    v_readfirstlane_b32 s42, v1
    s_cmp_ge_u32 s42, 4
    s_cbranch_scc0 L_sp_q1
    L_ok_q1:
    v_mfma_f32_16x16x32_bf16 v[52:55], v[72:75], v[172:175], v[52:55]
    ds_read_b64_tr_b16 v[72:73], v29 offset:40960
    s_waitcnt lgkmcnt(7)
    v_mfma_f32_16x16x32_bf16 v[36:39], v[76:79], v[168:171], v[36:39]
    ds_read_b64_tr_b16 v[74:75], v29 offset:42240
    v_mfma_f32_16x16x32_bf16 v[56:59], v[76:79], v[172:175], v[56:59]
    ds_read_b64_tr_b16 v[76:77], v29 offset:40992
    s_waitcnt lgkmcnt(7)
    v_mfma_f32_16x16x32_bf16 v[40:43], v[80:83], v[168:171], v[40:43]
    ds_read_b64_tr_b16 v[78:79], v29 offset:42272
    v_mfma_f32_16x16x32_bf16 v[60:63], v[80:83], v[172:175], v[60:63]
    ds_read_b64_tr_b16 v[80:81], v29 offset:41024
    s_waitcnt lgkmcnt(7)
    v_mfma_f32_16x16x32_bf16 v[44:47], v[84:87], v[168:171], v[44:47]
    ds_read_b64_tr_b16 v[82:83], v29 offset:42304
    v_mfma_f32_16x16x32_bf16 v[64:67], v[84:87], v[172:175], v[64:67]
    ds_read_b64_tr_b16 v[84:85], v29 offset:41056
    s_waitcnt lgkmcnt(7)
    v_mfma_f32_16x16x32_bf16 v[48:51], v[88:91], v[168:171], v[48:51]
    ds_read_b64_tr_b16 v[86:87], v29 offset:42336
    v_mfma_f32_16x16x32_bf16 v[68:71], v[88:91], v[172:175], v[68:71]
    ds_read_b64_tr_b16 v[88:89], v29 offset:41088
    s_waitcnt lgkmcnt(7)
    v_mfma_f32_16x16x32_bf16 v[32:35], v[72:75], v[176:179], v[32:35]
    ds_read_b64_tr_b16 v[90:91], v29 offset:42368
    ds_add_u32 v31, v9 offset:20
    v_mfma_f32_16x16x32_bf16 v[52:55], v[72:75], v[180:183], v[52:55]
    ds_read_b64_tr_b16 v[72:73], v30 offset:0
    s_waitcnt lgkmcnt(7)
    v_mfma_f32_16x16x32_bf16 v[36:39], v[76:79], v[176:179], v[36:39]
    ds_read_b64_tr_b16 v[74:75], v30 offset:1280
    v_mfma_f32_16x16x32_bf16 v[56:59], v[76:79], v[180:183], v[56:59]
    ds_read_b64_tr_b16 v[76:77], v30 offset:32
    s_waitcnt lgkmcnt(7)
    v_mfma_f32_16x16x32_bf16 v[40:43], v[80:83], v[176:179], v[40:43]
    ds_read_b64_tr_b16 v[78:79], v30 offset:1312
    v_mfma_f32_16x16x32_bf16 v[60:63], v[80:83], v[180:183], v[60:63]
    ds_read_b64_tr_b16 v[80:81], v30 offset:64
    s_waitcnt lgkmcnt(7)
    v_mfma_f32_16x16x32_bf16 v[44:47], v[84:87], v[176:179], v[44:47]
    ds_read_b64_tr_b16 v[82:83], v30 offset:1344
    v_mfma_f32_16x16x32_bf16 v[64:67], v[84:87], v[180:183], v[64:67]
    ds_read_b64_tr_b16 v[84:85], v30 offset:96
    s_waitcnt lgkmcnt(7)
    v_mfma_f32_16x16x32_bf16 v[48:51], v[88:91], v[176:179], v[48:51]
    ds_read_b64_tr_b16 v[86:87], v30 offset:1376
    v_mfma_f32_16x16x32_bf16 v[68:71], v[88:91], v[180:183], v[68:71]
    ds_read_b64_tr_b16 v[88:89], v30 offset:128
    s_waitcnt lgkmcnt(7)
    v_mfma_f32_16x16x32_bf16 v[32:35], v[72:75], v[184:187], v[32:35]
    ds_read_b64_tr_b16 v[90:91], v30 offset:1408
    s_waitcnt vmcnt(1)
    v_mfma_f32_16x16x32_bf16 v[52:55], v[72:75], v[188:191], v[52:55]
    ds_read_b64_tr_b16 v[72:73], v30 offset:5120
    s_waitcnt lgkmcnt(7)
    v_mfma_f32_16x16x32_bf16 v[36:39], v[76:79], v[184:187], v[36:39]
    ds_read_b64_tr_b16 v[74:75], v30 offset:6400
    ds_add_u32 v31, v9 offset:12
    v_mfma_f32_16x16x32_bf16 v[56:59], v[76:79], v[188:191], v[56:59]
    ds_read_b64_tr_b16 v[76:77], v30 offset:5152
    s_waitcnt lgkmcnt(7)
    v_mfma_f32_16x16x32_bf16 v[40:43], v[80:83], v[184:187], v[40:43]
    ds_read_b64_tr_b16 v[78:79], v30 offset:6432
    v_mfma_f32_16x16x32_bf16 v[60:63], v[80:83], v[188:191], v[60:63]
    ds_read_b64_tr_b16 v[80:81], v30 offset:5184
    s_waitcnt lgkmcnt(7)
    v_mfma_f32_16x16x32_bf16 v[44:47], v[84:87], v[184:187], v[44:47]
    ds_read_b64_tr_b16 v[82:83], v30 offset:6464
    ds_read_b32 v1, v31 offset:12
    v_mfma_f32_16x16x32_bf16 v[64:67], v[84:87], v[188:191], v[64:67]
    ds_read_b64_tr_b16 v[84:85], v30 offset:5216
    s_waitcnt lgkmcnt(8)
    v_mfma_f32_16x16x32_bf16 v[48:51], v[88:91], v[184:187], v[48:51]
    ds_read_b64_tr_b16 v[86:87], v30 offset:6496
    v_mfma_f32_16x16x32_bf16 v[68:71], v[88:91], v[188:191], v[68:71]
    ds_read_b64_tr_b16 v[88:89], v30 offset:5248
    s_waitcnt lgkmcnt(8)
    v_mfma_f32_16x16x32_bf16 v[32:35], v[72:75], v[192:195], v[32:35]
    ds_read_b64_tr_b16 v[90:91], v30 offset:6528
    ds_add_u32 v31, v9 offset:24
    v_mfma_f32_16x16x32_bf16 v[52:55], v[72:75], v[196:199], v[52:55]
    ds_read_b64_tr_b16 v[72:73], v30 offset:10240
    s_waitcnt lgkmcnt(8)
    v_mfma_f32_16x16x32_bf16 v[36:39], v[76:79], v[192:195], v[36:39]
    ds_read_b64_tr_b16 v[74:75], v30 offset:11520
    v_mfma_f32_16x16x32_bf16 v[56:59], v[76:79], v[196:199], v[56:59]
    ds_read_b64_tr_b16 v[76:77], v30 offset:10272
    s_waitcnt lgkmcnt(8)
    v_mfma_f32_16x16x32_bf16 v[40:43], v[80:83], v[192:195], v[40:43]
    ds_read_b64_tr_b16 v[78:79], v30 offset:11552
    v_mfma_f32_16x16x32_bf16 v[60:63], v[80:83], v[196:199], v[60:63]
    ds_read_b64_tr_b16 v[80:81], v30 offset:10304
    s_waitcnt lgkmcnt(7)
    v_mfma_f32_16x16x32_bf16 v[44:47], v[84:87], v[192:195], v[44:47]
    ds_read_b64_tr_b16 v[82:83], v30 offset:11584
    v_readfirstlane_b32 s70, v1
    v_mfma_f32_16x16x32_bf16 v[64:67], v[84:87], v[196:199], v[64:67]
    ds_read_b64_tr_b16 v[84:85], v30 offset:10336
    s_waitcnt lgkmcnt(7)
    v_mfma_f32_16x16x32_bf16 v[48:51], v[88:91], v[192:195], v[48:51]
    ds_read_b64_tr_b16 v[86:87], v30 offset:11616
    s_cmp_ge_u32 s70, 4
    v_mfma_f32_16x16x32_bf16 v[68:71], v[88:91], v[196:199], v[68:71]
    ds_read_b64_tr_b16 v[88:89], v30 offset:10368
    s_waitcnt lgkmcnt(7)
    v_mfma_f32_16x16x32_bf16 v[32:35], v[72:75], v[200:203], v[32:35]
    ds_read_b64_tr_b16 v[90:91], v30 offset:11648
    s_cbranch_scc1 L_ok_q2
    s_mov_b32 s78, 0
L_sp_q2:
    ds_read_b32 v1, v31 offset:12
    s_add_u32 s78, s78, 0x100
    s_cbranch_scc1 L_ok_q2
    s_waitcnt lgkmcnt(0)
    v_readfirstlane_b32 s42, v1
    s_cmp_ge_u32 s42, 4
    s_cbranch_scc0 L_sp_q2
    L_ok_q2:
    v_mfma_f32_16x16x32_bf16 v[52:55], v[72:75], v[204:207], v[52:55]
    ds_read_b64_tr_b16 v[72:73], v30 offset:15360
    s_waitcnt lgkmcnt(7)
    v_mfma_f32_16x16x32_bf16 v[36:39], v[76:79], v[200:203], v[36:39]
    ds_read_b64_tr_b16 v[74:75], v30 offset:16640
    v_mfma_f32_16x16x32_bf16 v[56:59], v[76:79], v[204:207], v[56:59]
    ds_read_b64_tr_b16 v[76:77], v30 offset:15392
    s_waitcnt lgkmcnt(7)
    v_mfma_f32_16x16x32_bf16 v[40:43], v[80:83], v[200:203], v[40:43]
    ds_read_b64_tr_b16 v[78:79], v30 offset:16672
    v_mfma_f32_16x16x32_bf16 v[60:63], v[80:83], v[204:207], v[60:63]
    ds_read_b64_tr_b16 v[80:81], v30 offset:15424
    s_waitcnt lgkmcnt(7)
    v_mfma_f32_16x16x32_bf16 v[44:47], v[84:87], v[200:203], v[44:47]
    ds_read_b64_tr_b16 v[82:83], v30 offset:16704
    v_mfma_f32_16x16x32_bf16 v[64:67], v[84:87], v[204:207], v[64:67]
    ds_read_b64_tr_b16 v[84:85], v30 offset:15456
    s_waitcnt lgkmcnt(7)
    v_mfma_f32_16x16x32_bf16 v[48:51], v[88:91], v[200:203], v[48:51]
    ds_read_b64_tr_b16 v[86:87], v30 offset:16736
    v_mfma_f32_16x16x32_bf16 v[68:71], v[88:91], v[204:207], v[68:71]
    ds_read_b64_tr_b16 v[88:89], v30 offset:15488
    s_waitcnt lgkmcnt(7)
    v_mfma_f32_16x16x32_bf16 v[32:35], v[72:75], v[208:211], v[32:35]
    ds_read_b64_tr_b16 v[90:91], v30 offset:16768
    v_mfma_f32_16x16x32_bf16 v[52:55], v[72:75], v[212:215], v[52:55]
    ds_read_b64_tr_b16 v[72:73], v30 offset:20480
    s_waitcnt lgkmcnt(7)
    v_mfma_f32_16x16x32_bf16 v[36:39], v[76:79], v[208:211], v[36:39]
    ds_read_b64_tr_b16 v[74:75], v30 offset:21760
    v_mfma_f32_16x16x32_bf16 v[56:59], v[76:79], v[212:215], v[56:59]
    ds_read_b64_tr_b16 v[76:77], v30 offset:20512
    s_waitcnt lgkmcnt(7)
    v_mfma_f32_16x16x32_bf16 v[40:43], v[80:83], v[208:211], v[40:43]
    ds_read_b64_tr_b16 v[78:79], v30 offset:21792
    v_mfma_f32_16x16x32_bf16 v[60:63], v[80:83], v[212:215], v[60:63]
    ds_read_b64_tr_b16 v[80:81], v30 offset:20544
    s_waitcnt lgkmcnt(7)
    v_mfma_f32_16x16x32_bf16 v[44:47], v[84:87], v[208:211], v[44:47]
    ds_read_b64_tr_b16 v[82:83], v30 offset:21824
    v_mfma_f32_16x16x32_bf16 v[64:67], v[84:87], v[212:215], v[64:67]
    ds_read_b64_tr_b16 v[84:85], v30 offset:20576
    s_waitcnt lgkmcnt(7)
    v_mfma_f32_16x16x32_bf16 v[48:51], v[88:91], v[208:211], v[48:51]
    ds_read_b64_tr_b16 v[86:87], v30 offset:21856
    v_mfma_f32_16x16x32_bf16 v[68:71], v[88:91], v[212:215], v[68:71]
    ds_read_b64_tr_b16 v[88:89], v30 offset:20608
    s_waitcnt lgkmcnt(7)
    v_mfma_f32_16x16x32_bf16 v[32:35], v[72:75], v[216:219], v[32:35]
    ds_read_b64_tr_b16 v[90:91], v30 offset:21888
    s_waitcnt vmcnt(11)
    v_mfma_f32_16x16x32_bf16 v[52:55], v[72:75], v[220:223], v[52:55]
    ds_read_b64_tr_b16 v[72:73], v30 offset:25600
    s_waitcnt lgkmcnt(7)
    v_mfma_f32_16x16x32_bf16 v[36:39], v[76:79], v[216:219], v[36:39]
    ds_read_b64_tr_b16 v[74:75], v30 offset:26880
    ds_add_u32 v31, v9 offset:16
    v_mfma_f32_16x16x32_bf16 v[56:59], v[76:79], v[220:223], v[56:59]
    ds_read_b64_tr_b16 v[76:77], v30 offset:25632
    s_waitcnt lgkmcnt(7)
    v_mfma_f32_16x16x32_bf16 v[40:43], v[80:83], v[216:219], v[40:43]
    ds_read_b64_tr_b16 v[78:79], v30 offset:26912
    v_mfma_f32_16x16x32_bf16 v[60:63], v[80:83], v[220:223], v[60:63]
    ds_read_b64_tr_b16 v[80:81], v30 offset:25664
    s_waitcnt lgkmcnt(7)
    v_mfma_f32_16x16x32_bf16 v[44:47], v[84:87], v[216:219], v[44:47]
    ds_read_b64_tr_b16 v[82:83], v30 offset:26944
    ds_read_b32 v1, v31 offset:16
    v_mfma_f32_16x16x32_bf16 v[64:67], v[84:87], v[220:223], v[64:67]
    ds_read_b64_tr_b16 v[84:85], v30 offset:25696
    s_waitcnt lgkmcnt(8)
    v_mfma_f32_16x16x32_bf16 v[48:51], v[88:91], v[216:219], v[48:51]
    ds_read_b64_tr_b16 v[86:87], v30 offset:26976
    v_mfma_f32_16x16x32_bf16 v[68:71], v[88:91], v[220:223], v[68:71]
    ds_read_b64_tr_b16 v[88:89], v30 offset:25728
    s_waitcnt lgkmcnt(8)
    v_mfma_f32_16x16x32_bf16 v[32:35], v[72:75], v[224:227], v[32:35]
    ds_read_b64_tr_b16 v[90:91], v30 offset:27008
    v_mfma_f32_16x16x32_bf16 v[52:55], v[72:75], v[228:231], v[52:55]
    ds_read_b64_tr_b16 v[72:73], v30 offset:30720
    s_waitcnt lgkmcnt(8)
    v_mfma_f32_16x16x32_bf16 v[36:39], v[76:79], v[224:227], v[36:39]
    ds_read_b64_tr_b16 v[74:75], v30 offset:32000
    v_mfma_f32_16x16x32_bf16 v[56:59], v[76:79], v[228:231], v[56:59]
    ds_read_b64_tr_b16 v[76:77], v30 offset:30752
    s_waitcnt lgkmcnt(8)
    v_mfma_f32_16x16x32_bf16 v[40:43], v[80:83], v[224:227], v[40:43]
    ds_read_b64_tr_b16 v[78:79], v30 offset:32032
    v_mfma_f32_16x16x32_bf16 v[60:63], v[80:83], v[228:231], v[60:63]
    ds_read_b64_tr_b16 v[80:81], v30 offset:30784
    s_waitcnt lgkmcnt(7)
    v_mfma_f32_16x16x32_bf16 v[44:47], v[84:87], v[224:227], v[44:47]
    ds_read_b64_tr_b16 v[82:83], v30 offset:32064
    v_readfirstlane_b32 s70, v1
    v_mfma_f32_16x16x32_bf16 v[64:67], v[84:87], v[228:231], v[64:67]
    ds_read_b64_tr_b16 v[84:85], v30 offset:30816
    s_waitcnt lgkmcnt(7)
    v_mfma_f32_16x16x32_bf16 v[48:51], v[88:91], v[224:227], v[48:51]
    ds_read_b64_tr_b16 v[86:87], v30 offset:32096
    s_cmp_ge_u32 s70, 4
    v_mfma_f32_16x16x32_bf16 v[68:71], v[88:91], v[228:231], v[68:71]
    ds_read_b64_tr_b16 v[88:89], v30 offset:30848
    s_waitcnt lgkmcnt(7)
    v_mfma_f32_16x16x32_bf16 v[32:35], v[72:75], v[232:235], v[32:35]
    ds_read_b64_tr_b16 v[90:91], v30 offset:32128
    s_cbranch_scc1 L_ok_q3
    s_mov_b32 s78, 0
L_sp_q3:
    ds_read_b32 v1, v31 offset:16
    s_add_u32 s78, s78, 0x100
    s_cbranch_scc1 L_ok_q3
    s_waitcnt lgkmcnt(0)
    v_readfirstlane_b32 s42, v1
    s_cmp_ge_u32 s42, 4
    s_cbranch_scc0 L_sp_q3
    L_ok_q3:
    v_mfma_f32_16x16x32_bf16 v[52:55], v[72:75], v[236:239], v[52:55]
    ds_read_b64_tr_b16 v[72:73], v30 offset:35840
    s_waitcnt lgkmcnt(7)
    v_mfma_f32_16x16x32_bf16 v[36:39], v[76:79], v[232:235], v[36:39]
    ds_read_b64_tr_b16 v[74:75], v30 offset:37120
    v_mfma_f32_16x16x32_bf16 v[56:59], v[76:79], v[236:239], v[56:59]
    ds_read_b64_tr_b16 v[76:77], v30 offset:35872
    s_waitcnt lgkmcnt(7)
    v_mfma_f32_16x16x32_bf16 v[40:43], v[80:83], v[232:235], v[40:43]
    ds_read_b64_tr_b16 v[78:79], v30 offset:37152
    v_mfma_f32_16x16x32_bf16 v[60:63], v[80:83], v[236:239], v[60:63]
    ds_read_b64_tr_b16 v[80:81], v30 offset:35904
    s_waitcnt lgkmcnt(7)
    v_mfma_f32_16x16x32_bf16 v[44:47], v[84:87], v[232:235], v[44:47]
    ds_read_b64_tr_b16 v[82:83], v30 offset:37184
    v_mfma_f32_16x16x32_bf16 v[64:67], v[84:87], v[236:239], v[64:67]
    ds_read_b64_tr_b16 v[84:85], v30 offset:35936
    s_waitcnt lgkmcnt(7)
    v_mfma_f32_16x16x32_bf16 v[48:51], v[88:91], v[232:235], v[48:51]
    ds_read_b64_tr_b16 v[86:87], v30 offset:37216
    v_mfma_f32_16x16x32_bf16 v[68:71], v[88:91], v[236:239], v[68:71]
    ds_read_b64_tr_b16 v[88:89], v30 offset:35968
    s_waitcnt lgkmcnt(7)
    v_mfma_f32_16x16x32_bf16 v[32:35], v[72:75], v[240:243], v[32:35]
    ds_read_b64_tr_b16 v[90:91], v30 offset:37248
    v_mfma_f32_16x16x32_bf16 v[52:55], v[72:75], v[244:247], v[52:55]
    ds_read_b64_tr_b16 v[72:73], v30 offset:40960
    s_waitcnt lgkmcnt(7)
    v_mfma_f32_16x16x32_bf16 v[36:39], v[76:79], v[240:243], v[36:39]
    ds_read_b64_tr_b16 v[74:75], v30 offset:42240
    v_mfma_f32_16x16x32_bf16 v[56:59], v[76:79], v[244:247], v[56:59]
    ds_read_b64_tr_b16 v[76:77], v30 offset:40992
    s_waitcnt lgkmcnt(7)
    v_mfma_f32_16x16x32_bf16 v[40:43], v[80:83], v[240:243], v[40:43]
    ds_read_b64_tr_b16 v[78:79], v30 offset:42272
    v_mfma_f32_16x16x32_bf16 v[60:63], v[80:83], v[244:247], v[60:63]
    ds_read_b64_tr_b16 v[80:81], v30 offset:41024
    s_waitcnt lgkmcnt(7)
    v_mfma_f32_16x16x32_bf16 v[44:47], v[84:87], v[240:243], v[44:47]
    ds_read_b64_tr_b16 v[82:83], v30 offset:42304
    v_mfma_f32_16x16x32_bf16 v[64:67], v[84:87], v[244:247], v[64:67]
    ds_read_b64_tr_b16 v[84:85], v30 offset:41056
    s_waitcnt lgkmcnt(7)
    v_mfma_f32_16x16x32_bf16 v[48:51], v[88:91], v[240:243], v[48:51]
    ds_read_b64_tr_b16 v[86:87], v30 offset:42336
    v_mfma_f32_16x16x32_bf16 v[68:71], v[88:91], v[244:247], v[68:71]
    ds_read_b64_tr_b16 v[88:89], v30 offset:41088
    s_waitcnt lgkmcnt(7)
    v_mfma_f32_16x16x32_bf16 v[32:35], v[72:75], v[248:251], v[32:35]
    ds_read_b64_tr_b16 v[90:91], v30 offset:42368
    v_mfma_f32_16x16x32_bf16 v[52:55], v[72:75], v[252:255], v[52:55]
    s_waitcnt lgkmcnt(6)
    v_mfma_f32_16x16x32_bf16 v[36:39], v[76:79], v[248:251], v[36:39]
    v_mfma_f32_16x16x32_bf16 v[56:59], v[76:79], v[252:255], v[56:59]
    s_waitcnt lgkmcnt(4)
    v_mfma_f32_16x16x32_bf16 v[40:43], v[80:83], v[248:251], v[40:43]
    v_mfma_f32_16x16x32_bf16 v[60:63], v[80:83], v[252:255], v[60:63]
    s_waitcnt lgkmcnt(2)
    v_mfma_f32_16x16x32_bf16 v[44:47], v[84:87], v[248:251], v[44:47]
    v_mfma_f32_16x16x32_bf16 v[64:67], v[84:87], v[252:255], v[64:67]
    s_waitcnt lgkmcnt(0)
    v_mfma_f32_16x16x32_bf16 v[48:51], v[88:91], v[248:251], v[48:51]
    v_mfma_f32_16x16x32_bf16 v[68:71], v[88:91], v[252:255], v[68:71]
    s_waitcnt vmcnt(0)
    v_pk_fma_f32 v[72:73], v[32:33], s[74:75], v[8:9] op_sel_hi:[1,1,0]
    v_pk_fma_f32 v[74:75], v[34:35], s[74:75], v[8:9] op_sel_hi:[1,1,0]
    v_pk_fma_f32 v[76:77], v[36:37], s[74:75], v[8:9] op_sel_hi:[1,1,0]
    v_pk_fma_f32 v[78:79], v[38:39], s[74:75], v[8:9] op_sel_hi:[1,1,0]
    v_exp_f32_e64 v72, v72 clamp
    v_max_f32 v32, s68, v32
    v_exp_f32_e64 v73, v73 clamp
    v_max_f32 v33, s68, v33
    v_exp_f32_e64 v74, v74 clamp
    v_max_f32 v34, s68, v34
    v_exp_f32_e64 v75, v75 clamp
    v_max_f32 v35, s68, v35
    v_exp_f32_e64 v76, v76 clamp
    v_max_f32 v36, s68, v36
    v_exp_f32_e64 v77, v77 clamp
    v_max_f32 v37, s68, v37
    v_exp_f32_e64 v78, v78 clamp
    v_max_f32 v38, s68, v38
    v_exp_f32_e64 v79, v79 clamp
    v_max_f32 v39, s68, v39
    v_pk_add_f32 v[32:33], v[32:33], v[72:73]
    v_pk_add_f32 v[34:35], v[34:35], v[74:75]
    v_pk_add_f32 v[36:37], v[36:37], v[76:77]
    v_pk_add_f32 v[38:39], v[38:39], v[78:79]
    v_cvt_pk_bf16_f32 v152, v32, v33
    v_cvt_pk_bf16_f32 v153, v34, v35
    v_cvt_pk_bf16_f32 v154, v36, v37
    v_cvt_pk_bf16_f32 v155, v38, v39
    v_pk_fma_f32 v[72:73], v[40:41], s[74:75], v[8:9] op_sel_hi:[1,1,0]
    v_pk_fma_f32 v[74:75], v[42:43], s[74:75], v[8:9] op_sel_hi:[1,1,0]
    v_pk_fma_f32 v[76:77], v[44:45], s[74:75], v[8:9] op_sel_hi:[1,1,0]
    v_pk_fma_f32 v[78:79], v[46:47], s[74:75], v[8:9] op_sel_hi:[1,1,0]
    v_exp_f32_e64 v72, v72 clamp
    v_max_f32 v40, s68, v40
    v_exp_f32_e64 v73, v73 clamp
    v_max_f32 v41, s68, v41
    v_exp_f32_e64 v74, v74 clamp
    v_max_f32 v42, s68, v42
    v_exp_f32_e64 v75, v75 clamp
    v_max_f32 v43, s68, v43
    v_exp_f32_e64 v76, v76 clamp
    v_max_f32 v44, s68, v44
    v_exp_f32_e64 v77, v77 clamp
    v_max_f32 v45, s68, v45
    v_exp_f32_e64 v78, v78 clamp
    v_max_f32 v46, s68, v46
    v_exp_f32_e64 v79, v79 clamp
    v_max_f32 v47, s68, v47
    v_pk_add_f32 v[40:41], v[40:41], v[72:73]
    v_pk_add_f32 v[42:43], v[42:43], v[74:75]
    v_pk_add_f32 v[44:45], v[44:45], v[76:77]
    v_pk_add_f32 v[46:47], v[46:47], v[78:79]
    v_cvt_pk_bf16_f32 v156, v40, v41
    v_cvt_pk_bf16_f32 v157, v42, v43
    v_cvt_pk_bf16_f32 v158, v44, v45
    v_cvt_pk_bf16_f32 v159, v46, v47
    v_pk_fma_f32 v[72:73], v[48:49], s[74:75], v[8:9] op_sel_hi:[1,1,0]
    v_pk_fma_f32 v[74:75], v[50:51], s[74:75], v[8:9] op_sel_hi:[1,1,0]
    v_pk_fma_f32 v[76:77], v[52:53], s[74:75], v[8:9] op_sel_hi:[1,1,0]
    v_pk_fma_f32 v[78:79], v[54:55], s[74:75], v[8:9] op_sel_hi:[1,1,0]
    v_exp_f32_e64 v72, v72 clamp
    v_max_f32 v48, s68, v48
    v_exp_f32_e64 v73, v73 clamp
    v_max_f32 v49, s68, v49
    v_exp_f32_e64 v74, v74 clamp
    v_max_f32 v50, s68, v50
    v_exp_f32_e64 v75, v75 clamp
    v_max_f32 v51, s68, v51
    v_exp_f32_e64 v76, v76 clamp
    v_max_f32 v52, s68, v52
    v_exp_f32_e64 v77, v77 clamp
    v_max_f32 v53, s68, v53
    v_exp_f32_e64 v78, v78 clamp
    v_max_f32 v54, s68, v54
    v_exp_f32_e64 v79, v79 clamp
    v_max_f32 v55, s68, v55
    v_pk_add_f32 v[48:49], v[48:49], v[72:73]
    v_pk_add_f32 v[50:51], v[50:51], v[74:75]
    v_pk_add_f32 v[52:53], v[52:53], v[76:77]
    v_pk_add_f32 v[54:55], v[54:55], v[78:79]
    v_cvt_pk_bf16_f32 v160, v48, v49
    v_cvt_pk_bf16_f32 v161, v50, v51
    v_cvt_pk_bf16_f32 v162, v52, v53
    v_cvt_pk_bf16_f32 v163, v54, v55
    v_pk_fma_f32 v[72:73], v[56:57], s[74:75], v[8:9] op_sel_hi:[1,1,0]
    v_pk_fma_f32 v[74:75], v[58:59], s[74:75], v[8:9] op_sel_hi:[1,1,0]
    v_pk_fma_f32 v[76:77], v[60:61], s[74:75], v[8:9] op_sel_hi:[1,1,0]
    v_pk_fma_f32 v[78:79], v[62:63], s[74:75], v[8:9] op_sel_hi:[1,1,0]
    v_exp_f32_e64 v72, v72 clamp
    v_max_f32 v56, s68, v56
    v_exp_f32_e64 v73, v73 clamp
    v_max_f32 v57, s68, v57
    v_exp_f32_e64 v74, v74 clamp
    v_max_f32 v58, s68, v58
    v_exp_f32_e64 v75, v75 clamp
    v_max_f32 v59, s68, v59
    v_exp_f32_e64 v76, v76 clamp
    v_max_f32 v60, s68, v60
    v_exp_f32_e64 v77, v77 clamp
    v_max_f32 v61, s68, v61
    v_exp_f32_e64 v78, v78 clamp
    v_max_f32 v62, s68, v62
    v_exp_f32_e64 v79, v79 clamp
    v_max_f32 v63, s68, v63
    v_pk_add_f32 v[56:57], v[56:57], v[72:73]
    v_pk_add_f32 v[58:59], v[58:59], v[74:75]
    v_pk_add_f32 v[60:61], v[60:61], v[76:77]
    v_pk_add_f32 v[62:63], v[62:63], v[78:79]
    v_cvt_pk_bf16_f32 v164, v56, v57
    v_cvt_pk_bf16_f32 v165, v58, v59
    v_cvt_pk_bf16_f32 v166, v60, v61
    v_cvt_pk_bf16_f32 v167, v62, v63
    v_pk_fma_f32 v[72:73], v[64:65], s[74:75], v[8:9] op_sel_hi:[1,1,0]
    v_pk_fma_f32 v[74:75], v[66:67], s[74:75], v[8:9] op_sel_hi:[1,1,0]
    v_pk_fma_f32 v[76:77], v[68:69], s[74:75], v[8:9] op_sel_hi:[1,1,0]
    v_pk_fma_f32 v[78:79], v[70:71], s[74:75], v[8:9] op_sel_hi:[1,1,0]
    v_exp_f32_e64 v72, v72 clamp
    v_max_f32 v64, s68, v64
    v_exp_f32_e64 v73, v73 clamp
    v_max_f32 v65, s68, v65
    v_exp_f32_e64 v74, v74 clamp
    v_max_f32 v66, s68, v66
    v_exp_f32_e64 v75, v75 clamp
    v_max_f32 v67, s68, v67
    v_exp_f32_e64 v76, v76 clamp
    v_max_f32 v68, s68, v68
    v_exp_f32_e64 v77, v77 clamp
    v_max_f32 v69, s68, v69
    v_exp_f32_e64 v78, v78 clamp
    v_max_f32 v70, s68, v70
    v_exp_f32_e64 v79, v79 clamp
    v_max_f32 v71, s68, v71
    v_pk_add_f32 v[64:65], v[64:65], v[72:73]
    v_pk_add_f32 v[66:67], v[66:67], v[74:75]
    v_pk_add_f32 v[68:69], v[68:69], v[76:77]
    v_pk_add_f32 v[70:71], v[70:71], v[78:79]
    v_cvt_pk_bf16_f32 v168, v64, v65
    v_cvt_pk_bf16_f32 v169, v66, v67
    v_cvt_pk_bf16_f32 v170, v68, v69
    v_cvt_pk_bf16_f32 v171, v70, v71
    s_mov_b32 s78, 0
L_sp_qk:
    ds_read_b32 v1, v31 offset:44
    s_add_u32 s78, s78, 0x100
    s_cbranch_scc1 L_ok_qk
    s_waitcnt lgkmcnt(0)
    v_readfirstlane_b32 s42, v1
    s_cmp_ge_u32 s42, 4
    s_cbranch_scc0 L_sp_qk
    L_ok_qk:
    ds_read_b128 v[192:195], v93 offset:0
    ds_read_b128 v[176:179], v92 offset:0
    ds_read_b128 v[196:199], v93 offset:1520
    ds_read_b128 v[180:183], v92 offset:1520
    ds_read_b128 v[200:203], v93 offset:3040
    ds_read_b128 v[184:187], v92 offset:3040
    ds_read_b128 v[204:207], v93 offset:4560
    ds_read_b128 v[188:191], v92 offset:4560
    s_waitcnt lgkmcnt(6)
    v_mfma_f32_16x16x32_bf16 v[48:51], v[192:195], v[152:155], v[96:99]
    v_mfma_f32_16x16x32_bf16 v[224:227], v[192:195], v[162:165], v[96:99]
    v_mfma_f32_16x16x32_bf16 v[32:35], v[176:179], v[152:155], 0
    v_mfma_f32_16x16x32_bf16 v[208:211], v[176:179], v[162:165], 0
    s_waitcnt lgkmcnt(4)
    v_mfma_f32_16x16x32_bf16 v[52:55], v[196:199], v[154:157], v[96:99]
    v_mfma_f32_16x16x32_bf16 v[228:231], v[196:199], v[164:167], v[96:99]
    v_mfma_f32_16x16x32_bf16 v[36:39], v[180:183], v[154:157], 0
    v_mfma_f32_16x16x32_bf16 v[212:215], v[180:183], v[164:167], 0
    v_rcp_f32 v50, v50
    v_rcp_f32 v226, v226
    v_pk_mul_f32 v[48:49], v[48:49], v[50:51] op_sel_hi:[1,0]
    v_pk_mul_f32 v[32:33], v[32:33], v[50:51] op_sel_hi:[1,0]
    v_pk_mul_f32 v[34:35], v[34:35], v[50:51] op_sel_hi:[1,0]
    v_pk_mul_f32 v[224:225], v[224:225], v[226:227] op_sel_hi:[1,0]
    v_pk_mul_f32 v[208:209], v[208:209], v[226:227] op_sel_hi:[1,0]
    v_pk_mul_f32 v[210:211], v[210:211], v[226:227] op_sel_hi:[1,0]
    v_cvt_pk_bf16_f32 v64, v48, v49
    s_waitcnt lgkmcnt(2)
    v_mfma_f32_16x16x32_bf16 v[56:59], v[200:203], v[156:159], v[96:99]
    v_cvt_pk_bf16_f32 v112, v32, v33
    v_mfma_f32_16x16x32_bf16 v[232:235], v[200:203], v[166:169], v[96:99]
    v_cvt_pk_bf16_f32 v113, v34, v35
    v_cvt_pk_bf16_f32 v68, v224, v225
    v_mfma_f32_16x16x32_bf16 v[40:43], v[184:187], v[156:159], 0
    v_cvt_pk_bf16_f32 v116, v208, v209
    v_cvt_pk_bf16_f32 v117, v210, v211
    v_mfma_f32_16x16x32_bf16 v[216:219], v[184:187], v[166:169], 0
    v_rcp_f32 v54, v54
    v_rcp_f32 v230, v230
    v_pk_mul_f32 v[52:53], v[52:53], v[54:55] op_sel_hi:[1,0]
    v_pk_mul_f32 v[36:37], v[36:37], v[54:55] op_sel_hi:[1,0]
    v_pk_mul_f32 v[38:39], v[38:39], v[54:55] op_sel_hi:[1,0]
    v_pk_mul_f32 v[228:229], v[228:229], v[230:231] op_sel_hi:[1,0]
    v_pk_mul_f32 v[212:213], v[212:213], v[230:231] op_sel_hi:[1,0]
    v_pk_mul_f32 v[214:215], v[214:215], v[230:231] op_sel_hi:[1,0]
    v_cvt_pk_bf16_f32 v65, v52, v53
    s_waitcnt lgkmcnt(0)
    v_mfma_f32_16x16x32_bf16 v[60:63], v[204:207], v[158:161], v[96:99]
    v_cvt_pk_bf16_f32 v114, v36, v37
    v_mfma_f32_16x16x32_bf16 v[236:239], v[204:207], v[168:171], v[96:99]
    v_cvt_pk_bf16_f32 v115, v38, v39
    v_cvt_pk_bf16_f32 v69, v228, v229
    v_mfma_f32_16x16x32_bf16 v[44:47], v[188:191], v[158:161], 0
    v_cvt_pk_bf16_f32 v118, v212, v213
    v_cvt_pk_bf16_f32 v119, v214, v215
    v_mfma_f32_16x16x32_bf16 v[220:223], v[188:191], v[168:171], 0
    v_rcp_f32 v58, v58
    v_rcp_f32 v234, v234
    v_pk_mul_f32 v[56:57], v[56:57], v[58:59] op_sel_hi:[1,0]
    v_pk_mul_f32 v[40:41], v[40:41], v[58:59] op_sel_hi:[1,0]
    v_pk_mul_f32 v[42:43], v[42:43], v[58:59] op_sel_hi:[1,0]
    v_pk_mul_f32 v[232:233], v[232:233], v[234:235] op_sel_hi:[1,0]
    v_pk_mul_f32 v[216:217], v[216:217], v[234:235] op_sel_hi:[1,0]
    v_pk_mul_f32 v[218:219], v[218:219], v[234:235] op_sel_hi:[1,0]
    v_cvt_pk_bf16_f32 v66, v56, v57
    v_cvt_pk_bf16_f32 v120, v40, v41
    v_cvt_pk_bf16_f32 v121, v42, v43
    v_cvt_pk_bf16_f32 v70, v232, v233
    v_cvt_pk_bf16_f32 v124, v216, v217
    v_cvt_pk_bf16_f32 v125, v218, v219
    v_rcp_f32 v62, v62
    v_rcp_f32 v238, v238
    v_pk_mul_f32 v[60:61], v[60:61], v[62:63] op_sel_hi:[1,0]
    v_pk_mul_f32 v[44:45], v[44:45], v[62:63] op_sel_hi:[1,0]
    v_pk_mul_f32 v[46:47], v[46:47], v[62:63] op_sel_hi:[1,0]
    v_pk_mul_f32 v[236:237], v[236:237], v[238:239] op_sel_hi:[1,0]
    v_pk_mul_f32 v[220:221], v[220:221], v[238:239] op_sel_hi:[1,0]
    v_pk_mul_f32 v[222:223], v[222:223], v[238:239] op_sel_hi:[1,0]
    v_cvt_pk_bf16_f32 v67, v60, v61
    v_cvt_pk_bf16_f32 v122, v44, v45
    v_cvt_pk_bf16_f32 v123, v46, v47
    v_cvt_pk_bf16_f32 v71, v236, v237
    v_cvt_pk_bf16_f32 v126, v220, v221
    v_cvt_pk_bf16_f32 v127, v222, v223
    v_cndmask_b32 v128, v64, v65, s[44:45]
    v_cndmask_b32 v129, v68, v69, s[44:45]
    v_cndmask_b32 v128, v128, v66, s[46:47]
    v_cndmask_b32 v129, v129, v70, s[46:47]
    v_cndmask_b32 v128, v128, v67, s[48:49]
    v_cndmask_b32 v129, v129, v71, s[48:49]
    s_add_u32 s42, s56, 0
    s_add_u32 s43, s57, 0
    buffer_store_dwordx4 v[112:115], v10, s[24:27], s42 offen sc1
    buffer_store_dwordx4 v[120:123], v10, s[24:27], s42 offen offset:1024 sc1
    buffer_store_dword v128, v11, s[24:27], s43 offen sc1
    s_add_u32 s42, s56, 18432
    s_add_u32 s43, s57, 18432
    buffer_store_dwordx4 v[116:119], v10, s[24:27], s42 offen sc1
    buffer_store_dwordx4 v[124:127], v10, s[24:27], s42 offen offset:1024 sc1
    buffer_store_dword v129, v11, s[24:27], s43 offen sc1
    s_branch L_main
L_k:
    s_lshr_b32 s4, s2, 3
    s_bfe_u32 s36, s2, 0x10002
    s_xor_b32 s36, s36, 1
    s_and_b32 s5, s4, 7
    s_lshr_b32 s6, s4, 3
    s_and_b32 s3, s2, 1
    s_lshl3_add_u32 s37, s3, s5
    s_lshl1_add_u32 s39, s6, s5
    s_sub_u32 s3, s39, 9
    s_cselect_b32 s39, s39, s3
    s_bfe_u32 s41, s40, 0x20006
    s_lshr_b32 s3, s41, 1
    s_lshl1_add_u32 s3, s37, s3
    s_lshl_b32 s3, s3, 6
    s_and_b32 s4, s41, 1
    s_add_u32 s3, s3, s4
    s_mul_i32 s54, s3, 1152
    s_lshl_b32 s61, s41, 12
    s_mov_b32 s10, 2359296
    s_mov_b32 s11, 0x20000
    s_cmp_eq_u32 s36, 0
    s_waitcnt lgkmcnt(0)
    s_cselect_b32 s8, s64, s70
    s_cselect_b32 s9, s65, s71
    s_load_dwordx2 s[80:81], s[0:1], 64
    s_bfe_u32 s4, s2, 0x10001
    s_lshl2_add_u32 s38, s4, s6
    s_lshr_b32 s40, s40, 6
    s_mov_b32 s63, s39
    s_lshl_b32 s62, s41, 11
    s_cmp_eq_u32 s5, 7
    s_cselect_b32 s5, 0, s5
    s_lshl_b32 s6, s5, 1
    s_mov_b32 s7, s2
    s_cmp_eq_u32 s36, 0
    s_cselect_b32 s12, s66, s72
    s_cselect_b32 s13, s67, s73
    s_mov_b32 s14, 1990656
    s_mov_b32 s15, 0x20000
    s_mov_b32 s35, 0x20000
    s_cmp_eq_u32 s36, 0
    s_cselect_b32 s16, s68, s74
    s_cselect_b32 s17, s69, s75
    s_mov_b32 s18, 663552
    s_mov_b32 s19, 0x20000
    s_mov_b32 s20, s76
    s_mov_b32 s21, s77
    s_mov_b32 s22, 4718592
    s_mov_b32 s23, 0x20000
    s_waitcnt lgkmcnt(0)
    s_mov_b32 s24, s80
    s_mov_b32 s25, s81
    s_mov_b32 s26, 0x10000000
    s_mov_b32 s27, 0x20000
    s_mov_b32 s28, s78
    s_mov_b32 s29, s79
    s_mov_b32 s30, 256
    s_mov_b32 s31, 0x20000
    s_cmp_lt_u32 s41, 2
    s_cselect_b32 s32, s12, s8
    s_cselect_b32 s33, s13, s9
    s_cselect_b32 s34, s14, s10
    s_mov_b32 s44, 0xffff0000
    s_mov_b32 s45, -1
    s_mov_b32 s46, 0
    s_mov_b32 s47, -1
    s_mov_b32 s48, 0
    s_mov_b32 s49, 0xffff0000
    v_lshlrev_b32 v1, 2, v0
    v_add_u32 v1, 163712, v1
    v_mov_b32 v2, 0
    s_mov_b64 exec, 0xffff
    ds_write_b32 v1, v2
    s_mov_b64 exec, -1
    s_waitcnt lgkmcnt(0)
    s_cmp_eq_u32 s36, 0
    s_cbranch_scc0 L_bk
    s_movk_i32 s70, 9
    s_movk_i32 s71, 15
    s_cmp_eq_u32 s41, 1
    s_cselect_b32 s70, 1, s70
    s_cselect_b32 s71, 7, s71
    s_lshr_b32 s42, s41, 1
    s_or_b32 s42, s42, s37
    s_cmp_eq_u32 s42, 0
    s_cselect_b32 s70, 64, s70
    v_and_b32 v1, 15, v0
    v_lshrrev_b32 v2, 4, v0
    v_lshlrev_b32 v2, 2, v2
    v_mov_b32 v6, 0xf149f2ca
    v_mov_b32 v7, 0xffff
    v_mov_b32 v8, 0xffff0000
    v_add_u32 v3, 0, v2
    v_sub_u32 v4, v1, v3
    v_cmp_gt_u32 vcc, 8, v4
    v_sub_u32 v5, v3, v1
    s_nop 0
    v_cndmask_b32 v242, v6, 0, vcc
    v_cmp_le_i32 vcc, 9, v5
    s_nop 1
    v_cndmask_b32 v246, v6, 0, vcc
    v_cmp_le_i32 vcc, s70, v5
    s_nop 1
    v_cndmask_b32 v250, v6, 0, vcc
    v_cmp_lt_u32 vcc, s71, v3
    s_nop 1
    v_cndmask_b32 v250, v250, v6, vcc
    v_cmp_ge_i32 vcc, 0, v5
    s_nop 1
    v_cndmask_b32 v254, 0, v7, vcc
    v_add_u32 v3, 1, v2
    v_sub_u32 v4, v1, v3
    v_cmp_gt_u32 vcc, 8, v4
    v_sub_u32 v5, v3, v1
    s_nop 0
    v_cndmask_b32 v243, v6, 0, vcc
    v_cmp_le_i32 vcc, 9, v5
    s_nop 1
    v_cndmask_b32 v247, v6, 0, vcc
    v_cmp_le_i32 vcc, s70, v5
    s_nop 1
    v_cndmask_b32 v251, v6, 0, vcc
    v_cmp_lt_u32 vcc, s71, v3
    s_nop 1
    v_cndmask_b32 v251, v251, v6, vcc
    v_cmp_ge_i32 vcc, 0, v5
    s_nop 1
    v_cndmask_b32 v9, 0, v8, vcc
    v_or_b32 v254, v254, v9
    v_add_u32 v3, 2, v2
    v_sub_u32 v4, v1, v3
    v_cmp_gt_u32 vcc, 8, v4
    v_sub_u32 v5, v3, v1
    s_nop 0
    v_cndmask_b32 v244, v6, 0, vcc
    v_cmp_le_i32 vcc, 9, v5
    s_nop 1
    v_cndmask_b32 v248, v6, 0, vcc
    v_cmp_le_i32 vcc, s70, v5
    s_nop 1
    v_cndmask_b32 v252, v6, 0, vcc
    v_cmp_lt_u32 vcc, s71, v3
    s_nop 1
    v_cndmask_b32 v252, v252, v6, vcc
    v_cmp_ge_i32 vcc, 0, v5
    s_nop 1
    v_cndmask_b32 v255, 0, v7, vcc
    v_add_u32 v3, 3, v2
    v_sub_u32 v4, v1, v3
    v_cmp_gt_u32 vcc, 8, v4
    v_sub_u32 v5, v3, v1
    s_nop 0
    v_cndmask_b32 v245, v6, 0, vcc
    v_cmp_le_i32 vcc, 9, v5
    s_nop 1
    v_cndmask_b32 v249, v6, 0, vcc
    v_cmp_le_i32 vcc, s70, v5
    s_nop 1
    v_cndmask_b32 v253, v6, 0, vcc
    v_cmp_lt_u32 vcc, s71, v3
    s_nop 1
    v_cndmask_b32 v253, v253, v6, vcc
    v_cmp_ge_i32 vcc, 0, v5
    s_nop 1
    v_cndmask_b32 v9, 0, v8, vcc
    v_or_b32 v255, v255, v9
    s_lshl_b32 s42, s37, 2
    s_add_u32 s42, s42, s41
    s_add_u32 s42, s42, 0
    s_mul_i32 s54, s42, 36864
    s_lshl_b32 s71, s42, 7
    s_add_u32 s71, s71, 6291456
    s_lshl_b32 s56, s38, 11
    s_add_u32 s56, s56, s54
    s_lshl_b32 s57, s38, 8
    s_add_u32 s57, s57, s54
    s_add_u32 s57, s57, 16384
    s_mov_b32 s76, 0
    s_mov_b32 s77, 47104
    v_lshlrev_b32 v10, 4, v0
    v_and_b32 v1, 15, v0
    v_lshrrev_b32 v2, 4, v0
    v_lshlrev_b32 v3, 4, v1
    v_lshl_add_u32 v11, v2, 3, v3
    v_mov_b32 v4, 1073741824
    v_cndmask_b32 v11, v11, v4, s[46:47]
    v_and_b32 v1, 15, v0
    v_lshrrev_b32 v2, 4, v0
    v_lshrrev_b32 v3, 1, v1
    v_xor_b32 v2, v2, v3
    v_lshlrev_b32 v2, 4, v2
    v_lshl_add_u32 v200, v1, 7, v2
    v_add_u32 v196, s61, v200
    v_xor_b32 v197, 64, v196
    v_add_u32 v200, 16384, v200
    v_xor_b32 v201, 64, v200
    v_lshrrev_b32 v1, 5, v0
    v_bfe_u32 v192, v0, 2, 3
    v_lshl_add_u32 v1, v1, 4, v192
    v_mul_u32_u24 v1, 288, v1
    v_and_b32 v192, 3, v0
    v_lshl_add_u32 v192, v192, 3, v1
    v_lshrrev_b32 v1, 5, v0
    v_bfe_u32 v193, v0, 2, 3
    v_lshl_add_u32 v1, v1, 4, v193
    v_mul_u32_u24 v1, 160, v1
    v_and_b32 v193, 3, v0
    v_lshl_add_u32 v193, v193, 3, v1
    s_and_b32 s42, s41, 1
    s_mul_i32 s42, s42, 5120
    s_add_u32 s42, s42, 141312
    s_cmp_lt_u32 s41, 2
    s_cselect_b32 s43, 151552, s42
    v_lshl_add_u32 v2, v0, 4, s43
    v_lshl_add_u32 v3, v0, 3, s43
    v_lshl_add_u32 v4, v0, 4, s42
    v_lshl_add_u32 v5, v0, 3, s42
    s_mov_b32 s42, 151552
    v_lshl_add_u32 v6, v0, 4, s42
    v_lshl_add_u32 v7, v0, 3, s42
    v_lshlrev_b32 v8, 2, v0
    v_add_u32 v8, 162816, v8
    v_mov_b32 v9, 163712
    v_cmp_eq_u32 vcc, 0, v0
    s_nop 1
    v_cndmask_b32 v8, v8, v9, vcc
    v_mov_b32 v9, 1
    s_mov_b64 vcc, 0
    s_lshr_b32 s42, s41, 1
    s_or_b32 s42, s42, s37
    s_or_b32 s42, s42, s38
    s_cmp_eq_u32 s42, 0
    s_cbranch_scc0 L_ni0
    s_lshl_b32 s42, s41, 13
    s_add_u32 s42, s42, 6291456
    v_lshlrev_b32 v12, 7, v0
    v_mov_b32 v13, 0
    buffer_store_dword v13, v12, s[24:27], s42 offen sc1
    s_mov_b64 vcc, 1
L_ni0:
    v_mov_b32 v12, 0
    v_mov_b32 v13, 0
    v_mov_b32 v14, 0
    v_mov_b32 v15, 0
    v_mov_b32 v16, 0
    v_mov_b32 v17, 0
    v_mov_b32 v18, 0
    v_mov_b32 v19, 0
    v_mov_b32 v20, 0
    v_mov_b32 v21, 0
    v_mov_b32 v22, 0
    v_mov_b32 v23, 0
    v_mov_b32 v24, 0
    v_mov_b32 v25, 0
    v_mov_b32 v26, 0
    v_mov_b32 v27, 0
    v_mov_b32 v28, 0
    v_mov_b32 v29, 0
    v_mov_b32 v30, 0
    v_mov_b32 v31, 0
    v_mov_b32 v32, 0
    v_mov_b32 v33, 0
    v_mov_b32 v34, 0
    v_mov_b32 v35, 0
    v_mov_b32 v36, 0
    v_mov_b32 v37, 0
    v_mov_b32 v38, 0
    v_mov_b32 v39, 0
    v_mov_b32 v40, 0
    v_mov_b32 v41, 0
    v_mov_b32 v42, 0
    v_mov_b32 v43, 0
    v_mov_b32 v44, 0
    v_mov_b32 v45, 0
    v_mov_b32 v46, 0
    v_mov_b32 v47, 0
    v_mov_b32 v48, 0
    v_mov_b32 v49, 0
    v_mov_b32 v50, 0
    v_mov_b32 v51, 0
    v_mov_b32 v52, 0
    v_mov_b32 v53, 0
    v_mov_b32 v54, 0
    v_mov_b32 v55, 0
    v_mov_b32 v56, 0
    v_mov_b32 v57, 0
    v_mov_b32 v58, 0
    v_mov_b32 v59, 0
    v_mov_b32 v60, 0
    v_mov_b32 v61, 0
    v_mov_b32 v62, 0
    v_mov_b32 v63, 0
    v_mov_b32 v64, 0
    v_mov_b32 v65, 0
    v_mov_b32 v66, 0
    v_mov_b32 v67, 0
    v_mov_b32 v68, 0
    v_mov_b32 v69, 0
    v_mov_b32 v70, 0
    v_mov_b32 v71, 0
    v_mov_b32 v72, 0
    v_mov_b32 v73, 0
    v_mov_b32 v74, 0
    v_mov_b32 v75, 0
    v_mov_b32 v76, 0
    v_mov_b32 v77, 0
    v_mov_b32 v78, 0
    v_mov_b32 v79, 0
    v_mov_b32 v80, 0
    v_mov_b32 v81, 0
    v_mov_b32 v82, 0
    v_mov_b32 v83, 0
    v_mov_b32 v84, 0
    v_mov_b32 v85, 0
    v_mov_b32 v86, 0
    v_mov_b32 v87, 0
    v_mov_b32 v88, 0
    v_mov_b32 v89, 0
    v_mov_b32 v90, 0
    v_mov_b32 v91, 0
    v_mov_b32 v92, 0
    v_mov_b32 v93, 0
    v_mov_b32 v94, 0
    v_mov_b32 v95, 0
    v_mov_b32 v96, 0
    v_mov_b32 v97, 0
    v_mov_b32 v98, 0
    v_mov_b32 v99, 0
    v_mov_b32 v100, 0
    v_mov_b32 v101, 0
    v_mov_b32 v102, 0
    v_mov_b32 v103, 0
    v_mov_b32 v104, 0
    v_mov_b32 v105, 0
    v_mov_b32 v106, 0
    v_mov_b32 v107, 0
    v_mov_b32 v108, 0
    v_mov_b32 v109, 0
    v_mov_b32 v110, 0
    v_mov_b32 v111, 0
    v_mov_b32 v112, 0
    v_mov_b32 v113, 0
    v_mov_b32 v114, 0
    v_mov_b32 v115, 0
    v_mov_b32 v116, 0
    v_mov_b32 v117, 0
    v_mov_b32 v118, 0
    v_mov_b32 v119, 0
    v_mov_b32 v120, 0
    v_mov_b32 v121, 0
    v_mov_b32 v122, 0
    v_mov_b32 v123, 0
    v_mov_b32 v124, 0
    v_mov_b32 v125, 0
    v_mov_b32 v126, 0
    v_mov_b32 v127, 0
    v_mov_b32 v128, 0
    v_mov_b32 v129, 0
    v_mov_b32 v130, 0
    v_mov_b32 v131, 0
    v_mov_b32 v132, 0
    v_mov_b32 v133, 0
    v_mov_b32 v134, 0
    v_mov_b32 v135, 0
    v_mov_b32 v136, 0
    v_mov_b32 v137, 0
    v_mov_b32 v138, 0
    v_mov_b32 v139, 0
    v_mov_b32 v140, 0
    v_mov_b32 v141, 0
    v_mov_b32 v142, 0
    v_mov_b32 v143, 0
    s_cmp_eq_u32 s41, 1
    s_cbranch_scc1 L_ak1
    s_cmp_eq_u32 s41, 2
    s_cbranch_scc1 L_ak2
    s_cmp_eq_u32 s41, 3
    s_cbranch_scc1 L_ak3
    s_mov_b32 s67, 0
    s_mov_b32 s66, 0
    v_add_u32 v190, 0, v192
    v_add_u32 v191, 0, v193
    v_add_u32 v194, 0, v196
    v_add_u32 v195, 0, v197
    v_add_u32 v198, 0, v200
    v_add_u32 v199, 0, v201
    v_mov_b32 v188, v190
    v_mov_b32 v189, v191
    s_barrier
    ds_read_b128 v[164:167], v194 offset:0
    ds_read_b64_tr_b16 v[144:145], v188 offset:18432
    ds_read_b64_tr_b16 v[146:147], v188 offset:20736
    ds_read_b128 v[168:171], v194 offset:2048
    ds_read_b128 v[172:175], v198 offset:0
    ds_read_b64_tr_b16 v[148:149], v188 offset:18464
    ds_read_b64_tr_b16 v[150:151], v188 offset:20768
    ds_read_b64_tr_b16 v[152:153], v188 offset:18496
    ds_read_b64_tr_b16 v[154:155], v188 offset:20800
    ds_read_b64_tr_b16 v[156:157], v188 offset:18528
    ds_read_b64_tr_b16 v[158:159], v188 offset:20832
L_kl_a0:
    ds_read_b64_tr_b16 v[160:161], v188 offset:18560
    s_waitcnt lgkmcnt(7)
    v_mfma_f32_16x16x32_bf16 v[52:55], v[144:147], v[164:167], v[52:55]
    ds_read_b64_tr_b16 v[162:163], v188 offset:20864
    s_add_u32 s42, s67, 47104
    v_mfma_f32_16x16x32_bf16 v[72:75], v[144:147], v[168:171], v[72:75]
    v_mfma_f32_16x16x32_bf16 v[132:135], v[144:147], v[172:175], v[132:135]
    ds_read_b64_tr_b16 v[144:145], v188 offset:18576
    s_waitcnt lgkmcnt(7)
    v_mfma_f32_16x16x32_bf16 v[56:59], v[148:151], v[164:167], v[56:59]
    ds_read_b64_tr_b16 v[146:147], v188 offset:20880
    s_cmp_eq_u32 s67, 94208
    v_mfma_f32_16x16x32_bf16 v[76:79], v[148:151], v[168:171], v[76:79]
    ds_read_b64_tr_b16 v[148:149], v188 offset:18608
    s_waitcnt lgkmcnt(7)
    v_mfma_f32_16x16x32_bf16 v[60:63], v[152:155], v[164:167], v[60:63]
    ds_read_b64_tr_b16 v[150:151], v188 offset:20912
    ds_read_b128 v[176:179], v195 offset:0
    v_mfma_f32_16x16x32_bf16 v[80:83], v[152:155], v[168:171], v[80:83]
    ds_read_b64_tr_b16 v[152:153], v188 offset:18640
    s_waitcnt lgkmcnt(8)
    v_mfma_f32_16x16x32_bf16 v[64:67], v[156:159], v[164:167], v[64:67]
    ds_read_b64_tr_b16 v[154:155], v188 offset:20944
    ds_read_b128 v[180:183], v195 offset:2048
    v_mfma_f32_16x16x32_bf16 v[84:87], v[156:159], v[168:171], v[84:87]
    ds_read_b64_tr_b16 v[156:157], v188 offset:18672
    s_waitcnt lgkmcnt(9)
    v_mfma_f32_16x16x32_bf16 v[68:71], v[160:163], v[164:167], v[68:71]
    ds_read_b64_tr_b16 v[158:159], v188 offset:20976
    ds_read_b128 v[184:187], v199 offset:0
    v_mfma_f32_16x16x32_bf16 v[88:91], v[160:163], v[168:171], v[88:91]
    v_mfma_f32_16x16x32_bf16 v[140:143], v[160:163], v[172:175], v[140:143]
    ds_read_b64_tr_b16 v[160:161], v188 offset:18704
    s_waitcnt lgkmcnt(10)
    v_mfma_f32_16x16x32_bf16 v[92:95], v[164:167], v[144:147], v[92:95]
    ds_read_b64_tr_b16 v[162:163], v188 offset:21008
    s_cselect_b32 s67, 0, s42
    v_mfma_f32_16x16x32_bf16 v[112:115], v[168:171], v[144:147], v[112:115]
    v_mfma_f32_16x16x32_bf16 v[136:139], v[172:175], v[144:147], v[136:139]
    ds_read_b64_tr_b16 v[144:145], v189 offset:36864
    s_waitcnt lgkmcnt(10)
    v_mfma_f32_16x16x32_bf16 v[96:99], v[164:167], v[148:151], v[96:99]
    ds_read_b64_tr_b16 v[146:147], v189 offset:38144
    v_add_u32 v190, s67, v192
    v_mfma_f32_16x16x32_bf16 v[116:119], v[168:171], v[148:151], v[116:119]
    ds_read_b64_tr_b16 v[148:149], v189 offset:36896
    s_waitcnt lgkmcnt(9)
    v_mfma_f32_16x16x32_bf16 v[100:103], v[164:167], v[152:155], v[100:103]
    ds_read_b64_tr_b16 v[150:151], v189 offset:38176
    v_add_u32 v191, s67, v193
    v_mfma_f32_16x16x32_bf16 v[120:123], v[168:171], v[152:155], v[120:123]
    ds_read_b64_tr_b16 v[152:153], v189 offset:36928
    s_waitcnt lgkmcnt(8)
    v_mfma_f32_16x16x32_bf16 v[104:107], v[164:167], v[156:159], v[104:107]
    ds_read_b64_tr_b16 v[154:155], v189 offset:38208
    v_add_u32 v194, s67, v196
    v_mfma_f32_16x16x32_bf16 v[124:127], v[168:171], v[156:159], v[124:127]
    ds_read_b64_tr_b16 v[156:157], v189 offset:36960
    s_waitcnt lgkmcnt(7)
    v_mfma_f32_16x16x32_bf16 v[108:111], v[164:167], v[160:163], v[108:111]
    ds_read_b64_tr_b16 v[158:159], v189 offset:38240
    v_add_u32 v195, s67, v197
    v_mfma_f32_16x16x32_bf16 v[128:131], v[168:171], v[160:163], v[128:131]
    ds_read_b64_tr_b16 v[160:161], v189 offset:36992
    s_waitcnt lgkmcnt(7)
    v_mfma_f32_16x16x32_bf16 v[12:15], v[144:147], v[164:167], v[12:15]
    ds_read_b64_tr_b16 v[162:163], v189 offset:38272
    v_add_u32 v198, s67, v200
    v_mfma_f32_16x16x32_bf16 v[32:35], v[144:147], v[168:171], v[32:35]
    ds_read_b64_tr_b16 v[144:145], v188 offset:27648
    s_waitcnt lgkmcnt(7)
    v_mfma_f32_16x16x32_bf16 v[16:19], v[148:151], v[164:167], v[16:19]
    ds_read_b64_tr_b16 v[146:147], v188 offset:29952
    v_add_u32 v199, s67, v201
    v_mfma_f32_16x16x32_bf16 v[36:39], v[148:151], v[168:171], v[36:39]
    ds_read_b64_tr_b16 v[148:149], v188 offset:27680
    s_waitcnt lgkmcnt(7)
    v_mfma_f32_16x16x32_bf16 v[20:23], v[152:155], v[164:167], v[20:23]
    ds_read_b64_tr_b16 v[150:151], v188 offset:29984
    s_add_u32 s66, s66, 1
    v_mfma_f32_16x16x32_bf16 v[40:43], v[152:155], v[168:171], v[40:43]
    ds_read_b64_tr_b16 v[152:153], v188 offset:27712
    s_waitcnt lgkmcnt(7)
    v_mfma_f32_16x16x32_bf16 v[24:27], v[156:159], v[164:167], v[24:27]
    ds_read_b64_tr_b16 v[154:155], v188 offset:30016
    s_cmp_lt_u32 s66, 8
    v_mfma_f32_16x16x32_bf16 v[44:47], v[156:159], v[168:171], v[44:47]
    ds_read_b64_tr_b16 v[156:157], v188 offset:27744
    s_waitcnt lgkmcnt(7)
    v_mfma_f32_16x16x32_bf16 v[28:31], v[160:163], v[164:167], v[28:31]
    ds_read_b64_tr_b16 v[158:159], v188 offset:30048
    s_cbranch_vccnz L_id_a0
L_ir_a0:
    v_mfma_f32_16x16x32_bf16 v[48:51], v[160:163], v[168:171], v[48:51]
    ds_read_b64_tr_b16 v[160:161], v188 offset:27776
    s_waitcnt lgkmcnt(7)
    v_mfma_f32_16x16x32_bf16 v[52:55], v[144:147], v[176:179], v[52:55]
    ds_read_b64_tr_b16 v[162:163], v188 offset:30080
    v_mfma_f32_16x16x32_bf16 v[72:75], v[144:147], v[180:183], v[72:75]
    v_mfma_f32_16x16x32_bf16 v[132:135], v[144:147], v[184:187], v[132:135]
    ds_read_b64_tr_b16 v[144:145], v188 offset:27792
    s_waitcnt lgkmcnt(7)
    v_mfma_f32_16x16x32_bf16 v[56:59], v[148:151], v[176:179], v[56:59]
    ds_read_b64_tr_b16 v[146:147], v188 offset:30096
    v_mfma_f32_16x16x32_bf16 v[76:79], v[148:151], v[180:183], v[76:79]
    ds_read_b64_tr_b16 v[148:149], v188 offset:27824
    s_waitcnt lgkmcnt(7)
    v_mfma_f32_16x16x32_bf16 v[60:63], v[152:155], v[176:179], v[60:63]
    ds_read_b64_tr_b16 v[150:151], v188 offset:30128
    v_mfma_f32_16x16x32_bf16 v[80:83], v[152:155], v[180:183], v[80:83]
    ds_read_b64_tr_b16 v[152:153], v188 offset:27856
    s_waitcnt lgkmcnt(7)
    v_mfma_f32_16x16x32_bf16 v[64:67], v[156:159], v[176:179], v[64:67]
    ds_read_b64_tr_b16 v[154:155], v188 offset:30160
    v_mfma_f32_16x16x32_bf16 v[84:87], v[156:159], v[180:183], v[84:87]
    ds_read_b64_tr_b16 v[156:157], v188 offset:27888
    s_waitcnt lgkmcnt(7)
    v_mfma_f32_16x16x32_bf16 v[68:71], v[160:163], v[176:179], v[68:71]
    ds_read_b64_tr_b16 v[158:159], v188 offset:30192
    v_mfma_f32_16x16x32_bf16 v[88:91], v[160:163], v[180:183], v[88:91]
    v_mfma_f32_16x16x32_bf16 v[140:143], v[160:163], v[184:187], v[140:143]
    ds_read_b64_tr_b16 v[160:161], v188 offset:27920
    s_waitcnt lgkmcnt(7)
    v_mfma_f32_16x16x32_bf16 v[92:95], v[176:179], v[144:147], v[92:95]
    ds_read_b64_tr_b16 v[162:163], v188 offset:30224
    v_mfma_f32_16x16x32_bf16 v[112:115], v[180:183], v[144:147], v[112:115]
    v_mfma_f32_16x16x32_bf16 v[136:139], v[184:187], v[144:147], v[136:139]
    ds_read_b64_tr_b16 v[144:145], v189 offset:41984
    s_waitcnt lgkmcnt(7)
    v_mfma_f32_16x16x32_bf16 v[96:99], v[176:179], v[148:151], v[96:99]
    ds_read_b64_tr_b16 v[146:147], v189 offset:43264
    v_mfma_f32_16x16x32_bf16 v[116:119], v[180:183], v[148:151], v[116:119]
    ds_read_b64_tr_b16 v[148:149], v189 offset:42016
    s_waitcnt lgkmcnt(7)
    v_mfma_f32_16x16x32_bf16 v[100:103], v[176:179], v[152:155], v[100:103]
    ds_read_b64_tr_b16 v[150:151], v189 offset:43296
    v_mfma_f32_16x16x32_bf16 v[120:123], v[180:183], v[152:155], v[120:123]
    ds_read_b64_tr_b16 v[152:153], v189 offset:42048
    s_waitcnt lgkmcnt(7)
    v_mfma_f32_16x16x32_bf16 v[104:107], v[176:179], v[156:159], v[104:107]
    ds_read_b64_tr_b16 v[154:155], v189 offset:43328
    v_mfma_f32_16x16x32_bf16 v[124:127], v[180:183], v[156:159], v[124:127]
    ds_read_b64_tr_b16 v[156:157], v189 offset:42080
    s_waitcnt lgkmcnt(7)
    v_mfma_f32_16x16x32_bf16 v[108:111], v[176:179], v[160:163], v[108:111]
    ds_read_b64_tr_b16 v[158:159], v189 offset:43360
    v_mfma_f32_16x16x32_bf16 v[128:131], v[180:183], v[160:163], v[128:131]
    ds_read_b64_tr_b16 v[160:161], v189 offset:42112
    s_waitcnt lgkmcnt(7)
    v_mfma_f32_16x16x32_bf16 v[12:15], v[144:147], v[176:179], v[12:15]
    ds_read_b64_tr_b16 v[162:163], v189 offset:43392
    v_mfma_f32_16x16x32_bf16 v[32:35], v[144:147], v[180:183], v[32:35]
    s_waitcnt lgkmcnt(6)
    v_mfma_f32_16x16x32_bf16 v[16:19], v[148:151], v[176:179], v[16:19]
    v_mfma_f32_16x16x32_bf16 v[36:39], v[148:151], v[180:183], v[36:39]
    s_waitcnt lgkmcnt(4)
    v_mfma_f32_16x16x32_bf16 v[20:23], v[152:155], v[176:179], v[20:23]
    s_waitcnt lgkmcnt(0)
    s_barrier
    v_mfma_f32_16x16x32_bf16 v[40:43], v[152:155], v[180:183], v[40:43]
    ds_read_b128 v[164:167], v194 offset:0
    ds_read_b64_tr_b16 v[144:145], v190 offset:18432
    ds_read_b64_tr_b16 v[146:147], v190 offset:20736
    v_mfma_f32_16x16x32_bf16 v[24:27], v[156:159], v[176:179], v[24:27]
    ds_read_b128 v[168:171], v194 offset:2048
    ds_read_b128 v[172:175], v198 offset:0
    ds_read_b64_tr_b16 v[148:149], v190 offset:18464
    v_mfma_f32_16x16x32_bf16 v[44:47], v[156:159], v[180:183], v[44:47]
    ds_read_b64_tr_b16 v[150:151], v190 offset:20768
    ds_read_b64_tr_b16 v[152:153], v190 offset:18496
    ds_read_b64_tr_b16 v[154:155], v190 offset:20800
    v_mfma_f32_16x16x32_bf16 v[28:31], v[160:163], v[176:179], v[28:31]
    ds_read_b64_tr_b16 v[156:157], v190 offset:18528
    ds_read_b64_tr_b16 v[158:159], v190 offset:20832
    v_mov_b32 v188, v190
    v_mfma_f32_16x16x32_bf16 v[48:51], v[160:163], v[180:183], v[48:51]
    v_mov_b32 v189, v191
    s_cbranch_scc1 L_kl_a0
    ds_read_b64_tr_b16 v[160:161], v188 offset:18560
    s_waitcnt lgkmcnt(7)
    v_mfma_f32_16x16x32_bf16 v[52:55], v[144:147], v[164:167], v[52:55]
    ds_read_b64_tr_b16 v[162:163], v188 offset:20864
    v_mfma_f32_16x16x32_bf16 v[72:75], v[144:147], v[168:171], v[72:75]
    v_mfma_f32_16x16x32_bf16 v[132:135], v[144:147], v[172:175], v[132:135]
    ds_read_b64_tr_b16 v[144:145], v188 offset:18576
    s_waitcnt lgkmcnt(7)
    v_mfma_f32_16x16x32_bf16 v[56:59], v[148:151], v[164:167], v[56:59]
    ds_read_b64_tr_b16 v[146:147], v188 offset:20880
    v_mfma_f32_16x16x32_bf16 v[76:79], v[148:151], v[168:171], v[76:79]
    ds_read_b64_tr_b16 v[148:149], v188 offset:18608
    s_waitcnt lgkmcnt(7)
    v_mfma_f32_16x16x32_bf16 v[60:63], v[152:155], v[164:167], v[60:63]
    ds_read_b64_tr_b16 v[150:151], v188 offset:20912
    ds_read_b128 v[176:179], v195 offset:0
    v_mfma_f32_16x16x32_bf16 v[80:83], v[152:155], v[168:171], v[80:83]
    ds_read_b64_tr_b16 v[152:153], v188 offset:18640
    s_waitcnt lgkmcnt(8)
    v_mfma_f32_16x16x32_bf16 v[64:67], v[156:159], v[164:167], v[64:67]
    ds_read_b64_tr_b16 v[154:155], v188 offset:20944
    ds_read_b128 v[180:183], v195 offset:2048
    v_mfma_f32_16x16x32_bf16 v[84:87], v[156:159], v[168:171], v[84:87]
    ds_read_b64_tr_b16 v[156:157], v188 offset:18672
    s_waitcnt lgkmcnt(9)
    v_mfma_f32_16x16x32_bf16 v[68:71], v[160:163], v[164:167], v[68:71]
    ds_read_b64_tr_b16 v[158:159], v188 offset:20976
    ds_read_b128 v[184:187], v199 offset:0
    v_mfma_f32_16x16x32_bf16 v[88:91], v[160:163], v[168:171], v[88:91]
    v_mfma_f32_16x16x32_bf16 v[140:143], v[160:163], v[172:175], v[140:143]
    ds_read_b64_tr_b16 v[160:161], v188 offset:18704
    s_waitcnt lgkmcnt(10)
    v_mfma_f32_16x16x32_bf16 v[92:95], v[164:167], v[144:147], v[92:95]
    ds_read_b64_tr_b16 v[162:163], v188 offset:21008
    v_mfma_f32_16x16x32_bf16 v[112:115], v[168:171], v[144:147], v[112:115]
    v_mfma_f32_16x16x32_bf16 v[136:139], v[172:175], v[144:147], v[136:139]
    ds_read_b64_tr_b16 v[144:145], v189 offset:36864
    s_waitcnt lgkmcnt(10)
    v_mfma_f32_16x16x32_bf16 v[96:99], v[164:167], v[148:151], v[96:99]
    ds_read_b64_tr_b16 v[146:147], v189 offset:38144
    v_mfma_f32_16x16x32_bf16 v[116:119], v[168:171], v[148:151], v[116:119]
    ds_read_b64_tr_b16 v[148:149], v189 offset:36896
    s_waitcnt lgkmcnt(9)
    v_mfma_f32_16x16x32_bf16 v[100:103], v[164:167], v[152:155], v[100:103]
    ds_read_b64_tr_b16 v[150:151], v189 offset:38176
    v_mfma_f32_16x16x32_bf16 v[120:123], v[168:171], v[152:155], v[120:123]
    ds_read_b64_tr_b16 v[152:153], v189 offset:36928
    s_waitcnt lgkmcnt(8)
    v_mfma_f32_16x16x32_bf16 v[104:107], v[164:167], v[156:159], v[104:107]
    ds_read_b64_tr_b16 v[154:155], v189 offset:38208
    v_mfma_f32_16x16x32_bf16 v[124:127], v[168:171], v[156:159], v[124:127]
    ds_read_b64_tr_b16 v[156:157], v189 offset:36960
    s_waitcnt lgkmcnt(7)
    v_mfma_f32_16x16x32_bf16 v[108:111], v[164:167], v[160:163], v[108:111]
    ds_read_b64_tr_b16 v[158:159], v189 offset:38240
    v_mfma_f32_16x16x32_bf16 v[128:131], v[168:171], v[160:163], v[128:131]
    ds_read_b64_tr_b16 v[160:161], v189 offset:36992
    s_waitcnt lgkmcnt(7)
    v_mfma_f32_16x16x32_bf16 v[12:15], v[144:147], v[164:167], v[12:15]
    ds_read_b64_tr_b16 v[162:163], v189 offset:38272
    v_mfma_f32_16x16x32_bf16 v[32:35], v[144:147], v[168:171], v[32:35]
    ds_read_b64_tr_b16 v[144:145], v188 offset:27648
    s_waitcnt lgkmcnt(7)
    v_mfma_f32_16x16x32_bf16 v[16:19], v[148:151], v[164:167], v[16:19]
    ds_read_b64_tr_b16 v[146:147], v188 offset:29952
    v_mfma_f32_16x16x32_bf16 v[36:39], v[148:151], v[168:171], v[36:39]
    ds_read_b64_tr_b16 v[148:149], v188 offset:27680
    s_waitcnt lgkmcnt(7)
    v_mfma_f32_16x16x32_bf16 v[20:23], v[152:155], v[164:167], v[20:23]
    ds_read_b64_tr_b16 v[150:151], v188 offset:29984
    v_mfma_f32_16x16x32_bf16 v[40:43], v[152:155], v[168:171], v[40:43]
    ds_read_b64_tr_b16 v[152:153], v188 offset:27712
    s_waitcnt lgkmcnt(7)
    v_mfma_f32_16x16x32_bf16 v[24:27], v[156:159], v[164:167], v[24:27]
    ds_read_b64_tr_b16 v[154:155], v188 offset:30016
    v_mfma_f32_16x16x32_bf16 v[44:47], v[156:159], v[168:171], v[44:47]
    ds_read_b64_tr_b16 v[156:157], v188 offset:27744
    s_waitcnt lgkmcnt(7)
    v_mfma_f32_16x16x32_bf16 v[28:31], v[160:163], v[164:167], v[28:31]
    ds_read_b64_tr_b16 v[158:159], v188 offset:30048
    v_mfma_f32_16x16x32_bf16 v[48:51], v[160:163], v[168:171], v[48:51]
    ds_read_b64_tr_b16 v[160:161], v188 offset:27776
    s_waitcnt lgkmcnt(7)
    v_mfma_f32_16x16x32_bf16 v[52:55], v[144:147], v[176:179], v[52:55]
    ds_read_b64_tr_b16 v[162:163], v188 offset:30080
    v_mfma_f32_16x16x32_bf16 v[72:75], v[144:147], v[180:183], v[72:75]
    v_mfma_f32_16x16x32_bf16 v[132:135], v[144:147], v[184:187], v[132:135]
    ds_read_b64_tr_b16 v[144:145], v188 offset:27792
    s_waitcnt lgkmcnt(7)
    v_mfma_f32_16x16x32_bf16 v[56:59], v[148:151], v[176:179], v[56:59]
    ds_read_b64_tr_b16 v[146:147], v188 offset:30096
    v_mfma_f32_16x16x32_bf16 v[76:79], v[148:151], v[180:183], v[76:79]
    ds_read_b64_tr_b16 v[148:149], v188 offset:27824
    s_waitcnt lgkmcnt(7)
    v_mfma_f32_16x16x32_bf16 v[60:63], v[152:155], v[176:179], v[60:63]
    ds_read_b64_tr_b16 v[150:151], v188 offset:30128
    v_mfma_f32_16x16x32_bf16 v[80:83], v[152:155], v[180:183], v[80:83]
    ds_read_b64_tr_b16 v[152:153], v188 offset:27856
    s_waitcnt lgkmcnt(7)
    v_mfma_f32_16x16x32_bf16 v[64:67], v[156:159], v[176:179], v[64:67]
    ds_read_b64_tr_b16 v[154:155], v188 offset:30160
    v_cvt_pk_bf16_f32 v190, v132, v133
    v_mfma_f32_16x16x32_bf16 v[84:87], v[156:159], v[180:183], v[84:87]
    ds_read_b64_tr_b16 v[156:157], v188 offset:27888
    s_waitcnt lgkmcnt(7)
    v_mfma_f32_16x16x32_bf16 v[68:71], v[160:163], v[176:179], v[68:71]
    ds_read_b64_tr_b16 v[158:159], v188 offset:30192
    v_cvt_pk_bf16_f32 v191, v134, v135
    v_mfma_f32_16x16x32_bf16 v[88:91], v[160:163], v[180:183], v[88:91]
    v_cvt_pk_bf16_f32 v202, v72, v73
    v_cvt_pk_bf16_f32 v203, v74, v75
    v_mfma_f32_16x16x32_bf16 v[140:143], v[160:163], v[184:187], v[140:143]
    ds_read_b64_tr_b16 v[160:161], v188 offset:27920
    s_waitcnt lgkmcnt(7)
    v_mfma_f32_16x16x32_bf16 v[92:95], v[176:179], v[144:147], v[92:95]
    ds_read_b64_tr_b16 v[162:163], v188 offset:30224
    v_cvt_pk_bf16_f32 v204, v76, v77
    v_mfma_f32_16x16x32_bf16 v[112:115], v[180:183], v[144:147], v[112:115]
    v_cvt_pk_bf16_f32 v205, v78, v79
    v_cvt_pk_bf16_f32 v206, v80, v81
    v_mfma_f32_16x16x32_bf16 v[136:139], v[184:187], v[144:147], v[136:139]
    ds_read_b64_tr_b16 v[144:145], v189 offset:41984
    s_waitcnt lgkmcnt(7)
    v_mfma_f32_16x16x32_bf16 v[96:99], v[176:179], v[148:151], v[96:99]
    ds_read_b64_tr_b16 v[146:147], v189 offset:43264
    v_cvt_pk_bf16_f32 v207, v82, v83
    v_mfma_f32_16x16x32_bf16 v[116:119], v[180:183], v[148:151], v[116:119]
    ds_read_b64_tr_b16 v[148:149], v189 offset:42016
    s_waitcnt lgkmcnt(7)
    v_mfma_f32_16x16x32_bf16 v[100:103], v[176:179], v[152:155], v[100:103]
    ds_read_b64_tr_b16 v[150:151], v189 offset:43296
    v_cvt_pk_bf16_f32 v208, v84, v85
    v_mfma_f32_16x16x32_bf16 v[120:123], v[180:183], v[152:155], v[120:123]
    ds_read_b64_tr_b16 v[152:153], v189 offset:42048
    s_waitcnt lgkmcnt(7)
    v_mfma_f32_16x16x32_bf16 v[104:107], v[176:179], v[156:159], v[104:107]
    ds_read_b64_tr_b16 v[154:155], v189 offset:43328
    v_cvt_pk_bf16_f32 v209, v86, v87
    v_mfma_f32_16x16x32_bf16 v[124:127], v[180:183], v[156:159], v[124:127]
    ds_read_b64_tr_b16 v[156:157], v189 offset:42080
    s_waitcnt lgkmcnt(7)
    v_mfma_f32_16x16x32_bf16 v[108:111], v[176:179], v[160:163], v[108:111]
    ds_read_b64_tr_b16 v[158:159], v189 offset:43360
    v_cvt_pk_bf16_f32 v196, v140, v141
    v_mfma_f32_16x16x32_bf16 v[128:131], v[180:183], v[160:163], v[128:131]
    ds_read_b64_tr_b16 v[160:161], v189 offset:42112
    s_waitcnt lgkmcnt(7)
    v_mfma_f32_16x16x32_bf16 v[12:15], v[144:147], v[176:179], v[12:15]
    ds_read_b64_tr_b16 v[162:163], v189 offset:43392
    v_cvt_pk_bf16_f32 v197, v142, v143
    v_mfma_f32_16x16x32_bf16 v[32:35], v[144:147], v[180:183], v[32:35]
    v_cvt_pk_bf16_f32 v210, v88, v89
    s_waitcnt lgkmcnt(6)
    v_mfma_f32_16x16x32_bf16 v[16:19], v[148:151], v[176:179], v[16:19]
    v_cvt_pk_bf16_f32 v211, v90, v91
    v_cvt_pk_bf16_f32 v192, v136, v137
    v_mfma_f32_16x16x32_bf16 v[36:39], v[148:151], v[180:183], v[36:39]
    v_cvt_pk_bf16_f32 v193, v138, v139
    s_waitcnt lgkmcnt(4)
    v_mfma_f32_16x16x32_bf16 v[20:23], v[152:155], v[176:179], v[20:23]
    v_cvt_pk_bf16_f32 v216, v112, v113
    v_cvt_pk_bf16_f32 v217, v114, v115
    v_mfma_f32_16x16x32_bf16 v[40:43], v[152:155], v[180:183], v[40:43]
    v_cvt_pk_bf16_f32 v222, v116, v117
    s_waitcnt lgkmcnt(2)
    v_mfma_f32_16x16x32_bf16 v[24:27], v[156:159], v[176:179], v[24:27]
    v_cvt_pk_bf16_f32 v223, v118, v119
    v_cvt_pk_bf16_f32 v228, v120, v121
    v_mfma_f32_16x16x32_bf16 v[44:47], v[156:159], v[180:183], v[44:47]
    v_cvt_pk_bf16_f32 v229, v122, v123
    s_waitcnt lgkmcnt(0)
    v_mfma_f32_16x16x32_bf16 v[28:31], v[160:163], v[176:179], v[28:31]
    v_cvt_pk_bf16_f32 v234, v124, v125
    v_cvt_pk_bf16_f32 v235, v126, v127
    v_mfma_f32_16x16x32_bf16 v[48:51], v[160:163], v[180:183], v[48:51]
    s_waitcnt vmcnt(0)
    ds_write_b64 v6, v[190:191] offset:0
    v_cvt_pk_bf16_f32 v240, v128, v129
    ds_write_b128 v4, v[202:205]
    v_cvt_pk_bf16_f32 v241, v130, v131
    ds_write_b128 v4, v[206:209] offset:1024
    v_cvt_pk_bf16_f32 v144, v52, v53
    ds_write_b64 v7, v[196:197] offset:2048
    v_cvt_pk_bf16_f32 v145, v54, v55
    ds_write_b64 v5, v[210:211] offset:2048
    v_cvt_pk_bf16_f32 v146, v56, v57
    ds_write_b64 v7, v[192:193] offset:2560
    v_cvt_pk_bf16_f32 v147, v58, v59
    ds_write_b64 v5, v[216:217] offset:2560
    v_cvt_pk_bf16_f32 v148, v60, v61
    ds_write_b64 v5, v[222:223] offset:3072
    v_cvt_pk_bf16_f32 v149, v62, v63
    ds_write_b64 v5, v[228:229] offset:3584
    v_cvt_pk_bf16_f32 v150, v64, v65
    ds_write_b64 v5, v[234:235] offset:4096
    v_cvt_pk_bf16_f32 v151, v66, v67
    ds_write_b64 v5, v[240:241] offset:4608
    v_cvt_pk_bf16_f32 v152, v68, v69
    v_cvt_pk_bf16_f32 v153, v70, v71
    v_cvt_pk_bf16_f32 v164, v12, v13
    v_cvt_pk_bf16_f32 v165, v14, v15
    v_cvt_pk_bf16_f32 v166, v16, v17
    v_cvt_pk_bf16_f32 v167, v18, v19
    s_waitcnt lgkmcnt(0)
    ds_add_u32 v8, v9 offset:40
    v_cvt_pk_bf16_f32 v168, v20, v21
    v_cvt_pk_bf16_f32 v169, v22, v23
    v_cvt_pk_bf16_f32 v170, v24, v25
    v_cvt_pk_bf16_f32 v171, v26, v27
    v_cvt_pk_bf16_f32 v172, v28, v29
    v_cvt_pk_bf16_f32 v173, v30, v31
    v_cvt_pk_bf16_f32 v174, v32, v33
    v_cvt_pk_bf16_f32 v175, v34, v35
    v_cvt_pk_bf16_f32 v176, v36, v37
    v_cvt_pk_bf16_f32 v177, v38, v39
    v_cvt_pk_bf16_f32 v178, v40, v41
    v_cvt_pk_bf16_f32 v179, v42, v43
    v_cvt_pk_bf16_f32 v180, v44, v45
    v_cvt_pk_bf16_f32 v181, v46, v47
    v_cvt_pk_bf16_f32 v182, v48, v49
    v_cvt_pk_bf16_f32 v183, v50, v51
    s_branch L_akx
L_ak1:
    s_mov_b32 s67, 0
    s_mov_b32 s66, 0
    v_add_u32 v190, 0, v192
    v_add_u32 v191, 0, v193
    v_add_u32 v194, 0, v196
    v_add_u32 v195, 0, v197
    v_add_u32 v198, 0, v200
    v_add_u32 v199, 0, v201
    v_mov_b32 v188, v190
    v_mov_b32 v189, v191
    s_barrier
    ds_read_b128 v[164:167], v194 offset:0
    ds_read_b64_tr_b16 v[144:145], v188 offset:18432
    ds_read_b64_tr_b16 v[146:147], v188 offset:20736
    ds_read_b128 v[168:171], v194 offset:2048
    ds_read_b128 v[172:175], v198 offset:0
    ds_read_b64_tr_b16 v[148:149], v188 offset:18464
    ds_read_b64_tr_b16 v[150:151], v188 offset:20768
    ds_read_b64_tr_b16 v[152:153], v188 offset:18496
    ds_read_b64_tr_b16 v[154:155], v188 offset:20800
    ds_read_b64_tr_b16 v[156:157], v188 offset:18528
    ds_read_b64_tr_b16 v[158:159], v188 offset:20832
L_kl_a1:
    ds_read_b64_tr_b16 v[160:161], v188 offset:18560
    s_waitcnt lgkmcnt(7)
    v_mfma_f32_16x16x32_bf16 v[52:55], v[144:147], v[164:167], v[52:55]
    ds_read_b64_tr_b16 v[162:163], v188 offset:20864
    s_add_u32 s42, s67, 47104
    v_mfma_f32_16x16x32_bf16 v[72:75], v[144:147], v[168:171], v[72:75]
    ds_read_b64_tr_b16 v[144:145], v188 offset:18576
    s_waitcnt lgkmcnt(7)
    v_mfma_f32_16x16x32_bf16 v[56:59], v[148:151], v[164:167], v[56:59]
    ds_read_b64_tr_b16 v[146:147], v188 offset:20880
    s_cmp_eq_u32 s67, 94208
    v_mfma_f32_16x16x32_bf16 v[76:79], v[148:151], v[168:171], v[76:79]
    v_mfma_f32_16x16x32_bf16 v[132:135], v[148:151], v[172:175], v[132:135]
    ds_read_b64_tr_b16 v[148:149], v188 offset:18608
    s_waitcnt lgkmcnt(7)
    v_mfma_f32_16x16x32_bf16 v[60:63], v[152:155], v[164:167], v[60:63]
    ds_read_b64_tr_b16 v[150:151], v188 offset:20912
    ds_read_b128 v[176:179], v195 offset:0
    v_mfma_f32_16x16x32_bf16 v[80:83], v[152:155], v[168:171], v[80:83]
    ds_read_b64_tr_b16 v[152:153], v188 offset:18640
    s_waitcnt lgkmcnt(8)
    v_mfma_f32_16x16x32_bf16 v[64:67], v[156:159], v[164:167], v[64:67]
    ds_read_b64_tr_b16 v[154:155], v188 offset:20944
    ds_read_b128 v[180:183], v195 offset:2048
    v_mfma_f32_16x16x32_bf16 v[84:87], v[156:159], v[168:171], v[84:87]
    ds_read_b64_tr_b16 v[156:157], v188 offset:18672
    s_waitcnt lgkmcnt(9)
    v_mfma_f32_16x16x32_bf16 v[68:71], v[160:163], v[164:167], v[68:71]
    ds_read_b64_tr_b16 v[158:159], v188 offset:20976
    ds_read_b128 v[184:187], v199 offset:0
    v_mfma_f32_16x16x32_bf16 v[88:91], v[160:163], v[168:171], v[88:91]
    ds_read_b64_tr_b16 v[160:161], v188 offset:18704
    s_waitcnt lgkmcnt(10)
    v_mfma_f32_16x16x32_bf16 v[92:95], v[164:167], v[144:147], v[92:95]
    ds_read_b64_tr_b16 v[162:163], v188 offset:21008
    s_cselect_b32 s67, 0, s42
    v_mfma_f32_16x16x32_bf16 v[112:115], v[168:171], v[144:147], v[112:115]
    ds_read_b64_tr_b16 v[144:145], v189 offset:36864
    s_waitcnt lgkmcnt(10)
    v_mfma_f32_16x16x32_bf16 v[96:99], v[164:167], v[148:151], v[96:99]
    ds_read_b64_tr_b16 v[146:147], v189 offset:38144
    v_add_u32 v190, s67, v192
    v_mfma_f32_16x16x32_bf16 v[116:119], v[168:171], v[148:151], v[116:119]
    v_mfma_f32_16x16x32_bf16 v[136:139], v[172:175], v[148:151], v[136:139]
    ds_read_b64_tr_b16 v[148:149], v189 offset:36896
    s_waitcnt lgkmcnt(9)
    v_mfma_f32_16x16x32_bf16 v[100:103], v[164:167], v[152:155], v[100:103]
    ds_read_b64_tr_b16 v[150:151], v189 offset:38176
    v_add_u32 v191, s67, v193
    v_mfma_f32_16x16x32_bf16 v[120:123], v[168:171], v[152:155], v[120:123]
    ds_read_b64_tr_b16 v[152:153], v189 offset:36928
    s_waitcnt lgkmcnt(8)
    v_mfma_f32_16x16x32_bf16 v[104:107], v[164:167], v[156:159], v[104:107]
    ds_read_b64_tr_b16 v[154:155], v189 offset:38208
    v_add_u32 v194, s67, v196
    v_mfma_f32_16x16x32_bf16 v[124:127], v[168:171], v[156:159], v[124:127]
    ds_read_b64_tr_b16 v[156:157], v189 offset:36960
    s_waitcnt lgkmcnt(7)
    v_mfma_f32_16x16x32_bf16 v[108:111], v[164:167], v[160:163], v[108:111]
    ds_read_b64_tr_b16 v[158:159], v189 offset:38240
    v_add_u32 v195, s67, v197
    v_mfma_f32_16x16x32_bf16 v[128:131], v[168:171], v[160:163], v[128:131]
    v_mfma_f32_16x16x32_bf16 v[140:143], v[172:175], v[160:163], v[140:143]
    ds_read_b64_tr_b16 v[160:161], v189 offset:36992
    s_waitcnt lgkmcnt(7)
    v_mfma_f32_16x16x32_bf16 v[12:15], v[144:147], v[164:167], v[12:15]
    ds_read_b64_tr_b16 v[162:163], v189 offset:38272
    v_add_u32 v198, s67, v200
    v_mfma_f32_16x16x32_bf16 v[32:35], v[144:147], v[168:171], v[32:35]
    ds_read_b64_tr_b16 v[144:145], v188 offset:27648
    s_waitcnt lgkmcnt(7)
    v_mfma_f32_16x16x32_bf16 v[16:19], v[148:151], v[164:167], v[16:19]
    ds_read_b64_tr_b16 v[146:147], v188 offset:29952
    v_add_u32 v199, s67, v201
    v_mfma_f32_16x16x32_bf16 v[36:39], v[148:151], v[168:171], v[36:39]
    ds_read_b64_tr_b16 v[148:149], v188 offset:27680
    s_waitcnt lgkmcnt(7)
    v_mfma_f32_16x16x32_bf16 v[20:23], v[152:155], v[164:167], v[20:23]
    ds_read_b64_tr_b16 v[150:151], v188 offset:29984
    s_add_u32 s66, s66, 1
    v_mfma_f32_16x16x32_bf16 v[40:43], v[152:155], v[168:171], v[40:43]
    ds_read_b64_tr_b16 v[152:153], v188 offset:27712
    s_waitcnt lgkmcnt(7)
    v_mfma_f32_16x16x32_bf16 v[24:27], v[156:159], v[164:167], v[24:27]
    ds_read_b64_tr_b16 v[154:155], v188 offset:30016
    s_cmp_lt_u32 s66, 8
    v_mfma_f32_16x16x32_bf16 v[44:47], v[156:159], v[168:171], v[44:47]
    ds_read_b64_tr_b16 v[156:157], v188 offset:27744
    s_waitcnt lgkmcnt(7)
    v_mfma_f32_16x16x32_bf16 v[28:31], v[160:163], v[164:167], v[28:31]
    ds_read_b64_tr_b16 v[158:159], v188 offset:30048
    s_cbranch_vccnz L_id_a1
L_ir_a1:
    v_mfma_f32_16x16x32_bf16 v[48:51], v[160:163], v[168:171], v[48:51]
    ds_read_b64_tr_b16 v[160:161], v188 offset:27776
    s_waitcnt lgkmcnt(7)
    v_mfma_f32_16x16x32_bf16 v[52:55], v[144:147], v[176:179], v[52:55]
    ds_read_b64_tr_b16 v[162:163], v188 offset:30080
    v_mfma_f32_16x16x32_bf16 v[72:75], v[144:147], v[180:183], v[72:75]
    ds_read_b64_tr_b16 v[144:145], v188 offset:27792
    s_waitcnt lgkmcnt(7)
    v_mfma_f32_16x16x32_bf16 v[56:59], v[148:151], v[176:179], v[56:59]
    ds_read_b64_tr_b16 v[146:147], v188 offset:30096
    v_mfma_f32_16x16x32_bf16 v[76:79], v[148:151], v[180:183], v[76:79]
    v_mfma_f32_16x16x32_bf16 v[132:135], v[148:151], v[184:187], v[132:135]
    ds_read_b64_tr_b16 v[148:149], v188 offset:27824
    s_waitcnt lgkmcnt(7)
    v_mfma_f32_16x16x32_bf16 v[60:63], v[152:155], v[176:179], v[60:63]
    ds_read_b64_tr_b16 v[150:151], v188 offset:30128
    v_mfma_f32_16x16x32_bf16 v[80:83], v[152:155], v[180:183], v[80:83]
    ds_read_b64_tr_b16 v[152:153], v188 offset:27856
    s_waitcnt lgkmcnt(7)
    v_mfma_f32_16x16x32_bf16 v[64:67], v[156:159], v[176:179], v[64:67]
    ds_read_b64_tr_b16 v[154:155], v188 offset:30160
    v_mfma_f32_16x16x32_bf16 v[84:87], v[156:159], v[180:183], v[84:87]
    ds_read_b64_tr_b16 v[156:157], v188 offset:27888
    s_waitcnt lgkmcnt(7)
    v_mfma_f32_16x16x32_bf16 v[68:71], v[160:163], v[176:179], v[68:71]
    ds_read_b64_tr_b16 v[158:159], v188 offset:30192
    v_mfma_f32_16x16x32_bf16 v[88:91], v[160:163], v[180:183], v[88:91]
    ds_read_b64_tr_b16 v[160:161], v188 offset:27920
    s_waitcnt lgkmcnt(7)
    v_mfma_f32_16x16x32_bf16 v[92:95], v[176:179], v[144:147], v[92:95]
    ds_read_b64_tr_b16 v[162:163], v188 offset:30224
    v_mfma_f32_16x16x32_bf16 v[112:115], v[180:183], v[144:147], v[112:115]
    ds_read_b64_tr_b16 v[144:145], v189 offset:41984
    s_waitcnt lgkmcnt(7)
    v_mfma_f32_16x16x32_bf16 v[96:99], v[176:179], v[148:151], v[96:99]
    ds_read_b64_tr_b16 v[146:147], v189 offset:43264
    v_mfma_f32_16x16x32_bf16 v[116:119], v[180:183], v[148:151], v[116:119]
    v_mfma_f32_16x16x32_bf16 v[136:139], v[184:187], v[148:151], v[136:139]
    ds_read_b64_tr_b16 v[148:149], v189 offset:42016
    s_waitcnt lgkmcnt(7)
    v_mfma_f32_16x16x32_bf16 v[100:103], v[176:179], v[152:155], v[100:103]
    ds_read_b64_tr_b16 v[150:151], v189 offset:43296
    v_mfma_f32_16x16x32_bf16 v[120:123], v[180:183], v[152:155], v[120:123]
    ds_read_b64_tr_b16 v[152:153], v189 offset:42048
    s_waitcnt lgkmcnt(7)
    v_mfma_f32_16x16x32_bf16 v[104:107], v[176:179], v[156:159], v[104:107]
    ds_read_b64_tr_b16 v[154:155], v189 offset:43328
    v_mfma_f32_16x16x32_bf16 v[124:127], v[180:183], v[156:159], v[124:127]
    ds_read_b64_tr_b16 v[156:157], v189 offset:42080
    s_waitcnt lgkmcnt(7)
    v_mfma_f32_16x16x32_bf16 v[108:111], v[176:179], v[160:163], v[108:111]
    ds_read_b64_tr_b16 v[158:159], v189 offset:43360
    v_mfma_f32_16x16x32_bf16 v[128:131], v[180:183], v[160:163], v[128:131]
    v_mfma_f32_16x16x32_bf16 v[140:143], v[184:187], v[160:163], v[140:143]
    ds_read_b64_tr_b16 v[160:161], v189 offset:42112
    s_waitcnt lgkmcnt(7)
    v_mfma_f32_16x16x32_bf16 v[12:15], v[144:147], v[176:179], v[12:15]
    ds_read_b64_tr_b16 v[162:163], v189 offset:43392
    v_mfma_f32_16x16x32_bf16 v[32:35], v[144:147], v[180:183], v[32:35]
    s_waitcnt lgkmcnt(6)
    v_mfma_f32_16x16x32_bf16 v[16:19], v[148:151], v[176:179], v[16:19]
    v_mfma_f32_16x16x32_bf16 v[36:39], v[148:151], v[180:183], v[36:39]
    s_waitcnt lgkmcnt(4)
    v_mfma_f32_16x16x32_bf16 v[20:23], v[152:155], v[176:179], v[20:23]
    s_waitcnt lgkmcnt(0)
    s_barrier
    v_mfma_f32_16x16x32_bf16 v[40:43], v[152:155], v[180:183], v[40:43]
    ds_read_b128 v[164:167], v194 offset:0
    ds_read_b64_tr_b16 v[144:145], v190 offset:18432
    ds_read_b64_tr_b16 v[146:147], v190 offset:20736
    v_mfma_f32_16x16x32_bf16 v[24:27], v[156:159], v[176:179], v[24:27]
    ds_read_b128 v[168:171], v194 offset:2048
    ds_read_b128 v[172:175], v198 offset:0
    ds_read_b64_tr_b16 v[148:149], v190 offset:18464
    v_mfma_f32_16x16x32_bf16 v[44:47], v[156:159], v[180:183], v[44:47]
    ds_read_b64_tr_b16 v[150:151], v190 offset:20768
    ds_read_b64_tr_b16 v[152:153], v190 offset:18496
    ds_read_b64_tr_b16 v[154:155], v190 offset:20800
    v_mfma_f32_16x16x32_bf16 v[28:31], v[160:163], v[176:179], v[28:31]
    ds_read_b64_tr_b16 v[156:157], v190 offset:18528
    ds_read_b64_tr_b16 v[158:159], v190 offset:20832
    v_mov_b32 v188, v190
    v_mfma_f32_16x16x32_bf16 v[48:51], v[160:163], v[180:183], v[48:51]
    v_mov_b32 v189, v191
    s_cbranch_scc1 L_kl_a1
    ds_read_b64_tr_b16 v[160:161], v188 offset:18560
    s_waitcnt lgkmcnt(7)
    v_mfma_f32_16x16x32_bf16 v[52:55], v[144:147], v[164:167], v[52:55]
    ds_read_b64_tr_b16 v[162:163], v188 offset:20864
    v_mfma_f32_16x16x32_bf16 v[72:75], v[144:147], v[168:171], v[72:75]
    ds_read_b64_tr_b16 v[144:145], v188 offset:18576
    s_waitcnt lgkmcnt(7)
    v_mfma_f32_16x16x32_bf16 v[56:59], v[148:151], v[164:167], v[56:59]
    ds_read_b64_tr_b16 v[146:147], v188 offset:20880
    v_mfma_f32_16x16x32_bf16 v[76:79], v[148:151], v[168:171], v[76:79]
    v_mfma_f32_16x16x32_bf16 v[132:135], v[148:151], v[172:175], v[132:135]
    ds_read_b64_tr_b16 v[148:149], v188 offset:18608
    s_waitcnt lgkmcnt(7)
    v_mfma_f32_16x16x32_bf16 v[60:63], v[152:155], v[164:167], v[60:63]
    ds_read_b64_tr_b16 v[150:151], v188 offset:20912
    ds_read_b128 v[176:179], v195 offset:0
    v_mfma_f32_16x16x32_bf16 v[80:83], v[152:155], v[168:171], v[80:83]
    ds_read_b64_tr_b16 v[152:153], v188 offset:18640
    s_waitcnt lgkmcnt(8)
    v_mfma_f32_16x16x32_bf16 v[64:67], v[156:159], v[164:167], v[64:67]
    ds_read_b64_tr_b16 v[154:155], v188 offset:20944
    ds_read_b128 v[180:183], v195 offset:2048
    v_mfma_f32_16x16x32_bf16 v[84:87], v[156:159], v[168:171], v[84:87]
    ds_read_b64_tr_b16 v[156:157], v188 offset:18672
    s_waitcnt lgkmcnt(9)
    v_mfma_f32_16x16x32_bf16 v[68:71], v[160:163], v[164:167], v[68:71]
    ds_read_b64_tr_b16 v[158:159], v188 offset:20976
    ds_read_b128 v[184:187], v199 offset:0
    v_mfma_f32_16x16x32_bf16 v[88:91], v[160:163], v[168:171], v[88:91]
    ds_read_b64_tr_b16 v[160:161], v188 offset:18704
    s_waitcnt lgkmcnt(10)
    v_mfma_f32_16x16x32_bf16 v[92:95], v[164:167], v[144:147], v[92:95]
    ds_read_b64_tr_b16 v[162:163], v188 offset:21008
    v_mfma_f32_16x16x32_bf16 v[112:115], v[168:171], v[144:147], v[112:115]
    ds_read_b64_tr_b16 v[144:145], v189 offset:36864
    s_waitcnt lgkmcnt(10)
    v_mfma_f32_16x16x32_bf16 v[96:99], v[164:167], v[148:151], v[96:99]
    ds_read_b64_tr_b16 v[146:147], v189 offset:38144
    v_mfma_f32_16x16x32_bf16 v[116:119], v[168:171], v[148:151], v[116:119]
    v_mfma_f32_16x16x32_bf16 v[136:139], v[172:175], v[148:151], v[136:139]
    ds_read_b64_tr_b16 v[148:149], v189 offset:36896
    s_waitcnt lgkmcnt(9)
    v_mfma_f32_16x16x32_bf16 v[100:103], v[164:167], v[152:155], v[100:103]
    ds_read_b64_tr_b16 v[150:151], v189 offset:38176
    v_mfma_f32_16x16x32_bf16 v[120:123], v[168:171], v[152:155], v[120:123]
    ds_read_b64_tr_b16 v[152:153], v189 offset:36928
    s_waitcnt lgkmcnt(8)
    v_mfma_f32_16x16x32_bf16 v[104:107], v[164:167], v[156:159], v[104:107]
    ds_read_b64_tr_b16 v[154:155], v189 offset:38208
    v_mfma_f32_16x16x32_bf16 v[124:127], v[168:171], v[156:159], v[124:127]
    ds_read_b64_tr_b16 v[156:157], v189 offset:36960
    s_waitcnt lgkmcnt(7)
    v_mfma_f32_16x16x32_bf16 v[108:111], v[164:167], v[160:163], v[108:111]
    ds_read_b64_tr_b16 v[158:159], v189 offset:38240
    v_mfma_f32_16x16x32_bf16 v[128:131], v[168:171], v[160:163], v[128:131]
    v_mfma_f32_16x16x32_bf16 v[140:143], v[172:175], v[160:163], v[140:143]
    ds_read_b64_tr_b16 v[160:161], v189 offset:36992
    s_waitcnt lgkmcnt(7)
    v_mfma_f32_16x16x32_bf16 v[12:15], v[144:147], v[164:167], v[12:15]
    ds_read_b64_tr_b16 v[162:163], v189 offset:38272
    v_mfma_f32_16x16x32_bf16 v[32:35], v[144:147], v[168:171], v[32:35]
    ds_read_b64_tr_b16 v[144:145], v188 offset:27648
    s_waitcnt lgkmcnt(7)
    v_mfma_f32_16x16x32_bf16 v[16:19], v[148:151], v[164:167], v[16:19]
    ds_read_b64_tr_b16 v[146:147], v188 offset:29952
    v_mfma_f32_16x16x32_bf16 v[36:39], v[148:151], v[168:171], v[36:39]
    ds_read_b64_tr_b16 v[148:149], v188 offset:27680
    s_waitcnt lgkmcnt(7)
    v_mfma_f32_16x16x32_bf16 v[20:23], v[152:155], v[164:167], v[20:23]
    ds_read_b64_tr_b16 v[150:151], v188 offset:29984
    v_mfma_f32_16x16x32_bf16 v[40:43], v[152:155], v[168:171], v[40:43]
    ds_read_b64_tr_b16 v[152:153], v188 offset:27712
    s_waitcnt lgkmcnt(7)
    v_mfma_f32_16x16x32_bf16 v[24:27], v[156:159], v[164:167], v[24:27]
    ds_read_b64_tr_b16 v[154:155], v188 offset:30016
    v_mfma_f32_16x16x32_bf16 v[44:47], v[156:159], v[168:171], v[44:47]
    ds_read_b64_tr_b16 v[156:157], v188 offset:27744
    s_waitcnt lgkmcnt(7)
    v_mfma_f32_16x16x32_bf16 v[28:31], v[160:163], v[164:167], v[28:31]
    ds_read_b64_tr_b16 v[158:159], v188 offset:30048
    v_mfma_f32_16x16x32_bf16 v[48:51], v[160:163], v[168:171], v[48:51]
    ds_read_b64_tr_b16 v[160:161], v188 offset:27776
    s_waitcnt lgkmcnt(7)
    v_mfma_f32_16x16x32_bf16 v[52:55], v[144:147], v[176:179], v[52:55]
    ds_read_b64_tr_b16 v[162:163], v188 offset:30080
    v_mfma_f32_16x16x32_bf16 v[72:75], v[144:147], v[180:183], v[72:75]
    ds_read_b64_tr_b16 v[144:145], v188 offset:27792
    s_waitcnt lgkmcnt(7)
    v_mfma_f32_16x16x32_bf16 v[56:59], v[148:151], v[176:179], v[56:59]
    ds_read_b64_tr_b16 v[146:147], v188 offset:30096
    v_mfma_f32_16x16x32_bf16 v[76:79], v[148:151], v[180:183], v[76:79]
    v_mfma_f32_16x16x32_bf16 v[132:135], v[148:151], v[184:187], v[132:135]
    ds_read_b64_tr_b16 v[148:149], v188 offset:27824
    s_waitcnt lgkmcnt(7)
    v_mfma_f32_16x16x32_bf16 v[60:63], v[152:155], v[176:179], v[60:63]
    ds_read_b64_tr_b16 v[150:151], v188 offset:30128
    v_mfma_f32_16x16x32_bf16 v[80:83], v[152:155], v[180:183], v[80:83]
    ds_read_b64_tr_b16 v[152:153], v188 offset:27856
    s_waitcnt lgkmcnt(7)
    v_mfma_f32_16x16x32_bf16 v[64:67], v[156:159], v[176:179], v[64:67]
    ds_read_b64_tr_b16 v[154:155], v188 offset:30160
    v_cvt_pk_bf16_f32 v202, v72, v73
    v_mfma_f32_16x16x32_bf16 v[84:87], v[156:159], v[180:183], v[84:87]
    ds_read_b64_tr_b16 v[156:157], v188 offset:27888
    s_waitcnt lgkmcnt(7)
    v_mfma_f32_16x16x32_bf16 v[68:71], v[160:163], v[176:179], v[68:71]
    ds_read_b64_tr_b16 v[158:159], v188 offset:30192
    v_cvt_pk_bf16_f32 v203, v74, v75
    v_mfma_f32_16x16x32_bf16 v[88:91], v[160:163], v[180:183], v[88:91]
    ds_read_b64_tr_b16 v[160:161], v188 offset:27920
    s_waitcnt lgkmcnt(7)
    v_mfma_f32_16x16x32_bf16 v[92:95], v[176:179], v[144:147], v[92:95]
    ds_read_b64_tr_b16 v[162:163], v188 offset:30224
    v_cvt_pk_bf16_f32 v190, v132, v133
    v_mfma_f32_16x16x32_bf16 v[112:115], v[180:183], v[144:147], v[112:115]
    ds_read_b64_tr_b16 v[144:145], v189 offset:41984
    s_waitcnt lgkmcnt(7)
    v_mfma_f32_16x16x32_bf16 v[96:99], v[176:179], v[148:151], v[96:99]
    ds_read_b64_tr_b16 v[146:147], v189 offset:43264
    v_cvt_pk_bf16_f32 v191, v134, v135
    v_mfma_f32_16x16x32_bf16 v[116:119], v[180:183], v[148:151], v[116:119]
    v_cvt_pk_bf16_f32 v204, v76, v77
    v_cvt_pk_bf16_f32 v205, v78, v79
    v_mfma_f32_16x16x32_bf16 v[136:139], v[184:187], v[148:151], v[136:139]
    ds_read_b64_tr_b16 v[148:149], v189 offset:42016
    s_waitcnt lgkmcnt(7)
    v_mfma_f32_16x16x32_bf16 v[100:103], v[176:179], v[152:155], v[100:103]
    ds_read_b64_tr_b16 v[150:151], v189 offset:43296
    v_cvt_pk_bf16_f32 v206, v80, v81
    v_mfma_f32_16x16x32_bf16 v[120:123], v[180:183], v[152:155], v[120:123]
    ds_read_b64_tr_b16 v[152:153], v189 offset:42048
    s_waitcnt lgkmcnt(7)
    v_mfma_f32_16x16x32_bf16 v[104:107], v[176:179], v[156:159], v[104:107]
    ds_read_b64_tr_b16 v[154:155], v189 offset:43328
    v_cvt_pk_bf16_f32 v207, v82, v83
    v_mfma_f32_16x16x32_bf16 v[124:127], v[180:183], v[156:159], v[124:127]
    ds_read_b64_tr_b16 v[156:157], v189 offset:42080
    s_waitcnt lgkmcnt(7)
    v_mfma_f32_16x16x32_bf16 v[108:111], v[176:179], v[160:163], v[108:111]
    ds_read_b64_tr_b16 v[158:159], v189 offset:43360
    v_cvt_pk_bf16_f32 v208, v84, v85
    v_mfma_f32_16x16x32_bf16 v[128:131], v[180:183], v[160:163], v[128:131]
    v_cvt_pk_bf16_f32 v209, v86, v87
    v_cvt_pk_bf16_f32 v210, v88, v89
    v_mfma_f32_16x16x32_bf16 v[140:143], v[184:187], v[160:163], v[140:143]
    ds_read_b64_tr_b16 v[160:161], v189 offset:42112
    s_waitcnt lgkmcnt(7)
    v_mfma_f32_16x16x32_bf16 v[12:15], v[144:147], v[176:179], v[12:15]
    ds_read_b64_tr_b16 v[162:163], v189 offset:43392
    v_cvt_pk_bf16_f32 v211, v90, v91
    v_mfma_f32_16x16x32_bf16 v[32:35], v[144:147], v[180:183], v[32:35]
    v_cvt_pk_bf16_f32 v216, v112, v113
    s_waitcnt lgkmcnt(6)
    v_mfma_f32_16x16x32_bf16 v[16:19], v[148:151], v[176:179], v[16:19]
    v_cvt_pk_bf16_f32 v217, v114, v115
    v_cvt_pk_bf16_f32 v192, v136, v137
    v_mfma_f32_16x16x32_bf16 v[36:39], v[148:151], v[180:183], v[36:39]
    v_cvt_pk_bf16_f32 v193, v138, v139
    s_waitcnt lgkmcnt(4)
    v_mfma_f32_16x16x32_bf16 v[20:23], v[152:155], v[176:179], v[20:23]
    v_cvt_pk_bf16_f32 v222, v116, v117
    v_cvt_pk_bf16_f32 v223, v118, v119
    v_mfma_f32_16x16x32_bf16 v[40:43], v[152:155], v[180:183], v[40:43]
    v_cvt_pk_bf16_f32 v228, v120, v121
    s_waitcnt lgkmcnt(2)
    v_mfma_f32_16x16x32_bf16 v[24:27], v[156:159], v[176:179], v[24:27]
    v_cvt_pk_bf16_f32 v229, v122, v123
    v_cvt_pk_bf16_f32 v234, v124, v125
    v_mfma_f32_16x16x32_bf16 v[44:47], v[156:159], v[180:183], v[44:47]
    v_cvt_pk_bf16_f32 v235, v126, v127
    s_waitcnt lgkmcnt(0)
    v_mfma_f32_16x16x32_bf16 v[28:31], v[160:163], v[176:179], v[28:31]
    v_cvt_pk_bf16_f32 v196, v140, v141
    v_cvt_pk_bf16_f32 v197, v142, v143
    v_mfma_f32_16x16x32_bf16 v[48:51], v[160:163], v[180:183], v[48:51]
    s_waitcnt vmcnt(0)
    ds_write_b64 v6, v[190:191] offset:8
    v_cvt_pk_bf16_f32 v240, v128, v129
    ds_write_b128 v4, v[202:205]
    v_cvt_pk_bf16_f32 v241, v130, v131
    ds_write_b128 v4, v[206:209] offset:1024
    v_cvt_pk_bf16_f32 v144, v52, v53
    ds_write_b64 v5, v[210:211] offset:2048
    v_cvt_pk_bf16_f32 v145, v54, v55
    ds_write_b64 v5, v[216:217] offset:2560
    v_cvt_pk_bf16_f32 v146, v56, v57
    ds_write_b64 v7, v[192:193] offset:3072
    v_cvt_pk_bf16_f32 v147, v58, v59
    ds_write_b64 v5, v[222:223] offset:3072
    v_cvt_pk_bf16_f32 v148, v60, v61
    ds_write_b64 v5, v[228:229] offset:3584
    v_cvt_pk_bf16_f32 v149, v62, v63
    ds_write_b64 v5, v[234:235] offset:4096
    v_cvt_pk_bf16_f32 v150, v64, v65
    ds_write_b64 v7, v[196:197] offset:4608
    v_cvt_pk_bf16_f32 v151, v66, v67
    ds_write_b64 v5, v[240:241] offset:4608
    v_cvt_pk_bf16_f32 v152, v68, v69
    v_cvt_pk_bf16_f32 v153, v70, v71
    v_cvt_pk_bf16_f32 v164, v12, v13
    v_cvt_pk_bf16_f32 v165, v14, v15
    v_cvt_pk_bf16_f32 v166, v16, v17
    v_cvt_pk_bf16_f32 v167, v18, v19
    s_waitcnt lgkmcnt(0)
    ds_add_u32 v8, v9 offset:40
    v_cvt_pk_bf16_f32 v168, v20, v21
    v_cvt_pk_bf16_f32 v169, v22, v23
    v_cvt_pk_bf16_f32 v170, v24, v25
    v_cvt_pk_bf16_f32 v171, v26, v27
    v_cvt_pk_bf16_f32 v172, v28, v29
    v_cvt_pk_bf16_f32 v173, v30, v31
    v_cvt_pk_bf16_f32 v174, v32, v33
    v_cvt_pk_bf16_f32 v175, v34, v35
    v_cvt_pk_bf16_f32 v176, v36, v37
    v_cvt_pk_bf16_f32 v177, v38, v39
    v_cvt_pk_bf16_f32 v178, v40, v41
    v_cvt_pk_bf16_f32 v179, v42, v43
    v_cvt_pk_bf16_f32 v180, v44, v45
    v_cvt_pk_bf16_f32 v181, v46, v47
    v_cvt_pk_bf16_f32 v182, v48, v49
    v_cvt_pk_bf16_f32 v183, v50, v51
    s_branch L_akx
L_ak2:
    s_mov_b32 s67, 0
    s_mov_b32 s66, 0
    v_add_u32 v190, 0, v192
    v_add_u32 v191, 0, v193
    v_add_u32 v194, 0, v196
    v_add_u32 v195, 0, v197
    v_add_u32 v198, 0, v200
    v_add_u32 v199, 0, v201
    v_mov_b32 v188, v190
    v_mov_b32 v189, v191
    s_barrier
    ds_read_b128 v[164:167], v194 offset:0
    ds_read_b64_tr_b16 v[144:145], v188 offset:18432
    ds_read_b64_tr_b16 v[146:147], v188 offset:20736
    ds_read_b128 v[168:171], v194 offset:2048
    ds_read_b128 v[172:175], v198 offset:0
    ds_read_b64_tr_b16 v[148:149], v188 offset:18464
    ds_read_b64_tr_b16 v[150:151], v188 offset:20768
    ds_read_b64_tr_b16 v[152:153], v188 offset:18496
    ds_read_b64_tr_b16 v[154:155], v188 offset:20800
    ds_read_b64_tr_b16 v[156:157], v188 offset:18528
    ds_read_b64_tr_b16 v[158:159], v188 offset:20832
L_kl_a2:
    ds_read_b64_tr_b16 v[160:161], v188 offset:18560
    s_waitcnt lgkmcnt(7)
    v_mfma_f32_16x16x32_bf16 v[52:55], v[144:147], v[164:167], v[52:55]
    ds_read_b64_tr_b16 v[162:163], v188 offset:20864
    s_add_u32 s42, s67, 47104
    v_mfma_f32_16x16x32_bf16 v[72:75], v[144:147], v[168:171], v[72:75]
    ds_read_b64_tr_b16 v[144:145], v188 offset:18576
    s_waitcnt lgkmcnt(7)
    v_mfma_f32_16x16x32_bf16 v[56:59], v[148:151], v[164:167], v[56:59]
    ds_read_b64_tr_b16 v[146:147], v188 offset:20880
    s_cmp_eq_u32 s67, 94208
    v_mfma_f32_16x16x32_bf16 v[76:79], v[148:151], v[168:171], v[76:79]
    ds_read_b64_tr_b16 v[148:149], v188 offset:18608
    s_waitcnt lgkmcnt(7)
    v_mfma_f32_16x16x32_bf16 v[60:63], v[152:155], v[164:167], v[60:63]
    ds_read_b64_tr_b16 v[150:151], v188 offset:20912
    ds_read_b128 v[176:179], v195 offset:0
    v_mfma_f32_16x16x32_bf16 v[80:83], v[152:155], v[168:171], v[80:83]
    v_mfma_f32_16x16x32_bf16 v[132:135], v[152:155], v[172:175], v[132:135]
    ds_read_b64_tr_b16 v[152:153], v188 offset:18640
    s_waitcnt lgkmcnt(8)
    v_mfma_f32_16x16x32_bf16 v[64:67], v[156:159], v[164:167], v[64:67]
    ds_read_b64_tr_b16 v[154:155], v188 offset:20944
    ds_read_b128 v[180:183], v195 offset:2048
    v_mfma_f32_16x16x32_bf16 v[84:87], v[156:159], v[168:171], v[84:87]
    ds_read_b64_tr_b16 v[156:157], v188 offset:18672
    s_waitcnt lgkmcnt(9)
    v_mfma_f32_16x16x32_bf16 v[68:71], v[160:163], v[164:167], v[68:71]
    ds_read_b64_tr_b16 v[158:159], v188 offset:20976
    ds_read_b128 v[184:187], v199 offset:0
    v_mfma_f32_16x16x32_bf16 v[88:91], v[160:163], v[168:171], v[88:91]
    ds_read_b64_tr_b16 v[160:161], v188 offset:18704
    s_waitcnt lgkmcnt(10)
    v_mfma_f32_16x16x32_bf16 v[92:95], v[164:167], v[144:147], v[92:95]
    ds_read_b64_tr_b16 v[162:163], v188 offset:21008
    s_cselect_b32 s67, 0, s42
    v_mfma_f32_16x16x32_bf16 v[112:115], v[168:171], v[144:147], v[112:115]
    ds_read_b64_tr_b16 v[144:145], v189 offset:36864
    s_waitcnt lgkmcnt(10)
    v_mfma_f32_16x16x32_bf16 v[96:99], v[164:167], v[148:151], v[96:99]
    ds_read_b64_tr_b16 v[146:147], v189 offset:38144
    v_add_u32 v190, s67, v192
    v_mfma_f32_16x16x32_bf16 v[116:119], v[168:171], v[148:151], v[116:119]
    ds_read_b64_tr_b16 v[148:149], v189 offset:36896
    s_waitcnt lgkmcnt(9)
    v_mfma_f32_16x16x32_bf16 v[100:103], v[164:167], v[152:155], v[100:103]
    ds_read_b64_tr_b16 v[150:151], v189 offset:38176
    v_add_u32 v191, s67, v193
    v_mfma_f32_16x16x32_bf16 v[120:123], v[168:171], v[152:155], v[120:123]
    v_mfma_f32_16x16x32_bf16 v[136:139], v[172:175], v[152:155], v[136:139]
    ds_read_b64_tr_b16 v[152:153], v189 offset:36928
    s_waitcnt lgkmcnt(8)
    v_mfma_f32_16x16x32_bf16 v[104:107], v[164:167], v[156:159], v[104:107]
    ds_read_b64_tr_b16 v[154:155], v189 offset:38208
    v_add_u32 v194, s67, v196
    v_mfma_f32_16x16x32_bf16 v[124:127], v[168:171], v[156:159], v[124:127]
    ds_read_b64_tr_b16 v[156:157], v189 offset:36960
    s_waitcnt lgkmcnt(7)
    v_mfma_f32_16x16x32_bf16 v[108:111], v[164:167], v[160:163], v[108:111]
    ds_read_b64_tr_b16 v[158:159], v189 offset:38240
    v_add_u32 v195, s67, v197
    v_mfma_f32_16x16x32_bf16 v[128:131], v[168:171], v[160:163], v[128:131]
    ds_read_b64_tr_b16 v[160:161], v189 offset:36992
    s_waitcnt lgkmcnt(7)
    v_mfma_f32_16x16x32_bf16 v[12:15], v[144:147], v[164:167], v[12:15]
    ds_read_b64_tr_b16 v[162:163], v189 offset:38272
    v_add_u32 v198, s67, v200
    v_mfma_f32_16x16x32_bf16 v[32:35], v[144:147], v[168:171], v[32:35]
    ds_read_b64_tr_b16 v[144:145], v188 offset:27648
    s_waitcnt lgkmcnt(7)
    v_mfma_f32_16x16x32_bf16 v[16:19], v[148:151], v[164:167], v[16:19]
    ds_read_b64_tr_b16 v[146:147], v188 offset:29952
    v_add_u32 v199, s67, v201
    v_mfma_f32_16x16x32_bf16 v[36:39], v[148:151], v[168:171], v[36:39]
    ds_read_b64_tr_b16 v[148:149], v188 offset:27680
    s_waitcnt lgkmcnt(7)
    v_mfma_f32_16x16x32_bf16 v[20:23], v[152:155], v[164:167], v[20:23]
    ds_read_b64_tr_b16 v[150:151], v188 offset:29984
    s_add_u32 s66, s66, 1
    v_mfma_f32_16x16x32_bf16 v[40:43], v[152:155], v[168:171], v[40:43]
    ds_read_b64_tr_b16 v[152:153], v188 offset:27712
    s_waitcnt lgkmcnt(7)
    v_mfma_f32_16x16x32_bf16 v[24:27], v[156:159], v[164:167], v[24:27]
    ds_read_b64_tr_b16 v[154:155], v188 offset:30016
    s_cmp_lt_u32 s66, 8
    v_mfma_f32_16x16x32_bf16 v[44:47], v[156:159], v[168:171], v[44:47]
    ds_read_b64_tr_b16 v[156:157], v188 offset:27744
    s_waitcnt lgkmcnt(7)
    v_mfma_f32_16x16x32_bf16 v[28:31], v[160:163], v[164:167], v[28:31]
    ds_read_b64_tr_b16 v[158:159], v188 offset:30048
    s_cbranch_vccnz L_id_a2
L_ir_a2:
    v_mfma_f32_16x16x32_bf16 v[48:51], v[160:163], v[168:171], v[48:51]
    ds_read_b64_tr_b16 v[160:161], v188 offset:27776
    s_waitcnt lgkmcnt(7)
    v_mfma_f32_16x16x32_bf16 v[52:55], v[144:147], v[176:179], v[52:55]
    ds_read_b64_tr_b16 v[162:163], v188 offset:30080
    v_mfma_f32_16x16x32_bf16 v[72:75], v[144:147], v[180:183], v[72:75]
    ds_read_b64_tr_b16 v[144:145], v188 offset:27792
    s_waitcnt lgkmcnt(7)
    v_mfma_f32_16x16x32_bf16 v[56:59], v[148:151], v[176:179], v[56:59]
    ds_read_b64_tr_b16 v[146:147], v188 offset:30096
    v_mfma_f32_16x16x32_bf16 v[76:79], v[148:151], v[180:183], v[76:79]
    ds_read_b64_tr_b16 v[148:149], v188 offset:27824
    s_waitcnt lgkmcnt(7)
    v_mfma_f32_16x16x32_bf16 v[60:63], v[152:155], v[176:179], v[60:63]
    ds_read_b64_tr_b16 v[150:151], v188 offset:30128
    v_mfma_f32_16x16x32_bf16 v[80:83], v[152:155], v[180:183], v[80:83]
    v_mfma_f32_16x16x32_bf16 v[132:135], v[152:155], v[184:187], v[132:135]
    ds_read_b64_tr_b16 v[152:153], v188 offset:27856
    s_waitcnt lgkmcnt(7)
    v_mfma_f32_16x16x32_bf16 v[64:67], v[156:159], v[176:179], v[64:67]
    ds_read_b64_tr_b16 v[154:155], v188 offset:30160
    v_mfma_f32_16x16x32_bf16 v[84:87], v[156:159], v[180:183], v[84:87]
    ds_read_b64_tr_b16 v[156:157], v188 offset:27888
    s_waitcnt lgkmcnt(7)
    v_mfma_f32_16x16x32_bf16 v[68:71], v[160:163], v[176:179], v[68:71]
    ds_read_b64_tr_b16 v[158:159], v188 offset:30192
    v_mfma_f32_16x16x32_bf16 v[88:91], v[160:163], v[180:183], v[88:91]
    ds_read_b64_tr_b16 v[160:161], v188 offset:27920
    s_waitcnt lgkmcnt(7)
    v_mfma_f32_16x16x32_bf16 v[92:95], v[176:179], v[144:147], v[92:95]
    ds_read_b64_tr_b16 v[162:163], v188 offset:30224
    v_mfma_f32_16x16x32_bf16 v[112:115], v[180:183], v[144:147], v[112:115]
    ds_read_b64_tr_b16 v[144:145], v189 offset:41984
    s_waitcnt lgkmcnt(7)
    v_mfma_f32_16x16x32_bf16 v[96:99], v[176:179], v[148:151], v[96:99]
    ds_read_b64_tr_b16 v[146:147], v189 offset:43264
    v_mfma_f32_16x16x32_bf16 v[116:119], v[180:183], v[148:151], v[116:119]
    ds_read_b64_tr_b16 v[148:149], v189 offset:42016
    s_waitcnt lgkmcnt(7)
    v_mfma_f32_16x16x32_bf16 v[100:103], v[176:179], v[152:155], v[100:103]
    ds_read_b64_tr_b16 v[150:151], v189 offset:43296
    v_mfma_f32_16x16x32_bf16 v[120:123], v[180:183], v[152:155], v[120:123]
    v_mfma_f32_16x16x32_bf16 v[136:139], v[184:187], v[152:155], v[136:139]
    ds_read_b64_tr_b16 v[152:153], v189 offset:42048
    s_waitcnt lgkmcnt(7)
    v_mfma_f32_16x16x32_bf16 v[104:107], v[176:179], v[156:159], v[104:107]
    ds_read_b64_tr_b16 v[154:155], v189 offset:43328
    v_mfma_f32_16x16x32_bf16 v[124:127], v[180:183], v[156:159], v[124:127]
    ds_read_b64_tr_b16 v[156:157], v189 offset:42080
    s_waitcnt lgkmcnt(7)
    v_mfma_f32_16x16x32_bf16 v[108:111], v[176:179], v[160:163], v[108:111]
    ds_read_b64_tr_b16 v[158:159], v189 offset:43360
    v_mfma_f32_16x16x32_bf16 v[128:131], v[180:183], v[160:163], v[128:131]
    ds_read_b64_tr_b16 v[160:161], v189 offset:42112
    s_waitcnt lgkmcnt(7)
    v_mfma_f32_16x16x32_bf16 v[12:15], v[144:147], v[176:179], v[12:15]
    ds_read_b64_tr_b16 v[162:163], v189 offset:43392
    v_mfma_f32_16x16x32_bf16 v[32:35], v[144:147], v[180:183], v[32:35]
    s_waitcnt lgkmcnt(6)
    v_mfma_f32_16x16x32_bf16 v[16:19], v[148:151], v[176:179], v[16:19]
    v_mfma_f32_16x16x32_bf16 v[36:39], v[148:151], v[180:183], v[36:39]
    s_waitcnt lgkmcnt(4)
    v_mfma_f32_16x16x32_bf16 v[20:23], v[152:155], v[176:179], v[20:23]
    s_waitcnt lgkmcnt(0)
    s_barrier
    v_mfma_f32_16x16x32_bf16 v[40:43], v[152:155], v[180:183], v[40:43]
    ds_read_b128 v[164:167], v194 offset:0
    ds_read_b64_tr_b16 v[144:145], v190 offset:18432
    ds_read_b64_tr_b16 v[146:147], v190 offset:20736
    v_mfma_f32_16x16x32_bf16 v[24:27], v[156:159], v[176:179], v[24:27]
    ds_read_b128 v[168:171], v194 offset:2048
    ds_read_b128 v[172:175], v198 offset:0
    ds_read_b64_tr_b16 v[148:149], v190 offset:18464
    v_mfma_f32_16x16x32_bf16 v[44:47], v[156:159], v[180:183], v[44:47]
    ds_read_b64_tr_b16 v[150:151], v190 offset:20768
    ds_read_b64_tr_b16 v[152:153], v190 offset:18496
    ds_read_b64_tr_b16 v[154:155], v190 offset:20800
    v_mfma_f32_16x16x32_bf16 v[28:31], v[160:163], v[176:179], v[28:31]
    ds_read_b64_tr_b16 v[156:157], v190 offset:18528
    ds_read_b64_tr_b16 v[158:159], v190 offset:20832
    v_mov_b32 v188, v190
    v_mfma_f32_16x16x32_bf16 v[48:51], v[160:163], v[180:183], v[48:51]
    v_mov_b32 v189, v191
    s_cbranch_scc1 L_kl_a2
    ds_read_b64_tr_b16 v[160:161], v188 offset:18560
    s_waitcnt lgkmcnt(7)
    v_mfma_f32_16x16x32_bf16 v[52:55], v[144:147], v[164:167], v[52:55]
    ds_read_b64_tr_b16 v[162:163], v188 offset:20864
    v_mfma_f32_16x16x32_bf16 v[72:75], v[144:147], v[168:171], v[72:75]
    ds_read_b64_tr_b16 v[144:145], v188 offset:18576
    s_waitcnt lgkmcnt(7)
    v_mfma_f32_16x16x32_bf16 v[56:59], v[148:151], v[164:167], v[56:59]
    ds_read_b64_tr_b16 v[146:147], v188 offset:20880
    v_mfma_f32_16x16x32_bf16 v[76:79], v[148:151], v[168:171], v[76:79]
    ds_read_b64_tr_b16 v[148:149], v188 offset:18608
    s_waitcnt lgkmcnt(7)
    v_mfma_f32_16x16x32_bf16 v[60:63], v[152:155], v[164:167], v[60:63]
    ds_read_b64_tr_b16 v[150:151], v188 offset:20912
    ds_read_b128 v[176:179], v195 offset:0
    v_mfma_f32_16x16x32_bf16 v[80:83], v[152:155], v[168:171], v[80:83]
    v_mfma_f32_16x16x32_bf16 v[132:135], v[152:155], v[172:175], v[132:135]
    ds_read_b64_tr_b16 v[152:153], v188 offset:18640
    s_waitcnt lgkmcnt(8)
    v_mfma_f32_16x16x32_bf16 v[64:67], v[156:159], v[164:167], v[64:67]
    ds_read_b64_tr_b16 v[154:155], v188 offset:20944
    ds_read_b128 v[180:183], v195 offset:2048
    v_mfma_f32_16x16x32_bf16 v[84:87], v[156:159], v[168:171], v[84:87]
    ds_read_b64_tr_b16 v[156:157], v188 offset:18672
    s_waitcnt lgkmcnt(9)
    v_mfma_f32_16x16x32_bf16 v[68:71], v[160:163], v[164:167], v[68:71]
    ds_read_b64_tr_b16 v[158:159], v188 offset:20976
    ds_read_b128 v[184:187], v199 offset:0
    v_mfma_f32_16x16x32_bf16 v[88:91], v[160:163], v[168:171], v[88:91]
    ds_read_b64_tr_b16 v[160:161], v188 offset:18704
    s_waitcnt lgkmcnt(10)
    v_mfma_f32_16x16x32_bf16 v[92:95], v[164:167], v[144:147], v[92:95]
    ds_read_b64_tr_b16 v[162:163], v188 offset:21008
    v_mfma_f32_16x16x32_bf16 v[112:115], v[168:171], v[144:147], v[112:115]
    ds_read_b64_tr_b16 v[144:145], v189 offset:36864
    s_waitcnt lgkmcnt(10)
    v_mfma_f32_16x16x32_bf16 v[96:99], v[164:167], v[148:151], v[96:99]
    ds_read_b64_tr_b16 v[146:147], v189 offset:38144
    v_mfma_f32_16x16x32_bf16 v[116:119], v[168:171], v[148:151], v[116:119]
    ds_read_b64_tr_b16 v[148:149], v189 offset:36896
    s_waitcnt lgkmcnt(9)
    v_mfma_f32_16x16x32_bf16 v[100:103], v[164:167], v[152:155], v[100:103]
    ds_read_b64_tr_b16 v[150:151], v189 offset:38176
    v_mfma_f32_16x16x32_bf16 v[120:123], v[168:171], v[152:155], v[120:123]
    v_mfma_f32_16x16x32_bf16 v[136:139], v[172:175], v[152:155], v[136:139]
    ds_read_b64_tr_b16 v[152:153], v189 offset:36928
    s_waitcnt lgkmcnt(8)
    v_mfma_f32_16x16x32_bf16 v[104:107], v[164:167], v[156:159], v[104:107]
    ds_read_b64_tr_b16 v[154:155], v189 offset:38208
    v_mfma_f32_16x16x32_bf16 v[124:127], v[168:171], v[156:159], v[124:127]
    ds_read_b64_tr_b16 v[156:157], v189 offset:36960
    s_waitcnt lgkmcnt(7)
    v_mfma_f32_16x16x32_bf16 v[108:111], v[164:167], v[160:163], v[108:111]
    ds_read_b64_tr_b16 v[158:159], v189 offset:38240
    v_mfma_f32_16x16x32_bf16 v[128:131], v[168:171], v[160:163], v[128:131]
    ds_read_b64_tr_b16 v[160:161], v189 offset:36992
    s_waitcnt lgkmcnt(7)
    v_mfma_f32_16x16x32_bf16 v[12:15], v[144:147], v[164:167], v[12:15]
    ds_read_b64_tr_b16 v[162:163], v189 offset:38272
    v_mfma_f32_16x16x32_bf16 v[32:35], v[144:147], v[168:171], v[32:35]
    ds_read_b64_tr_b16 v[144:145], v188 offset:27648
    s_waitcnt lgkmcnt(7)
    v_mfma_f32_16x16x32_bf16 v[16:19], v[148:151], v[164:167], v[16:19]
    ds_read_b64_tr_b16 v[146:147], v188 offset:29952
    v_mfma_f32_16x16x32_bf16 v[36:39], v[148:151], v[168:171], v[36:39]
    ds_read_b64_tr_b16 v[148:149], v188 offset:27680
    s_waitcnt lgkmcnt(7)
    v_mfma_f32_16x16x32_bf16 v[20:23], v[152:155], v[164:167], v[20:23]
    ds_read_b64_tr_b16 v[150:151], v188 offset:29984
    v_mfma_f32_16x16x32_bf16 v[40:43], v[152:155], v[168:171], v[40:43]
    ds_read_b64_tr_b16 v[152:153], v188 offset:27712
    s_waitcnt lgkmcnt(7)
    v_mfma_f32_16x16x32_bf16 v[24:27], v[156:159], v[164:167], v[24:27]
    ds_read_b64_tr_b16 v[154:155], v188 offset:30016
    v_mfma_f32_16x16x32_bf16 v[44:47], v[156:159], v[168:171], v[44:47]
    ds_read_b64_tr_b16 v[156:157], v188 offset:27744
    s_waitcnt lgkmcnt(7)
    v_mfma_f32_16x16x32_bf16 v[28:31], v[160:163], v[164:167], v[28:31]
    ds_read_b64_tr_b16 v[158:159], v188 offset:30048
    v_mfma_f32_16x16x32_bf16 v[48:51], v[160:163], v[168:171], v[48:51]
    ds_read_b64_tr_b16 v[160:161], v188 offset:27776
    s_waitcnt lgkmcnt(7)
    v_mfma_f32_16x16x32_bf16 v[52:55], v[144:147], v[176:179], v[52:55]
    ds_read_b64_tr_b16 v[162:163], v188 offset:30080
    v_mfma_f32_16x16x32_bf16 v[72:75], v[144:147], v[180:183], v[72:75]
    ds_read_b64_tr_b16 v[144:145], v188 offset:27792
    s_waitcnt lgkmcnt(7)
    v_mfma_f32_16x16x32_bf16 v[56:59], v[148:151], v[176:179], v[56:59]
    ds_read_b64_tr_b16 v[146:147], v188 offset:30096
    v_mfma_f32_16x16x32_bf16 v[76:79], v[148:151], v[180:183], v[76:79]
    ds_read_b64_tr_b16 v[148:149], v188 offset:27824
    s_waitcnt lgkmcnt(7)
    v_mfma_f32_16x16x32_bf16 v[60:63], v[152:155], v[176:179], v[60:63]
    ds_read_b64_tr_b16 v[150:151], v188 offset:30128
    v_mfma_f32_16x16x32_bf16 v[80:83], v[152:155], v[180:183], v[80:83]
    v_mfma_f32_16x16x32_bf16 v[132:135], v[152:155], v[184:187], v[132:135]
    ds_read_b64_tr_b16 v[152:153], v188 offset:27856
    s_waitcnt lgkmcnt(7)
    v_mfma_f32_16x16x32_bf16 v[64:67], v[156:159], v[176:179], v[64:67]
    ds_read_b64_tr_b16 v[154:155], v188 offset:30160
    v_cvt_pk_bf16_f32 v202, v72, v73
    v_mfma_f32_16x16x32_bf16 v[84:87], v[156:159], v[180:183], v[84:87]
    ds_read_b64_tr_b16 v[156:157], v188 offset:27888
    s_waitcnt lgkmcnt(7)
    v_mfma_f32_16x16x32_bf16 v[68:71], v[160:163], v[176:179], v[68:71]
    ds_read_b64_tr_b16 v[158:159], v188 offset:30192
    v_cvt_pk_bf16_f32 v203, v74, v75
    v_mfma_f32_16x16x32_bf16 v[88:91], v[160:163], v[180:183], v[88:91]
    ds_read_b64_tr_b16 v[160:161], v188 offset:27920
    s_waitcnt lgkmcnt(7)
    v_mfma_f32_16x16x32_bf16 v[92:95], v[176:179], v[144:147], v[92:95]
    ds_read_b64_tr_b16 v[162:163], v188 offset:30224
    v_cvt_pk_bf16_f32 v204, v76, v77
    v_mfma_f32_16x16x32_bf16 v[112:115], v[180:183], v[144:147], v[112:115]
    ds_read_b64_tr_b16 v[144:145], v189 offset:41984
    s_waitcnt lgkmcnt(7)
    v_mfma_f32_16x16x32_bf16 v[96:99], v[176:179], v[148:151], v[96:99]
    ds_read_b64_tr_b16 v[146:147], v189 offset:43264
    v_cvt_pk_bf16_f32 v205, v78, v79
    v_mfma_f32_16x16x32_bf16 v[116:119], v[180:183], v[148:151], v[116:119]
    ds_read_b64_tr_b16 v[148:149], v189 offset:42016
    s_waitcnt lgkmcnt(7)
    v_mfma_f32_16x16x32_bf16 v[100:103], v[176:179], v[152:155], v[100:103]
    ds_read_b64_tr_b16 v[150:151], v189 offset:43296
    v_cvt_pk_bf16_f32 v190, v132, v133
    v_mfma_f32_16x16x32_bf16 v[120:123], v[180:183], v[152:155], v[120:123]
    v_cvt_pk_bf16_f32 v191, v134, v135
    v_cvt_pk_bf16_f32 v206, v80, v81
    v_mfma_f32_16x16x32_bf16 v[136:139], v[184:187], v[152:155], v[136:139]
    ds_read_b64_tr_b16 v[152:153], v189 offset:42048
    s_waitcnt lgkmcnt(7)
    v_mfma_f32_16x16x32_bf16 v[104:107], v[176:179], v[156:159], v[104:107]
    ds_read_b64_tr_b16 v[154:155], v189 offset:43328
    v_cvt_pk_bf16_f32 v207, v82, v83
    v_mfma_f32_16x16x32_bf16 v[124:127], v[180:183], v[156:159], v[124:127]
    ds_read_b64_tr_b16 v[156:157], v189 offset:42080
    s_waitcnt lgkmcnt(7)
    v_mfma_f32_16x16x32_bf16 v[108:111], v[176:179], v[160:163], v[108:111]
    ds_read_b64_tr_b16 v[158:159], v189 offset:43360
    v_cvt_pk_bf16_f32 v208, v84, v85
    v_mfma_f32_16x16x32_bf16 v[128:131], v[180:183], v[160:163], v[128:131]
    ds_read_b64_tr_b16 v[160:161], v189 offset:42112
    s_waitcnt lgkmcnt(7)
    v_mfma_f32_16x16x32_bf16 v[12:15], v[144:147], v[176:179], v[12:15]
    ds_read_b64_tr_b16 v[162:163], v189 offset:43392
    v_cvt_pk_bf16_f32 v209, v86, v87
    v_mfma_f32_16x16x32_bf16 v[32:35], v[144:147], v[180:183], v[32:35]
    v_cvt_pk_bf16_f32 v210, v88, v89
    s_waitcnt lgkmcnt(6)
    v_mfma_f32_16x16x32_bf16 v[16:19], v[148:151], v[176:179], v[16:19]
    v_cvt_pk_bf16_f32 v211, v90, v91
    v_cvt_pk_bf16_f32 v216, v112, v113
    v_mfma_f32_16x16x32_bf16 v[36:39], v[148:151], v[180:183], v[36:39]
    v_cvt_pk_bf16_f32 v217, v114, v115
    s_waitcnt lgkmcnt(4)
    v_mfma_f32_16x16x32_bf16 v[20:23], v[152:155], v[176:179], v[20:23]
    v_cvt_pk_bf16_f32 v222, v116, v117
    v_cvt_pk_bf16_f32 v223, v118, v119
    v_mfma_f32_16x16x32_bf16 v[40:43], v[152:155], v[180:183], v[40:43]
    v_cvt_pk_bf16_f32 v192, v136, v137
    s_waitcnt lgkmcnt(2)
    v_mfma_f32_16x16x32_bf16 v[24:27], v[156:159], v[176:179], v[24:27]
    v_cvt_pk_bf16_f32 v193, v138, v139
    v_cvt_pk_bf16_f32 v228, v120, v121
    v_mfma_f32_16x16x32_bf16 v[44:47], v[156:159], v[180:183], v[44:47]
    v_cvt_pk_bf16_f32 v229, v122, v123
    s_waitcnt lgkmcnt(0)
    v_mfma_f32_16x16x32_bf16 v[28:31], v[160:163], v[176:179], v[28:31]
    v_cvt_pk_bf16_f32 v234, v124, v125
    v_cvt_pk_bf16_f32 v235, v126, v127
    v_mfma_f32_16x16x32_bf16 v[48:51], v[160:163], v[180:183], v[48:51]
    s_waitcnt vmcnt(0)
    ds_write_b64 v6, v[190:191] offset:1024
    v_cvt_pk_bf16_f32 v240, v128, v129
    v_cvt_pk_bf16_f32 v241, v130, v131
    ds_write_b64 v7, v[192:193] offset:3584
    v_cvt_pk_bf16_f32 v144, v52, v53
    v_cvt_pk_bf16_f32 v145, v54, v55
    v_cvt_pk_bf16_f32 v146, v56, v57
    v_cvt_pk_bf16_f32 v147, v58, v59
    v_cvt_pk_bf16_f32 v148, v60, v61
    v_cvt_pk_bf16_f32 v149, v62, v63
    s_waitcnt lgkmcnt(0)
    ds_add_u32 v8, v9 offset:40
    v_cvt_pk_bf16_f32 v150, v64, v65
    v_cvt_pk_bf16_f32 v151, v66, v67
    v_cvt_pk_bf16_f32 v152, v68, v69
    v_cvt_pk_bf16_f32 v153, v70, v71
    v_cvt_pk_bf16_f32 v164, v12, v13
    v_cvt_pk_bf16_f32 v165, v14, v15
    v_cvt_pk_bf16_f32 v166, v16, v17
    v_cvt_pk_bf16_f32 v167, v18, v19
    v_cvt_pk_bf16_f32 v168, v20, v21
    v_cvt_pk_bf16_f32 v169, v22, v23
    v_cvt_pk_bf16_f32 v170, v24, v25
    v_cvt_pk_bf16_f32 v171, v26, v27
    v_cvt_pk_bf16_f32 v172, v28, v29
    v_cvt_pk_bf16_f32 v173, v30, v31
    v_cvt_pk_bf16_f32 v174, v32, v33
    v_cvt_pk_bf16_f32 v175, v34, v35
    v_cvt_pk_bf16_f32 v176, v36, v37
    v_cvt_pk_bf16_f32 v177, v38, v39
    v_cvt_pk_bf16_f32 v178, v40, v41
    v_cvt_pk_bf16_f32 v179, v42, v43
    v_cvt_pk_bf16_f32 v180, v44, v45
    v_cvt_pk_bf16_f32 v181, v46, v47
    v_cvt_pk_bf16_f32 v182, v48, v49
    v_cvt_pk_bf16_f32 v183, v50, v51
    s_branch L_akx
L_ak3:
    s_mov_b32 s67, 0
    s_mov_b32 s66, 0
    v_add_u32 v190, 0, v192
    v_add_u32 v191, 0, v193
    v_add_u32 v194, 0, v196
    v_add_u32 v195, 0, v197
    v_add_u32 v198, 0, v200
    v_add_u32 v199, 0, v201
    v_mov_b32 v188, v190
    v_mov_b32 v189, v191
    s_barrier
    ds_read_b128 v[164:167], v194 offset:0
    ds_read_b64_tr_b16 v[144:145], v188 offset:18432
    ds_read_b64_tr_b16 v[146:147], v188 offset:20736
    ds_read_b128 v[168:171], v194 offset:2048
    ds_read_b128 v[172:175], v198 offset:0
    ds_read_b64_tr_b16 v[148:149], v188 offset:18464
    ds_read_b64_tr_b16 v[150:151], v188 offset:20768
    ds_read_b64_tr_b16 v[152:153], v188 offset:18496
    ds_read_b64_tr_b16 v[154:155], v188 offset:20800
    ds_read_b64_tr_b16 v[156:157], v188 offset:18528
    ds_read_b64_tr_b16 v[158:159], v188 offset:20832
L_kl_a3:
    ds_read_b64_tr_b16 v[160:161], v188 offset:18560
    s_waitcnt lgkmcnt(7)
    v_mfma_f32_16x16x32_bf16 v[52:55], v[144:147], v[164:167], v[52:55]
    ds_read_b64_tr_b16 v[162:163], v188 offset:20864
    s_add_u32 s42, s67, 47104
    v_mfma_f32_16x16x32_bf16 v[72:75], v[144:147], v[168:171], v[72:75]
    ds_read_b64_tr_b16 v[144:145], v188 offset:18576
    s_waitcnt lgkmcnt(7)
    v_mfma_f32_16x16x32_bf16 v[56:59], v[148:151], v[164:167], v[56:59]
    ds_read_b64_tr_b16 v[146:147], v188 offset:20880
    s_cmp_eq_u32 s67, 94208
    v_mfma_f32_16x16x32_bf16 v[76:79], v[148:151], v[168:171], v[76:79]
    ds_read_b64_tr_b16 v[148:149], v188 offset:18608
    s_waitcnt lgkmcnt(7)
    v_mfma_f32_16x16x32_bf16 v[60:63], v[152:155], v[164:167], v[60:63]
    ds_read_b64_tr_b16 v[150:151], v188 offset:20912
    ds_read_b128 v[176:179], v195 offset:0
    v_mfma_f32_16x16x32_bf16 v[80:83], v[152:155], v[168:171], v[80:83]
    ds_read_b64_tr_b16 v[152:153], v188 offset:18640
    s_waitcnt lgkmcnt(8)
    v_mfma_f32_16x16x32_bf16 v[64:67], v[156:159], v[164:167], v[64:67]
    ds_read_b64_tr_b16 v[154:155], v188 offset:20944
    ds_read_b128 v[180:183], v195 offset:2048
    v_mfma_f32_16x16x32_bf16 v[84:87], v[156:159], v[168:171], v[84:87]
    v_mfma_f32_16x16x32_bf16 v[132:135], v[156:159], v[172:175], v[132:135]
    ds_read_b64_tr_b16 v[156:157], v188 offset:18672
    s_waitcnt lgkmcnt(9)
    v_mfma_f32_16x16x32_bf16 v[68:71], v[160:163], v[164:167], v[68:71]
    ds_read_b64_tr_b16 v[158:159], v188 offset:20976
    ds_read_b128 v[184:187], v199 offset:0
    v_mfma_f32_16x16x32_bf16 v[88:91], v[160:163], v[168:171], v[88:91]
    ds_read_b64_tr_b16 v[160:161], v188 offset:18704
    s_waitcnt lgkmcnt(10)
    v_mfma_f32_16x16x32_bf16 v[92:95], v[164:167], v[144:147], v[92:95]
    ds_read_b64_tr_b16 v[162:163], v188 offset:21008
    s_cselect_b32 s67, 0, s42
    v_mfma_f32_16x16x32_bf16 v[112:115], v[168:171], v[144:147], v[112:115]
    ds_read_b64_tr_b16 v[144:145], v189 offset:36864
    s_waitcnt lgkmcnt(10)
    v_mfma_f32_16x16x32_bf16 v[96:99], v[164:167], v[148:151], v[96:99]
    ds_read_b64_tr_b16 v[146:147], v189 offset:38144
    v_add_u32 v190, s67, v192
    v_mfma_f32_16x16x32_bf16 v[116:119], v[168:171], v[148:151], v[116:119]
    ds_read_b64_tr_b16 v[148:149], v189 offset:36896
    s_waitcnt lgkmcnt(9)
    v_mfma_f32_16x16x32_bf16 v[100:103], v[164:167], v[152:155], v[100:103]
    ds_read_b64_tr_b16 v[150:151], v189 offset:38176
    v_add_u32 v191, s67, v193
    v_mfma_f32_16x16x32_bf16 v[120:123], v[168:171], v[152:155], v[120:123]
    ds_read_b64_tr_b16 v[152:153], v189 offset:36928
    s_waitcnt lgkmcnt(8)
    v_mfma_f32_16x16x32_bf16 v[104:107], v[164:167], v[156:159], v[104:107]
    ds_read_b64_tr_b16 v[154:155], v189 offset:38208
    v_add_u32 v194, s67, v196
    v_mfma_f32_16x16x32_bf16 v[124:127], v[168:171], v[156:159], v[124:127]
    v_mfma_f32_16x16x32_bf16 v[136:139], v[172:175], v[156:159], v[136:139]
    ds_read_b64_tr_b16 v[156:157], v189 offset:36960
    s_waitcnt lgkmcnt(7)
    v_mfma_f32_16x16x32_bf16 v[108:111], v[164:167], v[160:163], v[108:111]
    ds_read_b64_tr_b16 v[158:159], v189 offset:38240
    v_add_u32 v195, s67, v197
    v_mfma_f32_16x16x32_bf16 v[128:131], v[168:171], v[160:163], v[128:131]
    ds_read_b64_tr_b16 v[160:161], v189 offset:36992
    s_waitcnt lgkmcnt(7)
    v_mfma_f32_16x16x32_bf16 v[12:15], v[144:147], v[164:167], v[12:15]
    ds_read_b64_tr_b16 v[162:163], v189 offset:38272
    v_add_u32 v198, s67, v200
    v_mfma_f32_16x16x32_bf16 v[32:35], v[144:147], v[168:171], v[32:35]
    ds_read_b64_tr_b16 v[144:145], v188 offset:27648
    s_waitcnt lgkmcnt(7)
    v_mfma_f32_16x16x32_bf16 v[16:19], v[148:151], v[164:167], v[16:19]
    ds_read_b64_tr_b16 v[146:147], v188 offset:29952
    v_add_u32 v199, s67, v201
    v_mfma_f32_16x16x32_bf16 v[36:39], v[148:151], v[168:171], v[36:39]
    ds_read_b64_tr_b16 v[148:149], v188 offset:27680
    s_waitcnt lgkmcnt(7)
    v_mfma_f32_16x16x32_bf16 v[20:23], v[152:155], v[164:167], v[20:23]
    ds_read_b64_tr_b16 v[150:151], v188 offset:29984
    s_add_u32 s66, s66, 1
    v_mfma_f32_16x16x32_bf16 v[40:43], v[152:155], v[168:171], v[40:43]
    ds_read_b64_tr_b16 v[152:153], v188 offset:27712
    s_waitcnt lgkmcnt(7)
    v_mfma_f32_16x16x32_bf16 v[24:27], v[156:159], v[164:167], v[24:27]
    ds_read_b64_tr_b16 v[154:155], v188 offset:30016
    s_cmp_lt_u32 s66, 8
    v_mfma_f32_16x16x32_bf16 v[44:47], v[156:159], v[168:171], v[44:47]
    ds_read_b64_tr_b16 v[156:157], v188 offset:27744
    s_waitcnt lgkmcnt(7)
    v_mfma_f32_16x16x32_bf16 v[28:31], v[160:163], v[164:167], v[28:31]
    ds_read_b64_tr_b16 v[158:159], v188 offset:30048
    s_cbranch_vccnz L_id_a3
L_ir_a3:
    v_mfma_f32_16x16x32_bf16 v[48:51], v[160:163], v[168:171], v[48:51]
    ds_read_b64_tr_b16 v[160:161], v188 offset:27776
    s_waitcnt lgkmcnt(7)
    v_mfma_f32_16x16x32_bf16 v[52:55], v[144:147], v[176:179], v[52:55]
    ds_read_b64_tr_b16 v[162:163], v188 offset:30080
    v_mfma_f32_16x16x32_bf16 v[72:75], v[144:147], v[180:183], v[72:75]
    ds_read_b64_tr_b16 v[144:145], v188 offset:27792
    s_waitcnt lgkmcnt(7)
    v_mfma_f32_16x16x32_bf16 v[56:59], v[148:151], v[176:179], v[56:59]
    ds_read_b64_tr_b16 v[146:147], v188 offset:30096
    v_mfma_f32_16x16x32_bf16 v[76:79], v[148:151], v[180:183], v[76:79]
    ds_read_b64_tr_b16 v[148:149], v188 offset:27824
    s_waitcnt lgkmcnt(7)
    v_mfma_f32_16x16x32_bf16 v[60:63], v[152:155], v[176:179], v[60:63]
    ds_read_b64_tr_b16 v[150:151], v188 offset:30128
    v_mfma_f32_16x16x32_bf16 v[80:83], v[152:155], v[180:183], v[80:83]
    ds_read_b64_tr_b16 v[152:153], v188 offset:27856
    s_waitcnt lgkmcnt(7)
    v_mfma_f32_16x16x32_bf16 v[64:67], v[156:159], v[176:179], v[64:67]
    ds_read_b64_tr_b16 v[154:155], v188 offset:30160
    v_mfma_f32_16x16x32_bf16 v[84:87], v[156:159], v[180:183], v[84:87]
    v_mfma_f32_16x16x32_bf16 v[132:135], v[156:159], v[184:187], v[132:135]
    ds_read_b64_tr_b16 v[156:157], v188 offset:27888
    s_waitcnt lgkmcnt(7)
    v_mfma_f32_16x16x32_bf16 v[68:71], v[160:163], v[176:179], v[68:71]
    ds_read_b64_tr_b16 v[158:159], v188 offset:30192
    v_mfma_f32_16x16x32_bf16 v[88:91], v[160:163], v[180:183], v[88:91]
    ds_read_b64_tr_b16 v[160:161], v188 offset:27920
    s_waitcnt lgkmcnt(7)
    v_mfma_f32_16x16x32_bf16 v[92:95], v[176:179], v[144:147], v[92:95]
    ds_read_b64_tr_b16 v[162:163], v188 offset:30224
    v_mfma_f32_16x16x32_bf16 v[112:115], v[180:183], v[144:147], v[112:115]
    ds_read_b64_tr_b16 v[144:145], v189 offset:41984
    s_waitcnt lgkmcnt(7)
    v_mfma_f32_16x16x32_bf16 v[96:99], v[176:179], v[148:151], v[96:99]
    ds_read_b64_tr_b16 v[146:147], v189 offset:43264
    v_mfma_f32_16x16x32_bf16 v[116:119], v[180:183], v[148:151], v[116:119]
    ds_read_b64_tr_b16 v[148:149], v189 offset:42016
    s_waitcnt lgkmcnt(7)
    v_mfma_f32_16x16x32_bf16 v[100:103], v[176:179], v[152:155], v[100:103]
    ds_read_b64_tr_b16 v[150:151], v189 offset:43296
    v_mfma_f32_16x16x32_bf16 v[120:123], v[180:183], v[152:155], v[120:123]
    ds_read_b64_tr_b16 v[152:153], v189 offset:42048
    s_waitcnt lgkmcnt(7)
    v_mfma_f32_16x16x32_bf16 v[104:107], v[176:179], v[156:159], v[104:107]
    ds_read_b64_tr_b16 v[154:155], v189 offset:43328
    v_mfma_f32_16x16x32_bf16 v[124:127], v[180:183], v[156:159], v[124:127]
    v_mfma_f32_16x16x32_bf16 v[136:139], v[184:187], v[156:159], v[136:139]
    ds_read_b64_tr_b16 v[156:157], v189 offset:42080
    s_waitcnt lgkmcnt(7)
    v_mfma_f32_16x16x32_bf16 v[108:111], v[176:179], v[160:163], v[108:111]
    ds_read_b64_tr_b16 v[158:159], v189 offset:43360
    v_mfma_f32_16x16x32_bf16 v[128:131], v[180:183], v[160:163], v[128:131]
    ds_read_b64_tr_b16 v[160:161], v189 offset:42112
    s_waitcnt lgkmcnt(7)
    v_mfma_f32_16x16x32_bf16 v[12:15], v[144:147], v[176:179], v[12:15]
    ds_read_b64_tr_b16 v[162:163], v189 offset:43392
    v_mfma_f32_16x16x32_bf16 v[32:35], v[144:147], v[180:183], v[32:35]
    s_waitcnt lgkmcnt(6)
    v_mfma_f32_16x16x32_bf16 v[16:19], v[148:151], v[176:179], v[16:19]
    v_mfma_f32_16x16x32_bf16 v[36:39], v[148:151], v[180:183], v[36:39]
    s_waitcnt lgkmcnt(4)
    v_mfma_f32_16x16x32_bf16 v[20:23], v[152:155], v[176:179], v[20:23]
    s_waitcnt lgkmcnt(0)
    s_barrier
    v_mfma_f32_16x16x32_bf16 v[40:43], v[152:155], v[180:183], v[40:43]
    ds_read_b128 v[164:167], v194 offset:0
    ds_read_b64_tr_b16 v[144:145], v190 offset:18432
    ds_read_b64_tr_b16 v[146:147], v190 offset:20736
    v_mfma_f32_16x16x32_bf16 v[24:27], v[156:159], v[176:179], v[24:27]
    ds_read_b128 v[168:171], v194 offset:2048
    ds_read_b128 v[172:175], v198 offset:0
    ds_read_b64_tr_b16 v[148:149], v190 offset:18464
    v_mfma_f32_16x16x32_bf16 v[44:47], v[156:159], v[180:183], v[44:47]
    ds_read_b64_tr_b16 v[150:151], v190 offset:20768
    ds_read_b64_tr_b16 v[152:153], v190 offset:18496
    ds_read_b64_tr_b16 v[154:155], v190 offset:20800
    v_mfma_f32_16x16x32_bf16 v[28:31], v[160:163], v[176:179], v[28:31]
    ds_read_b64_tr_b16 v[156:157], v190 offset:18528
    ds_read_b64_tr_b16 v[158:159], v190 offset:20832
    v_mov_b32 v188, v190
    v_mfma_f32_16x16x32_bf16 v[48:51], v[160:163], v[180:183], v[48:51]
    v_mov_b32 v189, v191
    s_cbranch_scc1 L_kl_a3
    ds_read_b64_tr_b16 v[160:161], v188 offset:18560
    s_waitcnt lgkmcnt(7)
    v_mfma_f32_16x16x32_bf16 v[52:55], v[144:147], v[164:167], v[52:55]
    ds_read_b64_tr_b16 v[162:163], v188 offset:20864
    v_mfma_f32_16x16x32_bf16 v[72:75], v[144:147], v[168:171], v[72:75]
    ds_read_b64_tr_b16 v[144:145], v188 offset:18576
    s_waitcnt lgkmcnt(7)
    v_mfma_f32_16x16x32_bf16 v[56:59], v[148:151], v[164:167], v[56:59]
    ds_read_b64_tr_b16 v[146:147], v188 offset:20880
    v_mfma_f32_16x16x32_bf16 v[76:79], v[148:151], v[168:171], v[76:79]
    ds_read_b64_tr_b16 v[148:149], v188 offset:18608
    s_waitcnt lgkmcnt(7)
    v_mfma_f32_16x16x32_bf16 v[60:63], v[152:155], v[164:167], v[60:63]
    ds_read_b64_tr_b16 v[150:151], v188 offset:20912
    ds_read_b128 v[176:179], v195 offset:0
    v_mfma_f32_16x16x32_bf16 v[80:83], v[152:155], v[168:171], v[80:83]
    ds_read_b64_tr_b16 v[152:153], v188 offset:18640
    s_waitcnt lgkmcnt(8)
    v_mfma_f32_16x16x32_bf16 v[64:67], v[156:159], v[164:167], v[64:67]
    ds_read_b64_tr_b16 v[154:155], v188 offset:20944
    ds_read_b128 v[180:183], v195 offset:2048
    v_mfma_f32_16x16x32_bf16 v[84:87], v[156:159], v[168:171], v[84:87]
    v_mfma_f32_16x16x32_bf16 v[132:135], v[156:159], v[172:175], v[132:135]
    ds_read_b64_tr_b16 v[156:157], v188 offset:18672
    s_waitcnt lgkmcnt(9)
    v_mfma_f32_16x16x32_bf16 v[68:71], v[160:163], v[164:167], v[68:71]
    ds_read_b64_tr_b16 v[158:159], v188 offset:20976
    ds_read_b128 v[184:187], v199 offset:0
    v_mfma_f32_16x16x32_bf16 v[88:91], v[160:163], v[168:171], v[88:91]
    ds_read_b64_tr_b16 v[160:161], v188 offset:18704
    s_waitcnt lgkmcnt(10)
    v_mfma_f32_16x16x32_bf16 v[92:95], v[164:167], v[144:147], v[92:95]
    ds_read_b64_tr_b16 v[162:163], v188 offset:21008
    v_mfma_f32_16x16x32_bf16 v[112:115], v[168:171], v[144:147], v[112:115]
    ds_read_b64_tr_b16 v[144:145], v189 offset:36864
    s_waitcnt lgkmcnt(10)
    v_mfma_f32_16x16x32_bf16 v[96:99], v[164:167], v[148:151], v[96:99]
    ds_read_b64_tr_b16 v[146:147], v189 offset:38144
    v_mfma_f32_16x16x32_bf16 v[116:119], v[168:171], v[148:151], v[116:119]
    ds_read_b64_tr_b16 v[148:149], v189 offset:36896
    s_waitcnt lgkmcnt(9)
    v_mfma_f32_16x16x32_bf16 v[100:103], v[164:167], v[152:155], v[100:103]
    ds_read_b64_tr_b16 v[150:151], v189 offset:38176
    v_mfma_f32_16x16x32_bf16 v[120:123], v[168:171], v[152:155], v[120:123]
    ds_read_b64_tr_b16 v[152:153], v189 offset:36928
    s_waitcnt lgkmcnt(8)
    v_mfma_f32_16x16x32_bf16 v[104:107], v[164:167], v[156:159], v[104:107]
    ds_read_b64_tr_b16 v[154:155], v189 offset:38208
    v_mfma_f32_16x16x32_bf16 v[124:127], v[168:171], v[156:159], v[124:127]
    v_mfma_f32_16x16x32_bf16 v[136:139], v[172:175], v[156:159], v[136:139]
    ds_read_b64_tr_b16 v[156:157], v189 offset:36960
    s_waitcnt lgkmcnt(7)
    v_mfma_f32_16x16x32_bf16 v[108:111], v[164:167], v[160:163], v[108:111]
    ds_read_b64_tr_b16 v[158:159], v189 offset:38240
    v_mfma_f32_16x16x32_bf16 v[128:131], v[168:171], v[160:163], v[128:131]
    ds_read_b64_tr_b16 v[160:161], v189 offset:36992
    s_waitcnt lgkmcnt(7)
    v_mfma_f32_16x16x32_bf16 v[12:15], v[144:147], v[164:167], v[12:15]
    ds_read_b64_tr_b16 v[162:163], v189 offset:38272
    v_mfma_f32_16x16x32_bf16 v[32:35], v[144:147], v[168:171], v[32:35]
    ds_read_b64_tr_b16 v[144:145], v188 offset:27648
    s_waitcnt lgkmcnt(7)
    v_mfma_f32_16x16x32_bf16 v[16:19], v[148:151], v[164:167], v[16:19]
    ds_read_b64_tr_b16 v[146:147], v188 offset:29952
    v_mfma_f32_16x16x32_bf16 v[36:39], v[148:151], v[168:171], v[36:39]
    ds_read_b64_tr_b16 v[148:149], v188 offset:27680
    s_waitcnt lgkmcnt(7)
    v_mfma_f32_16x16x32_bf16 v[20:23], v[152:155], v[164:167], v[20:23]
    ds_read_b64_tr_b16 v[150:151], v188 offset:29984
    v_mfma_f32_16x16x32_bf16 v[40:43], v[152:155], v[168:171], v[40:43]
    ds_read_b64_tr_b16 v[152:153], v188 offset:27712
    s_waitcnt lgkmcnt(7)
    v_mfma_f32_16x16x32_bf16 v[24:27], v[156:159], v[164:167], v[24:27]
    ds_read_b64_tr_b16 v[154:155], v188 offset:30016
    v_mfma_f32_16x16x32_bf16 v[44:47], v[156:159], v[168:171], v[44:47]
    ds_read_b64_tr_b16 v[156:157], v188 offset:27744
    s_waitcnt lgkmcnt(7)
    v_mfma_f32_16x16x32_bf16 v[28:31], v[160:163], v[164:167], v[28:31]
    ds_read_b64_tr_b16 v[158:159], v188 offset:30048
    v_mfma_f32_16x16x32_bf16 v[48:51], v[160:163], v[168:171], v[48:51]
    ds_read_b64_tr_b16 v[160:161], v188 offset:27776
    s_waitcnt lgkmcnt(7)
    v_mfma_f32_16x16x32_bf16 v[52:55], v[144:147], v[176:179], v[52:55]
    ds_read_b64_tr_b16 v[162:163], v188 offset:30080
    v_mfma_f32_16x16x32_bf16 v[72:75], v[144:147], v[180:183], v[72:75]
    ds_read_b64_tr_b16 v[144:145], v188 offset:27792
    s_waitcnt lgkmcnt(7)
    v_mfma_f32_16x16x32_bf16 v[56:59], v[148:151], v[176:179], v[56:59]
    ds_read_b64_tr_b16 v[146:147], v188 offset:30096
    v_mfma_f32_16x16x32_bf16 v[76:79], v[148:151], v[180:183], v[76:79]
    ds_read_b64_tr_b16 v[148:149], v188 offset:27824
    s_waitcnt lgkmcnt(7)
    v_mfma_f32_16x16x32_bf16 v[60:63], v[152:155], v[176:179], v[60:63]
    ds_read_b64_tr_b16 v[150:151], v188 offset:30128
    v_mfma_f32_16x16x32_bf16 v[80:83], v[152:155], v[180:183], v[80:83]
    ds_read_b64_tr_b16 v[152:153], v188 offset:27856
    s_waitcnt lgkmcnt(7)
    v_mfma_f32_16x16x32_bf16 v[64:67], v[156:159], v[176:179], v[64:67]
    ds_read_b64_tr_b16 v[154:155], v188 offset:30160
    v_cvt_pk_bf16_f32 v202, v72, v73
    v_mfma_f32_16x16x32_bf16 v[84:87], v[156:159], v[180:183], v[84:87]
    v_cvt_pk_bf16_f32 v203, v74, v75
    v_mfma_f32_16x16x32_bf16 v[132:135], v[156:159], v[184:187], v[132:135]
    ds_read_b64_tr_b16 v[156:157], v188 offset:27888
    s_waitcnt lgkmcnt(7)
    v_mfma_f32_16x16x32_bf16 v[68:71], v[160:163], v[176:179], v[68:71]
    ds_read_b64_tr_b16 v[158:159], v188 offset:30192
    v_cvt_pk_bf16_f32 v204, v76, v77
    v_mfma_f32_16x16x32_bf16 v[88:91], v[160:163], v[180:183], v[88:91]
    ds_read_b64_tr_b16 v[160:161], v188 offset:27920
    s_waitcnt lgkmcnt(7)
    v_mfma_f32_16x16x32_bf16 v[92:95], v[176:179], v[144:147], v[92:95]
    ds_read_b64_tr_b16 v[162:163], v188 offset:30224
    v_cvt_pk_bf16_f32 v205, v78, v79
    v_mfma_f32_16x16x32_bf16 v[112:115], v[180:183], v[144:147], v[112:115]
    ds_read_b64_tr_b16 v[144:145], v189 offset:41984
    s_waitcnt lgkmcnt(7)
    v_mfma_f32_16x16x32_bf16 v[96:99], v[176:179], v[148:151], v[96:99]
    ds_read_b64_tr_b16 v[146:147], v189 offset:43264
    v_cvt_pk_bf16_f32 v206, v80, v81
    v_mfma_f32_16x16x32_bf16 v[116:119], v[180:183], v[148:151], v[116:119]
    ds_read_b64_tr_b16 v[148:149], v189 offset:42016
    s_waitcnt lgkmcnt(7)
    v_mfma_f32_16x16x32_bf16 v[100:103], v[176:179], v[152:155], v[100:103]
    ds_read_b64_tr_b16 v[150:151], v189 offset:43296
    v_cvt_pk_bf16_f32 v207, v82, v83
    v_mfma_f32_16x16x32_bf16 v[120:123], v[180:183], v[152:155], v[120:123]
    ds_read_b64_tr_b16 v[152:153], v189 offset:42048
    s_waitcnt lgkmcnt(7)
    v_mfma_f32_16x16x32_bf16 v[104:107], v[176:179], v[156:159], v[104:107]
    ds_read_b64_tr_b16 v[154:155], v189 offset:43328
    v_cvt_pk_bf16_f32 v190, v132, v133
    v_mfma_f32_16x16x32_bf16 v[124:127], v[180:183], v[156:159], v[124:127]
    v_cvt_pk_bf16_f32 v191, v134, v135
    v_cvt_pk_bf16_f32 v208, v84, v85
    v_mfma_f32_16x16x32_bf16 v[136:139], v[184:187], v[156:159], v[136:139]
    ds_read_b64_tr_b16 v[156:157], v189 offset:42080
    s_waitcnt lgkmcnt(7)
    v_mfma_f32_16x16x32_bf16 v[108:111], v[176:179], v[160:163], v[108:111]
    ds_read_b64_tr_b16 v[158:159], v189 offset:43360
    v_cvt_pk_bf16_f32 v209, v86, v87
    v_mfma_f32_16x16x32_bf16 v[128:131], v[180:183], v[160:163], v[128:131]
    ds_read_b64_tr_b16 v[160:161], v189 offset:42112
    s_waitcnt lgkmcnt(7)
    v_mfma_f32_16x16x32_bf16 v[12:15], v[144:147], v[176:179], v[12:15]
    ds_read_b64_tr_b16 v[162:163], v189 offset:43392
    v_cvt_pk_bf16_f32 v210, v88, v89
    v_mfma_f32_16x16x32_bf16 v[32:35], v[144:147], v[180:183], v[32:35]
    v_cvt_pk_bf16_f32 v211, v90, v91
    s_waitcnt lgkmcnt(6)
    v_mfma_f32_16x16x32_bf16 v[16:19], v[148:151], v[176:179], v[16:19]
    v_cvt_pk_bf16_f32 v216, v112, v113
    v_cvt_pk_bf16_f32 v217, v114, v115
    v_mfma_f32_16x16x32_bf16 v[36:39], v[148:151], v[180:183], v[36:39]
    v_cvt_pk_bf16_f32 v222, v116, v117
    s_waitcnt lgkmcnt(4)
    v_mfma_f32_16x16x32_bf16 v[20:23], v[152:155], v[176:179], v[20:23]
    v_cvt_pk_bf16_f32 v223, v118, v119
    v_cvt_pk_bf16_f32 v228, v120, v121
    v_mfma_f32_16x16x32_bf16 v[40:43], v[152:155], v[180:183], v[40:43]
    v_cvt_pk_bf16_f32 v229, v122, v123
    s_waitcnt lgkmcnt(2)
    v_mfma_f32_16x16x32_bf16 v[24:27], v[156:159], v[176:179], v[24:27]
    v_cvt_pk_bf16_f32 v192, v136, v137
    v_cvt_pk_bf16_f32 v193, v138, v139
    v_mfma_f32_16x16x32_bf16 v[44:47], v[156:159], v[180:183], v[44:47]
    v_cvt_pk_bf16_f32 v234, v124, v125
    s_waitcnt lgkmcnt(0)
    v_mfma_f32_16x16x32_bf16 v[28:31], v[160:163], v[176:179], v[28:31]
    v_cvt_pk_bf16_f32 v235, v126, v127
    v_cvt_pk_bf16_f32 v240, v128, v129
    v_mfma_f32_16x16x32_bf16 v[48:51], v[160:163], v[180:183], v[48:51]
    s_waitcnt vmcnt(0)
    ds_write_b64 v6, v[190:191] offset:1032
    v_cvt_pk_bf16_f32 v241, v130, v131
    ds_write_b64 v7, v[192:193] offset:4096
    v_cvt_pk_bf16_f32 v144, v52, v53
    v_cvt_pk_bf16_f32 v145, v54, v55
    v_cvt_pk_bf16_f32 v146, v56, v57
    v_cvt_pk_bf16_f32 v147, v58, v59
    v_cvt_pk_bf16_f32 v148, v60, v61
    v_cvt_pk_bf16_f32 v149, v62, v63
    s_waitcnt lgkmcnt(0)
    ds_add_u32 v8, v9 offset:40
    v_cvt_pk_bf16_f32 v150, v64, v65
    v_cvt_pk_bf16_f32 v151, v66, v67
    v_cvt_pk_bf16_f32 v152, v68, v69
    v_cvt_pk_bf16_f32 v153, v70, v71
    v_cvt_pk_bf16_f32 v164, v12, v13
    v_cvt_pk_bf16_f32 v165, v14, v15
    v_cvt_pk_bf16_f32 v166, v16, v17
    v_cvt_pk_bf16_f32 v167, v18, v19
    v_cvt_pk_bf16_f32 v168, v20, v21
    v_cvt_pk_bf16_f32 v169, v22, v23
    v_cvt_pk_bf16_f32 v170, v24, v25
    v_cvt_pk_bf16_f32 v171, v26, v27
    v_cvt_pk_bf16_f32 v172, v28, v29
    v_cvt_pk_bf16_f32 v173, v30, v31
    v_cvt_pk_bf16_f32 v174, v32, v33
    v_cvt_pk_bf16_f32 v175, v34, v35
    v_cvt_pk_bf16_f32 v176, v36, v37
    v_cvt_pk_bf16_f32 v177, v38, v39
    v_cvt_pk_bf16_f32 v178, v40, v41
    v_cvt_pk_bf16_f32 v179, v42, v43
    v_cvt_pk_bf16_f32 v180, v44, v45
    v_cvt_pk_bf16_f32 v181, v46, v47
    v_cvt_pk_bf16_f32 v182, v48, v49
    v_cvt_pk_bf16_f32 v183, v50, v51
L_akx:
    v_cndmask_b32 v14, v178, 0, s[44:45]
    v_cndmask_b32 v15, v179, 0, s[44:45]
    v_cndmask_b32 v12, 0, v176, s[44:45]
    v_mov_b32 v13, v177
    v_cndmask_b32 v176, v176, 0, s[44:45]
    v_mov_b32 v177, 0
    v_cndmask_b32 v16, 0, v178, s[44:45]
    v_cndmask_b32 v17, 0, v179, s[44:45]
    v_cndmask_b32 v18, v180, 0, s[46:47]
    v_cndmask_b32 v19, v181, 0, s[44:45]
    v_cndmask_b32 v180, 0, v180, s[46:47]
    v_cndmask_b32 v181, 0, v181, s[44:45]
    s_mov_b32 s78, 0
L_sp_ax:
    ds_read_b32 v1, v8 offset:40
    s_add_u32 s78, s78, 0x100
    s_cbranch_scc1 L_ok_ax
    s_waitcnt lgkmcnt(0)
    v_readfirstlane_b32 s42, v1
    s_cmp_ge_u32 s42, 4
    s_cbranch_scc0 L_sp_ax
    L_ok_ax:
    ds_read_b128 v[154:157], v2
    ds_read_b128 v[158:161], v2 offset:1024
    ds_read_b64 v[162:163], v3 offset:2048
    ds_read_b64 v[212:213], v3 offset:2560
    ds_read_b64 v[218:219], v3 offset:3072
    ds_read_b64 v[224:225], v3 offset:3584
    ds_read_b64 v[230:231], v3 offset:4096
    ds_read_b64 v[236:237], v3 offset:4608
    v_cndmask_b32 v186, v168, 0, s[44:45]
    v_cndmask_b32 v187, v169, 0, s[44:45]
    v_mfma_f32_16x16x32_bf16 v[52:55], v[202:205], v[174:177], v[242:245]
    v_cndmask_b32 v184, 0, v166, s[44:45]
    v_mov_b32 v185, v167
    v_mfma_f32_16x16x32_bf16 v[68:71], v[144:147], v[174:177], v[246:249]
    v_cndmask_b32 v166, v166, 0, s[44:45]
    v_mov_b32 v167, 0
    v_mfma_f32_16x16x32_bf16 v[56:59], v[204:207], v[12:15], v[242:245]
    v_cndmask_b32 v188, 0, v168, s[44:45]
    v_cndmask_b32 v189, 0, v169, s[44:45]
    v_mfma_f32_16x16x32_bf16 v[72:75], v[146:149], v[12:15], v[246:249]
    v_cndmask_b32 v190, v170, 0, s[46:47]
    v_cndmask_b32 v191, v171, 0, s[44:45]
    v_mfma_f32_16x16x32_bf16 v[60:63], v[206:209], v[16:19], v[242:245]
    v_cndmask_b32 v170, 0, v170, s[46:47]
    v_cndmask_b32 v171, 0, v171, s[44:45]
    v_mfma_f32_16x16x32_bf16 v[76:79], v[148:151], v[16:19], v[246:249]
    v_cvt_pk_bf16_f32 v214, v92, v93
    v_cvt_pk_bf16_f32 v215, v94, v95
    v_mfma_f32_16x16x32_bf16 v[64:67], v[208:211], v[180:183], v[242:245]
    v_cvt_pk_bf16_f32 v220, v96, v97
    v_cvt_pk_bf16_f32 v221, v98, v99
    v_mfma_f32_16x16x32_bf16 v[80:83], v[150:153], v[180:183], v[246:249]
    v_cvt_pk_bf16_f32 v226, v100, v101
    v_cvt_pk_bf16_f32 v227, v102, v103
    v_cvt_pk_bf16_f32 v232, v104, v105
    v_cvt_pk_bf16_f32 v233, v106, v107
    v_cvt_pk_bf16_f32 v238, v108, v109
    v_cvt_pk_bf16_f32 v239, v110, v111
    s_mov_b32 s74, 0x3eae1a93
    s_mov_b32 s75, 0x3eae1a93
    s_waitcnt lgkmcnt(5)
    v_mfma_f32_16x16x32_bf16 v[20:23], v[144:147], v[164:167], v[242:245]
    v_mfma_f32_16x16x32_bf16 v[36:39], v[154:157], v[164:167], v[250:253]
    v_max_f32 v52, v52, v68
    v_max_f32 v53, v53, v69
    v_max_f32 v54, v54, v70
    v_mfma_f32_16x16x32_bf16 v[24:27], v[146:149], v[184:187], v[242:245]
    v_max_f32 v55, v55, v71
    v_max3_f32 v138, v52, v53, v54
    v_max_f32 v138, v138, v55
    v_mfma_f32_16x16x32_bf16 v[40:43], v[156:159], v[184:187], v[250:253]
    v_max_f32 v56, v56, v72
    v_max_f32 v57, v57, v73
    v_max_f32 v58, v58, v74
    v_mfma_f32_16x16x32_bf16 v[28:31], v[148:151], v[188:191], v[242:245]
    v_max_f32 v59, v59, v75
    v_max3_f32 v139, v56, v57, v58
    v_max_f32 v139, v139, v59
    v_mfma_f32_16x16x32_bf16 v[44:47], v[158:161], v[188:191], v[250:253]
    v_max_f32 v60, v60, v76
    v_max_f32 v61, v61, v77
    v_max_f32 v62, v62, v78
    v_mfma_f32_16x16x32_bf16 v[32:35], v[150:153], v[170:173], v[242:245]
    v_max_f32 v63, v63, v79
    v_max3_f32 v140, v60, v61, v62
    v_max_f32 v140, v140, v63
    v_mfma_f32_16x16x32_bf16 v[48:51], v[160:163], v[170:173], v[250:253]
    v_max_f32 v64, v64, v80
    v_max_f32 v65, v65, v81
    v_max_f32 v66, v66, v82
    v_max_f32 v67, v67, v83
    v_max3_f32 v141, v64, v65, v66
    v_max_f32 v141, v141, v67
    v_max_f32 v20, v20, v36
    v_max_f32 v21, v21, v37
    v_max_f32 v22, v22, v38
    v_max_f32 v23, v23, v39
    v_max3_f32 v132, v20, v21, v22
    v_max_f32 v132, v132, v23
    v_max_f32 v24, v24, v40
    v_max_f32 v25, v25, v41
    v_max_f32 v26, v26, v42
    v_max_f32 v27, v27, v43
    v_max3_f32 v133, v24, v25, v26
    v_max_f32 v133, v133, v27
    v_max_f32 v28, v28, v44
    v_max_f32 v29, v29, v45
    v_max_f32 v30, v30, v46
    v_max_f32 v31, v31, v47
    v_max3_f32 v134, v28, v29, v30
    v_max_f32 v134, v134, v31
    v_max_f32 v32, v32, v48
    v_max_f32 v33, v33, v49
    v_max_f32 v34, v34, v50
    v_max_f32 v35, v35, v51
    v_max3_f32 v135, v32, v33, v34
    v_max_f32 v135, v135, v35
    v_permlane32_swap_b32 v138, v139
    v_permlane32_swap_b32 v132, v133
    v_permlane32_swap_b32 v140, v141
    v_permlane32_swap_b32 v134, v135
    v_max_f32 v138, v138, v139
    v_max_f32 v132, v132, v133
    v_max_f32 v140, v140, v141
    v_max_f32 v134, v134, v135
    s_nop 0
    v_permlane16_swap_b32 v138, v140
    v_permlane16_swap_b32 v132, v134
    v_max_f32 v138, v138, v140
    v_max_f32 v132, v132, v134
    v_mul_f32 v138, 0xbeae1a93, v138
    v_mul_f32 v132, 0xbeae1a93, v132
    v_mov_b32 v139, v138
    v_mov_b32 v133, v132
    s_nop 0
    v_permlane16_swap_b32 v138, v139
    v_permlane16_swap_b32 v132, v133
    v_mov_b32 v142, v138
    v_mov_b32 v136, v132
    v_mov_b32 v143, v139
    v_mov_b32 v137, v133
    v_permlane32_swap_b32 v138, v142
    v_permlane32_swap_b32 v132, v136
    v_permlane32_swap_b32 v139, v143
    v_permlane32_swap_b32 v133, v137
    v_pk_fma_f32 v[52:53], v[52:53], s[74:75], v[138:139] op_sel:[0,0,0] op_sel_hi:[1,1,0]
    v_pk_fma_f32 v[54:55], v[54:55], s[74:75], v[138:139] op_sel:[0,0,0] op_sel_hi:[1,1,0]
    v_pk_fma_f32 v[56:57], v[56:57], s[74:75], v[142:143] op_sel:[0,0,0] op_sel_hi:[1,1,0]
    v_pk_fma_f32 v[58:59], v[58:59], s[74:75], v[142:143] op_sel:[0,0,0] op_sel_hi:[1,1,0]
    v_pk_fma_f32 v[60:61], v[60:61], s[74:75], v[138:139] op_sel:[0,0,1] op_sel_hi:[1,1,1]
    v_pk_fma_f32 v[62:63], v[62:63], s[74:75], v[138:139] op_sel:[0,0,1] op_sel_hi:[1,1,1]
    v_pk_fma_f32 v[64:65], v[64:65], s[74:75], v[142:143] op_sel:[0,0,1] op_sel_hi:[1,1,1]
    v_pk_fma_f32 v[66:67], v[66:67], s[74:75], v[142:143] op_sel:[0,0,1] op_sel_hi:[1,1,1]
    v_pk_fma_f32 v[20:21], v[20:21], s[74:75], v[132:133] op_sel:[0,0,0] op_sel_hi:[1,1,0]
    v_pk_fma_f32 v[22:23], v[22:23], s[74:75], v[132:133] op_sel:[0,0,0] op_sel_hi:[1,1,0]
    v_pk_fma_f32 v[24:25], v[24:25], s[74:75], v[136:137] op_sel:[0,0,0] op_sel_hi:[1,1,0]
    v_pk_fma_f32 v[26:27], v[26:27], s[74:75], v[136:137] op_sel:[0,0,0] op_sel_hi:[1,1,0]
    v_pk_fma_f32 v[28:29], v[28:29], s[74:75], v[132:133] op_sel:[0,0,1] op_sel_hi:[1,1,1]
    v_pk_fma_f32 v[30:31], v[30:31], s[74:75], v[132:133] op_sel:[0,0,1] op_sel_hi:[1,1,1]
    v_pk_fma_f32 v[32:33], v[32:33], s[74:75], v[136:137] op_sel:[0,0,1] op_sel_hi:[1,1,1]
    v_pk_fma_f32 v[34:35], v[34:35], s[74:75], v[136:137] op_sel:[0,0,1] op_sel_hi:[1,1,1]
    v_exp_f32 v52, v52
    v_exp_f32 v53, v53
    v_exp_f32 v54, v54
    v_exp_f32 v55, v55
    v_exp_f32 v56, v56
    v_exp_f32 v57, v57
    v_exp_f32 v58, v58
    v_exp_f32 v59, v59
    v_exp_f32 v60, v60
    v_exp_f32 v61, v61
    v_exp_f32 v62, v62
    v_exp_f32 v63, v63
    v_exp_f32 v64, v64
    v_exp_f32 v65, v65
    v_exp_f32 v66, v66
    v_exp_f32 v67, v67
    v_exp_f32 v20, v20
    v_exp_f32 v21, v21
    v_exp_f32 v22, v22
    v_exp_f32 v23, v23
    v_exp_f32 v24, v24
    v_exp_f32 v25, v25
    v_exp_f32 v26, v26
    v_exp_f32 v27, v27
    v_exp_f32 v28, v28
    v_exp_f32 v29, v29
    v_exp_f32 v30, v30
    v_exp_f32 v31, v31
    v_exp_f32 v32, v32
    v_exp_f32 v33, v33
    v_exp_f32 v34, v34
    v_exp_f32 v35, v35
    v_pk_add_f32 v[68:69], v[52:53], v[54:55]
    v_pk_add_f32 v[70:71], v[56:57], v[58:59]
    v_pk_add_f32 v[72:73], v[60:61], v[62:63]
    v_pk_add_f32 v[74:75], v[64:65], v[66:67]
    v_add_f32 v138, v68, v69
    v_add_f32 v139, v70, v71
    v_add_f32 v140, v72, v73
    v_add_f32 v141, v74, v75
    v_pk_add_f32 v[36:37], v[20:21], v[22:23]
    v_pk_add_f32 v[38:39], v[24:25], v[26:27]
    v_pk_add_f32 v[40:41], v[28:29], v[30:31]
    v_pk_add_f32 v[42:43], v[32:33], v[34:35]
    v_add_f32 v132, v36, v37
    v_add_f32 v133, v38, v39
    v_add_f32 v134, v40, v41
    v_add_f32 v135, v42, v43
    v_permlane32_swap_b32 v138, v139
    v_permlane32_swap_b32 v132, v133
    v_permlane32_swap_b32 v140, v141
    v_permlane32_swap_b32 v134, v135
    v_add_f32 v138, v138, v139
    v_add_f32 v132, v132, v133
    v_add_f32 v140, v140, v141
    v_add_f32 v134, v134, v135
    s_nop 0
    v_permlane16_swap_b32 v138, v140
    v_permlane16_swap_b32 v132, v134
    v_add_f32 v138, v138, v140
    v_add_f32 v132, v132, v134
    v_rcp_f32 v138, v138
    v_rcp_f32 v132, v132
    v_mov_b32 v139, v138
    v_mov_b32 v133, v132
    s_nop 0
    v_permlane16_swap_b32 v138, v139
    v_permlane16_swap_b32 v132, v133
    v_mov_b32 v142, v138
    v_mov_b32 v136, v132
    v_mov_b32 v143, v139
    v_mov_b32 v137, v133
    v_permlane32_swap_b32 v138, v142
    v_permlane32_swap_b32 v132, v136
    v_permlane32_swap_b32 v139, v143
    v_permlane32_swap_b32 v133, v137
    s_waitcnt lgkmcnt(0)
    v_pk_mul_f32 v[52:53], v[52:53], v[138:139] op_sel:[0,0] op_sel_hi:[1,0]
    v_pk_mul_f32 v[54:55], v[54:55], v[138:139] op_sel:[0,0] op_sel_hi:[1,0]
    v_cvt_pk_bf16_f32 v100, v52, v53
    v_cvt_pk_bf16_f32 v101, v54, v55
    v_and_b32 v102, v100, v254
    v_and_b32 v103, v101, v255
    v_xor_b32 v100, v100, v102
    v_xor_b32 v101, v101, v103
    v_pk_mul_f32 v[56:57], v[56:57], v[142:143] op_sel:[0,0] op_sel_hi:[1,0]
    v_pk_mul_f32 v[58:59], v[58:59], v[142:143] op_sel:[0,0] op_sel_hi:[1,0]
    v_cvt_pk_bf16_f32 v104, v56, v57
    v_cvt_pk_bf16_f32 v105, v58, v59
    v_and_b32 v106, v104, v254
    v_and_b32 v107, v105, v255
    v_xor_b32 v104, v104, v106
    v_xor_b32 v105, v105, v107
    v_pk_mul_f32 v[60:61], v[60:61], v[138:139] op_sel:[0,1] op_sel_hi:[1,1]
    v_pk_mul_f32 v[62:63], v[62:63], v[138:139] op_sel:[0,1] op_sel_hi:[1,1]
    v_cvt_pk_bf16_f32 v108, v60, v61
    v_cvt_pk_bf16_f32 v109, v62, v63
    v_and_b32 v110, v108, v254
    v_and_b32 v111, v109, v255
    v_xor_b32 v108, v108, v110
    v_xor_b32 v109, v109, v111
    v_pk_mul_f32 v[64:65], v[64:65], v[142:143] op_sel:[0,1] op_sel_hi:[1,1]
    v_pk_mul_f32 v[66:67], v[66:67], v[142:143] op_sel:[0,1] op_sel_hi:[1,1]
    v_cvt_pk_bf16_f32 v112, v64, v65
    v_cvt_pk_bf16_f32 v113, v66, v67
    v_and_b32 v114, v112, v254
    v_and_b32 v115, v113, v255
    v_xor_b32 v112, v112, v114
    v_xor_b32 v113, v113, v115
    v_pk_mul_f32 v[20:21], v[20:21], v[132:133] op_sel:[0,0] op_sel_hi:[1,0]
    v_pk_mul_f32 v[22:23], v[22:23], v[132:133] op_sel:[0,0] op_sel_hi:[1,0]
    v_cvt_pk_bf16_f32 v84, v20, v21
    v_cvt_pk_bf16_f32 v85, v22, v23
    v_mfma_f32_16x16x32_bf16 v[52:55], v[214:217], v[100:103], 0
    v_and_b32 v86, v84, v254
    v_and_b32 v87, v85, v255
    v_mfma_f32_16x16x32_bf16 v[56:59], v[220:223], v[100:103], 0
    v_xor_b32 v84, v84, v86
    v_xor_b32 v85, v85, v87
    v_pk_mul_f32 v[24:25], v[24:25], v[136:137] op_sel:[0,0] op_sel_hi:[1,0]
    v_pk_mul_f32 v[26:27], v[26:27], v[136:137] op_sel:[0,0] op_sel_hi:[1,0]
    v_cvt_pk_bf16_f32 v88, v24, v25
    v_cvt_pk_bf16_f32 v89, v26, v27
    v_mfma_f32_16x16x32_bf16 v[60:63], v[220:223], v[104:107], 0
    v_and_b32 v90, v88, v254
    v_and_b32 v91, v89, v255
    v_mfma_f32_16x16x32_bf16 v[64:67], v[226:229], v[104:107], 0
    v_xor_b32 v88, v88, v90
    v_xor_b32 v89, v89, v91
    v_pk_mul_f32 v[28:29], v[28:29], v[132:133] op_sel:[0,1] op_sel_hi:[1,1]
    v_pk_mul_f32 v[30:31], v[30:31], v[132:133] op_sel:[0,1] op_sel_hi:[1,1]
    v_cvt_pk_bf16_f32 v92, v28, v29
    v_cvt_pk_bf16_f32 v93, v30, v31
    v_mfma_f32_16x16x32_bf16 v[68:71], v[226:229], v[108:111], 0
    v_and_b32 v94, v92, v254
    v_and_b32 v95, v93, v255
    v_mfma_f32_16x16x32_bf16 v[72:75], v[232:235], v[108:111], 0
    v_xor_b32 v92, v92, v94
    v_xor_b32 v93, v93, v95
    v_pk_mul_f32 v[32:33], v[32:33], v[136:137] op_sel:[0,1] op_sel_hi:[1,1]
    v_pk_mul_f32 v[34:35], v[34:35], v[136:137] op_sel:[0,1] op_sel_hi:[1,1]
    v_cvt_pk_bf16_f32 v96, v32, v33
    v_cvt_pk_bf16_f32 v97, v34, v35
    v_mfma_f32_16x16x32_bf16 v[76:79], v[232:235], v[112:115], 0
    v_and_b32 v98, v96, v254
    v_and_b32 v99, v97, v255
    v_mfma_f32_16x16x32_bf16 v[80:83], v[238:241], v[112:115], 0
    v_xor_b32 v96, v96, v98
    v_xor_b32 v97, v97, v99
    v_cvt_pk_bf16_f32 v116, v52, v53
    v_cvt_pk_bf16_f32 v117, v54, v55
    v_mfma_f32_16x16x32_bf16 v[20:23], v[212:215], v[84:87], 0
    v_cvt_pk_bf16_f32 v118, v60, v61
    v_cvt_pk_bf16_f32 v12, v56, v57
    v_mfma_f32_16x16x32_bf16 v[24:27], v[218:221], v[84:87], 0
    v_cndmask_b32 v118, v12, v118, s[44:45]
    v_cvt_pk_bf16_f32 v119, v62, v63
    v_mfma_f32_16x16x32_bf16 v[28:31], v[218:221], v[88:91], 0
    v_cvt_pk_bf16_f32 v124, v68, v69
    v_cvt_pk_bf16_f32 v12, v64, v65
    v_mfma_f32_16x16x32_bf16 v[32:35], v[224:227], v[88:91], 0
    v_cndmask_b32 v124, v12, v124, s[44:45]
    v_cvt_pk_bf16_f32 v125, v70, v71
    v_mfma_f32_16x16x32_bf16 v[36:39], v[224:227], v[92:95], 0
    v_cvt_pk_bf16_f32 v13, v66, v67
    v_cndmask_b32 v125, v13, v125, s[44:45]
    v_mfma_f32_16x16x32_bf16 v[40:43], v[230:233], v[92:95], 0
    v_cvt_pk_bf16_f32 v126, v76, v77
    v_cvt_pk_bf16_f32 v12, v72, v73
    v_mfma_f32_16x16x32_bf16 v[44:47], v[230:233], v[96:99], 0
    v_cndmask_b32 v126, v12, v126, s[46:47]
    v_cvt_pk_bf16_f32 v127, v78, v79
    v_mfma_f32_16x16x32_bf16 v[48:51], v[236:239], v[96:99], 0
    v_cvt_pk_bf16_f32 v13, v74, v75
    v_cndmask_b32 v127, v13, v127, s[44:45]
    v_cvt_pk_bf16_f32 v130, v80, v81
    v_cvt_pk_bf16_f32 v131, v82, v83
    s_add_u32 s42, s56, 18432
    s_add_u32 s43, s57, 18432
    buffer_store_dwordx4 v[116:119], v10, s[24:27], s42 offen sc1
    buffer_store_dwordx4 v[124:127], v10, s[24:27], s42 offen offset:1024 sc1
    buffer_store_dwordx2 v[130:131], v11, s[24:27], s43 offen sc1
    v_cvt_pk_bf16_f32 v112, v20, v21
    v_cvt_pk_bf16_f32 v113, v22, v23
    v_cvt_pk_bf16_f32 v114, v28, v29
    v_cvt_pk_bf16_f32 v12, v24, v25
    v_cndmask_b32 v114, v12, v114, s[44:45]
    v_cvt_pk_bf16_f32 v115, v30, v31
    v_cvt_pk_bf16_f32 v120, v36, v37
    v_cvt_pk_bf16_f32 v12, v32, v33
    v_cndmask_b32 v120, v12, v120, s[44:45]
    v_cvt_pk_bf16_f32 v121, v38, v39
    v_cvt_pk_bf16_f32 v13, v34, v35
    v_cndmask_b32 v121, v13, v121, s[44:45]
    v_cvt_pk_bf16_f32 v122, v44, v45
    v_cvt_pk_bf16_f32 v12, v40, v41
    v_cndmask_b32 v122, v12, v122, s[46:47]
    v_cvt_pk_bf16_f32 v123, v46, v47
    v_cvt_pk_bf16_f32 v13, v42, v43
    v_cndmask_b32 v123, v13, v123, s[44:45]
    v_cvt_pk_bf16_f32 v128, v48, v49
    v_cvt_pk_bf16_f32 v129, v50, v51
    s_add_u32 s42, s56, 0
    s_add_u32 s43, s57, 0
    buffer_store_dwordx4 v[112:115], v10, s[24:27], s42 offen sc1
    buffer_store_dwordx4 v[120:123], v10, s[24:27], s42 offen offset:1024 sc1
    buffer_store_dwordx2 v[128:129], v11, s[24:27], s43 offen sc1
    s_branch L_main
L_bk:
    s_mov_b32 s72, 0x00ff00ff
    s_mov_b32 s73, 0x00ff00ff
    s_mul_i32 s43, s38, 144
    v_mov_b32 v9, 1073741824
    v_add_u32 v1, 0, v0
    v_mul_u32_u24 v2, 6554, v1
    v_lshrrev_b32 v2, 16, v2
    v_mul_u32_u24 v3, 10, v2
    v_sub_u32 v3, v1, v3
    v_lshrrev_b32 v4, 4, v2
    v_bfe_u32 v5, v2, 2, 1
    v_lshl_add_u32 v4, v4, 1, v5
    v_bfe_u32 v5, v2, 3, 1
    v_and_b32 v6, 3, v2
    v_mul_u32_u24 v7, 18, v5
    v_lshl_add_u32 v7, v4, 2, v7
    v_add_u32 v7, v7, v6
    v_mul_u32_u24 v240, 1152, v7
    v_lshl_add_u32 v240, v3, 4, v240
    v_add_u32 v240, s43, v240
    v_cmp_eq_u32 vcc, 9, v3
    s_nop 1
    v_cndmask_b32 v240, v240, v9, vcc
    v_lshl_add_u32 v5, v5, 2, v6
    v_lshrrev_b32 v7, 1, v5
    v_mul_u32_u24 v7, 18, v7
    v_and_b32 v5, 1, v5
    v_add3_u32 v7, v7, v5, 16
    v_mul_u32_u24 v4, 72, v4
    v_add_u32 v7, v7, v4
    v_mul_u32_u24 v245, 1152, v7
    v_lshl_add_u32 v245, v3, 4, v245
    v_add_u32 v245, s43, v245
    v_cmp_eq_u32 vcc, 9, v3
    s_nop 1
    v_cndmask_b32 v245, v245, v9, vcc
    v_add_u32 v1, 64, v0
    v_mul_u32_u24 v2, 6554, v1
    v_lshrrev_b32 v2, 16, v2
    v_mul_u32_u24 v3, 10, v2
    v_sub_u32 v3, v1, v3
    v_lshrrev_b32 v4, 4, v2
    v_bfe_u32 v5, v2, 2, 1
    v_lshl_add_u32 v4, v4, 1, v5
    v_bfe_u32 v5, v2, 3, 1
    v_and_b32 v6, 3, v2
    v_mul_u32_u24 v7, 18, v5
    v_lshl_add_u32 v7, v4, 2, v7
    v_add_u32 v7, v7, v6
    v_mul_u32_u24 v241, 1152, v7
    v_lshl_add_u32 v241, v3, 4, v241
    v_add_u32 v241, s43, v241
    v_cmp_eq_u32 vcc, 9, v3
    s_nop 1
    v_cndmask_b32 v241, v241, v9, vcc
    v_lshl_add_u32 v5, v5, 2, v6
    v_lshrrev_b32 v7, 1, v5
    v_mul_u32_u24 v7, 18, v7
    v_and_b32 v5, 1, v5
    v_add3_u32 v7, v7, v5, 16
    v_mul_u32_u24 v4, 72, v4
    v_add_u32 v7, v7, v4
    v_mul_u32_u24 v246, 1152, v7
    v_lshl_add_u32 v246, v3, 4, v246
    v_add_u32 v246, s43, v246
    v_cmp_eq_u32 vcc, 9, v3
    s_nop 1
    v_cndmask_b32 v246, v246, v9, vcc
    v_add_u32 v1, 128, v0
    v_mul_u32_u24 v2, 6554, v1
    v_lshrrev_b32 v2, 16, v2
    v_mul_u32_u24 v3, 10, v2
    v_sub_u32 v3, v1, v3
    v_lshrrev_b32 v4, 4, v2
    v_bfe_u32 v5, v2, 2, 1
    v_lshl_add_u32 v4, v4, 1, v5
    v_bfe_u32 v5, v2, 3, 1
    v_and_b32 v6, 3, v2
    v_mul_u32_u24 v7, 18, v5
    v_lshl_add_u32 v7, v4, 2, v7
    v_add_u32 v7, v7, v6
    v_mul_u32_u24 v242, 1152, v7
    v_lshl_add_u32 v242, v3, 4, v242
    v_add_u32 v242, s43, v242
    v_cmp_eq_u32 vcc, 9, v3
    s_nop 1
    v_cndmask_b32 v242, v242, v9, vcc
    v_lshl_add_u32 v5, v5, 2, v6
    v_lshrrev_b32 v7, 1, v5
    v_mul_u32_u24 v7, 18, v7
    v_and_b32 v5, 1, v5
    v_add3_u32 v7, v7, v5, 16
    v_mul_u32_u24 v4, 72, v4
    v_add_u32 v7, v7, v4
    v_mul_u32_u24 v247, 1152, v7
    v_lshl_add_u32 v247, v3, 4, v247
    v_add_u32 v247, s43, v247
    v_cmp_eq_u32 vcc, 9, v3
    s_nop 1
    v_cndmask_b32 v247, v247, v9, vcc
    v_add_u32 v1, 192, v0
    v_mul_u32_u24 v2, 6554, v1
    v_lshrrev_b32 v2, 16, v2
    v_mul_u32_u24 v3, 10, v2
    v_sub_u32 v3, v1, v3
    v_lshrrev_b32 v4, 4, v2
    v_bfe_u32 v5, v2, 2, 1
    v_lshl_add_u32 v4, v4, 1, v5
    v_bfe_u32 v5, v2, 3, 1
    v_and_b32 v6, 3, v2
    v_mul_u32_u24 v7, 18, v5
    v_lshl_add_u32 v7, v4, 2, v7
    v_add_u32 v7, v7, v6
    v_mul_u32_u24 v243, 1152, v7
    v_lshl_add_u32 v243, v3, 4, v243
    v_add_u32 v243, s43, v243
    v_cmp_eq_u32 vcc, 9, v3
    s_nop 1
    v_cndmask_b32 v243, v243, v9, vcc
    v_lshl_add_u32 v5, v5, 2, v6
    v_lshrrev_b32 v7, 1, v5
    v_mul_u32_u24 v7, 18, v7
    v_and_b32 v5, 1, v5
    v_add3_u32 v7, v7, v5, 16
    v_mul_u32_u24 v4, 72, v4
    v_add_u32 v7, v7, v4
    v_mul_u32_u24 v248, 1152, v7
    v_lshl_add_u32 v248, v3, 4, v248
    v_add_u32 v248, s43, v248
    v_cmp_eq_u32 vcc, 9, v3
    s_nop 1
    v_cndmask_b32 v248, v248, v9, vcc
    v_add_u32 v1, 256, v0
    v_mul_u32_u24 v2, 6554, v1
    v_lshrrev_b32 v2, 16, v2
    v_mul_u32_u24 v3, 10, v2
    v_sub_u32 v3, v1, v3
    v_lshrrev_b32 v4, 4, v2
    v_bfe_u32 v5, v2, 2, 1
    v_lshl_add_u32 v4, v4, 1, v5
    v_bfe_u32 v5, v2, 3, 1
    v_and_b32 v6, 3, v2
    v_mul_u32_u24 v7, 18, v5
    v_lshl_add_u32 v7, v4, 2, v7
    v_add_u32 v7, v7, v6
    v_mul_u32_u24 v244, 1152, v7
    v_lshl_add_u32 v244, v3, 4, v244
    v_add_u32 v244, s43, v244
    v_cmp_eq_u32 vcc, 9, v3
    s_nop 1
    v_cndmask_b32 v244, v244, v9, vcc
    v_lshl_add_u32 v5, v5, 2, v6
    v_lshrrev_b32 v7, 1, v5
    v_mul_u32_u24 v7, 18, v7
    v_and_b32 v5, 1, v5
    v_add3_u32 v7, v7, v5, 16
    v_mul_u32_u24 v4, 72, v4
    v_add_u32 v7, v7, v4
    v_mul_u32_u24 v249, 1152, v7
    v_lshl_add_u32 v249, v3, 4, v249
    v_add_u32 v249, s43, v249
    v_cmp_eq_u32 vcc, 9, v3
    s_nop 1
    v_cndmask_b32 v249, v249, v9, vcc
    v_lshlrev_b32 v253, 2, v0
    v_add_u32 v253, 162816, v253
    v_mov_b32 v254, 163712
    v_cmp_eq_u32 vcc, 0, v0
    s_nop 1
    v_cndmask_b32 v253, v253, v254, vcc
    v_mov_b32 v254, 1
    v_and_b32 v1, 15, v0
    v_lshrrev_b32 v2, 4, v0
    v_lshrrev_b32 v3, 1, v1
    v_xor_b32 v2, v2, v3
    v_lshlrev_b32 v2, 4, v2
    v_lshl_add_u32 v171, v1, 7, v2
    v_add_u32 v171, s61, v171
    v_xor_b32 v172, 64, v171
    v_lshrrev_b32 v1, 5, v0
    v_bfe_u32 v173, v0, 2, 3
    v_lshl_add_u32 v1, v1, 4, v173
    v_mul_u32_u24 v1, 288, v1
    v_and_b32 v173, 3, v0
    v_lshl_add_u32 v173, v173, 3, v1
    v_and_b32 v1, 15, v0
    v_lshrrev_b32 v2, 4, v0
    v_mul_u32_u24 v3, 2336, v2
    s_mul_i32 s42, s41, 9344
    s_add_u32 s42, s42, 112640
    v_add_u32 v201, s42, v3
    v_lshl_add_u32 v200, v1, 4, v201
    v_mov_b32 v216, 0x3f803f80
    v_mov_b32 v217, 0x3f803f80
    v_mov_b32 v218, 0x3f803f80
    v_mov_b32 v219, 0x3f803f80
    s_mul_i32 s42, s41, 288
    s_add_u32 s42, s42, 112640
    v_add_u32 v4, s42, v3
    v_lshl_add_u32 v202, v1, 4, v4
    v_add_u32 v203, 1152, v202
    v_add_u32 v5, 114944, v3
    v_add_u32 v204, 256, v202
    v_add_u32 v7, 1376, v202
    v_cmp_lt_u32 vcc, 1, v1
    s_nop 1
    v_cndmask_b32 v204, v204, v7, vcc
    v_add_u32 v7, 1328, v202
    v_cmp_lt_u32 vcc, 4, v1
    s_nop 1
    v_cndmask_b32 v204, v204, v7, vcc
    v_cmp_eq_u32 vcc, 4, v1
    s_nop 1
    v_cndmask_b32 v204, v204, v5, vcc
    v_cmp_le_u32 vcc, 7, v1
    s_nop 1
    v_cndmask_b32 v204, v204, v5, vcc
    v_lshlrev_b32 v208, 2, v0
    v_lshl_add_u32 v4, v2, 3, v1
    v_lshlrev_b32 v4, 2, v4
    v_mov_b32 v5, 1073741824
    v_cndmask_b32 v209, v5, v4, s[72:73]
    v_and_b32 v210, 31, v0
    v_lshlrev_b32 v210, 2, v210
    s_mul_i32 s68, s41, 1520
    s_add_u32 s68, s68, 153600
    s_lshl_b32 s43, s41, 1
    v_lshl_add_u32 v4, v2, 2, s43
    v_bfe_u32 v211, v4, 2, 2
    v_lshlrev_b32 v211, 4, v211
    v_lshrrev_b32 v5, 4, v4
    v_lshl_add_u32 v211, v5, 3, v211
    v_and_b32 v5, 3, v4
    v_lshl_add_u32 v211, v5, 1, v211
    v_add_u32 v4, 2, v4
    v_bfe_u32 v212, v4, 2, 2
    v_lshlrev_b32 v212, 4, v212
    v_lshrrev_b32 v5, 4, v4
    v_lshl_add_u32 v212, v5, 3, v212
    v_and_b32 v5, 3, v4
    v_lshl_add_u32 v212, v5, 1, v212
    v_mul_u32_u24 v6, 80, v1
    v_add_u32 v6, s68, v6
    v_add_u32 v211, v211, v6
    v_add_u32 v212, v212, v6
    v_and_b32 v1, 7, v0
    v_bfe_u32 v2, v0, 3, 2
    v_lshl_add_u32 v4, v2, 2, s43
    v_bfe_u32 v213, v4, 2, 2
    v_lshlrev_b32 v213, 4, v213
    v_lshrrev_b32 v5, 4, v4
    v_lshl_add_u32 v213, v5, 3, v213
    v_and_b32 v5, 3, v4
    v_lshl_add_u32 v213, v5, 1, v213
    v_add_u32 v4, 2, v4
    v_bfe_u32 v214, v4, 2, 2
    v_lshlrev_b32 v214, 4, v214
    v_lshrrev_b32 v5, 4, v4
    v_lshl_add_u32 v214, v5, 3, v214
    v_and_b32 v5, 3, v4
    v_lshl_add_u32 v214, v5, 1, v214
    v_mul_u32_u24 v6, 80, v1
    v_add_u32 v6, s68, v6
    v_add_u32 v6, 1280, v6
    v_subrev_u32 v4, 160, v6
    v_add_u32 v213, v213, v4
    v_add_u32 v214, v214, v4
    v_mov_b32 v7, 159744
    v_subrev_u32 v4, 2, v1
    v_cmp_gt_u32 vcc, 3, v4
    s_nop 1
    v_cndmask_b32 v213, v7, v213, vcc
    v_cndmask_b32 v214, v7, v214, vcc
    s_add_u32 s42, s43, 16
    v_mov_b32 v4, s42
    v_bfe_u32 v9, v4, 2, 2
    v_lshlrev_b32 v9, 4, v9
    v_lshrrev_b32 v5, 4, v4
    v_lshl_add_u32 v9, v5, 3, v9
    v_and_b32 v5, 3, v4
    v_lshl_add_u32 v9, v5, 1, v9
    v_add_u32 v9, v9, v6
    v_subrev_u32 v9, 400, v9
    v_and_b32 v4, 31, v0
    v_subrev_u32 v4, 5, v4
    v_cmp_gt_u32 vcc, 3, v4
    s_nop 1
    v_cndmask_b32 v213, v213, v9, vcc
    v_add_u32 v4, s42, v1
    v_bfe_u32 v215, v4, 2, 2
    v_lshlrev_b32 v215, 4, v215
    v_lshrrev_b32 v5, 4, v4
    v_lshl_add_u32 v215, v5, 3, v215
    v_and_b32 v5, 3, v4
    v_lshl_add_u32 v215, v5, 1, v215
    v_mul_u32_u24 v6, 320, v2
    v_add3_u32 v215, v215, v6, s68
    v_cmp_gt_u32 vcc, 2, v1
    s_nop 1
    v_cndmask_b32 v215, v7, v215, vcc
    s_lshl_b32 s42, s38, 2
    s_add_u32 s42, s42, s41
    s_lshl_b32 s64, s42, 11
    s_add_u32 s64, s64, 5242880
    s_add_u32 s79, s64, 1536
    v_mov_b32 v4, 0
    v_mov_b32 v5, 0
    v_mov_b32 v6, 0
    v_mov_b32 v7, 0
    s_lshl_b32 s42, s41, 10
    s_add_u32 s42, s42, 153600
    v_lshl_add_u32 v3, v0, 4, s42
    ds_write_b128 v3, v[4:7]
    ds_write_b128 v3, v[4:7] offset:4096
    s_mov_b64 vcc, 0
    s_cmp_eq_u32 s37, 0
    s_cbranch_scc0 L_ni1
    v_lshlrev_b32 v3, 4, v0
    buffer_store_dwordx4 v[4:7], v3, s[24:27], s64 offen sc1
    buffer_store_dwordx4 v[4:7], v3, s[24:27], s64 offen offset:1024 sc1
    s_mov_b64 vcc, 1
L_ni1:
    s_mov_b32 s74, 0x3fb8aa3b
    s_mov_b32 s75, 0x3fb8aa3b
    s_mov_b32 s68, 0x358637bd
    v_mov_b32 v8, 0xb5c1a2a0
    v_mov_b32 v1, 0x358637bd
    v_cndmask_b32 v2, 0, v1, s[72:73]
    s_waitcnt lgkmcnt(0)
    v_mov_b32 v12, v1
    v_mov_b32 v13, v1
    v_mov_b32 v14, v1
    v_mov_b32 v15, v1
    v_mov_b32 v16, v1
    v_mov_b32 v17, v1
    v_mov_b32 v18, v1
    v_mov_b32 v19, v1
    v_mov_b32 v20, v1
    v_mov_b32 v21, v1
    v_mov_b32 v22, v1
    v_mov_b32 v23, v1
    v_mov_b32 v24, v1
    v_mov_b32 v25, v1
    v_mov_b32 v26, v1
    v_mov_b32 v27, v1
    v_mov_b32 v28, v2
    v_mov_b32 v29, v2
    v_mov_b32 v30, v2
    v_mov_b32 v31, v2
    v_mov_b32 v32, 0
    v_mov_b32 v33, 0
    v_mov_b32 v34, 0
    v_mov_b32 v35, 0
    v_mov_b32 v36, 0
    v_mov_b32 v37, 0
    v_mov_b32 v38, 0
    v_mov_b32 v39, 0
    v_mov_b32 v40, 0
    v_mov_b32 v41, 0
    v_mov_b32 v42, 0
    v_mov_b32 v43, 0
    v_mov_b32 v44, 0
    v_mov_b32 v45, 0
    v_mov_b32 v46, 0
    v_mov_b32 v47, 0
    v_mov_b32 v48, v1
    v_mov_b32 v49, v1
    v_mov_b32 v50, v1
    v_mov_b32 v51, v1
    v_mov_b32 v52, v1
    v_mov_b32 v53, v1
    v_mov_b32 v54, v1
    v_mov_b32 v55, v1
    v_mov_b32 v56, v1
    v_mov_b32 v57, v1
    v_mov_b32 v58, v1
    v_mov_b32 v59, v1
    v_mov_b32 v60, v1
    v_mov_b32 v61, v1
    v_mov_b32 v62, v1
    v_mov_b32 v63, v1
    v_mov_b32 v64, v2
    v_mov_b32 v65, v2
    v_mov_b32 v66, v2
    v_mov_b32 v67, v2
    v_mov_b32 v68, 0
    v_mov_b32 v69, 0
    v_mov_b32 v70, 0
    v_mov_b32 v71, 0
    v_mov_b32 v72, 0
    v_mov_b32 v73, 0
    v_mov_b32 v74, 0
    v_mov_b32 v75, 0
    v_mov_b32 v76, 0
    v_mov_b32 v77, 0
    v_mov_b32 v78, 0
    v_mov_b32 v79, 0
    v_mov_b32 v80, 0
    v_mov_b32 v81, 0
    v_mov_b32 v82, 0
    v_mov_b32 v83, 0
    s_mov_b32 s67, 110592
    s_mov_b32 s66, 0
    v_add_u32 v174, 110592, v173
    v_add_u32 v168, 110592, v171
    v_add_u32 v169, 110592, v172
    v_mov_b32 v170, v174
    s_barrier
    ds_read_b64_tr_b16 v[112:113], v170 offset:18432
    ds_read_b64_tr_b16 v[114:115], v170 offset:20736
    ds_read_b128 v[152:155], v168 offset:0
    ds_read_b64_tr_b16 v[116:117], v170 offset:18464
    ds_read_b64_tr_b16 v[118:119], v170 offset:20768
    ds_read_b128 v[156:159], v168 offset:2048
    ds_read_b64_tr_b16 v[120:121], v170 offset:18496
    ds_read_b64_tr_b16 v[122:123], v170 offset:20800
    ds_read_b64_tr_b16 v[124:125], v170 offset:18528
    ds_read_b64_tr_b16 v[126:127], v170 offset:20832
L_kl_b:
    ds_read_b64_tr_b16 v[128:129], v170 offset:18560
    s_waitcnt lgkmcnt(5)
    v_mfma_f32_16x16x32_bf16 v[12:15], v[152:155], v[112:115], v[12:15]
    ds_read_b64_tr_b16 v[130:131], v170 offset:20864
    s_add_u32 s42, s67, 36864
    v_mfma_f32_16x16x32_bf16 v[48:51], v[156:159], v[112:115], v[48:51]
    ds_read_b64_tr_b16 v[132:133], v170 offset:18592
    v_mfma_f32_16x16x32_bf16 v[16:19], v[152:155], v[116:119], v[16:19]
    ds_read_b64_tr_b16 v[134:135], v170 offset:20896
    s_cmp_eq_u32 s67, 110592
    v_mfma_f32_16x16x32_bf16 v[52:55], v[156:159], v[116:119], v[52:55]
    ds_read_b64_tr_b16 v[136:137], v170 offset:18624
    s_waitcnt lgkmcnt(7)
    v_mfma_f32_16x16x32_bf16 v[20:23], v[152:155], v[120:123], v[20:23]
    ds_read_b64_tr_b16 v[138:139], v170 offset:20928
    ds_read_b128 v[160:163], v169 offset:0
    v_mfma_f32_16x16x32_bf16 v[56:59], v[156:159], v[120:123], v[56:59]
    ds_read_b64_tr_b16 v[140:141], v170 offset:18656
    s_waitcnt lgkmcnt(8)
    v_mfma_f32_16x16x32_bf16 v[24:27], v[152:155], v[124:127], v[24:27]
    ds_read_b64_tr_b16 v[142:143], v170 offset:20960
    ds_read_b128 v[164:167], v169 offset:2048
    v_mfma_f32_16x16x32_bf16 v[60:63], v[156:159], v[124:127], v[60:63]
    ds_read_b64_tr_b16 v[144:145], v170 offset:18688
    s_waitcnt lgkmcnt(9)
    v_mfma_f32_16x16x32_bf16 v[28:31], v[152:155], v[128:131], v[28:31]
    ds_read_b64_tr_b16 v[146:147], v170 offset:20992
    s_cselect_b32 s67, 0, s42
    v_mfma_f32_16x16x32_bf16 v[64:67], v[156:159], v[128:131], v[64:67]
    ds_read_b64_tr_b16 v[112:113], v170 offset:27648
    s_waitcnt lgkmcnt(9)
    v_mfma_f32_16x16x32_bf16 v[32:35], v[152:155], v[132:135], v[32:35]
    ds_read_b64_tr_b16 v[114:115], v170 offset:29952
    v_add_u32 v174, s67, v173
    v_mfma_f32_16x16x32_bf16 v[68:71], v[156:159], v[132:135], v[68:71]
    ds_read_b64_tr_b16 v[116:117], v170 offset:27680
    s_waitcnt lgkmcnt(9)
    v_mfma_f32_16x16x32_bf16 v[36:39], v[152:155], v[136:139], v[36:39]
    ds_read_b64_tr_b16 v[118:119], v170 offset:29984
    v_add_u32 v168, s67, v171
    v_mfma_f32_16x16x32_bf16 v[72:75], v[156:159], v[136:139], v[72:75]
    ds_read_b64_tr_b16 v[120:121], v170 offset:27712
    s_waitcnt lgkmcnt(8)
    v_mfma_f32_16x16x32_bf16 v[40:43], v[152:155], v[140:143], v[40:43]
    ds_read_b64_tr_b16 v[122:123], v170 offset:30016
    v_add_u32 v169, s67, v172
    v_mfma_f32_16x16x32_bf16 v[76:79], v[156:159], v[140:143], v[76:79]
    ds_read_b64_tr_b16 v[124:125], v170 offset:27744
    s_waitcnt lgkmcnt(7)
    v_mfma_f32_16x16x32_bf16 v[44:47], v[152:155], v[144:147], v[44:47]
    ds_read_b64_tr_b16 v[126:127], v170 offset:30048
    s_add_u32 s66, s66, 1
    v_mfma_f32_16x16x32_bf16 v[80:83], v[156:159], v[144:147], v[80:83]
    ds_read_b64_tr_b16 v[128:129], v170 offset:27776
    s_waitcnt lgkmcnt(7)
    v_mfma_f32_16x16x32_bf16 v[12:15], v[160:163], v[112:115], v[12:15]
    ds_read_b64_tr_b16 v[130:131], v170 offset:30080
    s_cmp_lt_u32 s66, 8
    v_mfma_f32_16x16x32_bf16 v[48:51], v[164:167], v[112:115], v[48:51]
    ds_read_b64_tr_b16 v[132:133], v170 offset:27808
    s_waitcnt lgkmcnt(7)
    v_mfma_f32_16x16x32_bf16 v[16:19], v[160:163], v[116:119], v[16:19]
    ds_read_b64_tr_b16 v[134:135], v170 offset:30112
    s_cbranch_vccnz L_id_b
L_ir_b:
    v_mfma_f32_16x16x32_bf16 v[52:55], v[164:167], v[116:119], v[52:55]
    ds_read_b64_tr_b16 v[136:137], v170 offset:27840
    s_waitcnt lgkmcnt(7)
    v_mfma_f32_16x16x32_bf16 v[20:23], v[160:163], v[120:123], v[20:23]
    ds_read_b64_tr_b16 v[138:139], v170 offset:30144
    v_mfma_f32_16x16x32_bf16 v[56:59], v[164:167], v[120:123], v[56:59]
    ds_read_b64_tr_b16 v[140:141], v170 offset:27872
    s_waitcnt lgkmcnt(7)
    v_mfma_f32_16x16x32_bf16 v[24:27], v[160:163], v[124:127], v[24:27]
    ds_read_b64_tr_b16 v[142:143], v170 offset:30176
    v_mfma_f32_16x16x32_bf16 v[60:63], v[164:167], v[124:127], v[60:63]
    ds_read_b64_tr_b16 v[144:145], v170 offset:27904
    s_waitcnt lgkmcnt(7)
    v_mfma_f32_16x16x32_bf16 v[28:31], v[160:163], v[128:131], v[28:31]
    ds_read_b64_tr_b16 v[146:147], v170 offset:30208
    s_barrier
    v_mfma_f32_16x16x32_bf16 v[64:67], v[164:167], v[128:131], v[64:67]
    ds_read_b64_tr_b16 v[112:113], v174 offset:18432
    s_waitcnt lgkmcnt(7)
    v_mfma_f32_16x16x32_bf16 v[32:35], v[160:163], v[132:135], v[32:35]
    ds_read_b64_tr_b16 v[114:115], v174 offset:20736
    ds_read_b128 v[152:155], v168 offset:0
    v_mfma_f32_16x16x32_bf16 v[68:71], v[164:167], v[132:135], v[68:71]
    ds_read_b64_tr_b16 v[116:117], v174 offset:18464
    s_waitcnt lgkmcnt(8)
    v_mfma_f32_16x16x32_bf16 v[36:39], v[160:163], v[136:139], v[36:39]
    ds_read_b64_tr_b16 v[118:119], v174 offset:20768
    ds_read_b128 v[156:159], v168 offset:2048
    v_mfma_f32_16x16x32_bf16 v[72:75], v[164:167], v[136:139], v[72:75]
    ds_read_b64_tr_b16 v[120:121], v174 offset:18496
    s_waitcnt lgkmcnt(9)
    v_mfma_f32_16x16x32_bf16 v[40:43], v[160:163], v[140:143], v[40:43]
    ds_read_b64_tr_b16 v[122:123], v174 offset:20800
    v_mfma_f32_16x16x32_bf16 v[76:79], v[164:167], v[140:143], v[76:79]
    ds_read_b64_tr_b16 v[124:125], v174 offset:18528
    s_waitcnt lgkmcnt(9)
    v_mfma_f32_16x16x32_bf16 v[44:47], v[160:163], v[144:147], v[44:47]
    ds_read_b64_tr_b16 v[126:127], v174 offset:20832
    v_mov_b32 v170, v174
    v_mfma_f32_16x16x32_bf16 v[80:83], v[164:167], v[144:147], v[80:83]
    s_cbranch_scc1 L_kl_b
    ds_read_b64_tr_b16 v[128:129], v170 offset:18560
    s_waitcnt lgkmcnt(5)
    v_mfma_f32_16x16x32_bf16 v[12:15], v[152:155], v[112:115], v[12:15]
    ds_read_b64_tr_b16 v[130:131], v170 offset:20864
    v_mfma_f32_16x16x32_bf16 v[48:51], v[156:159], v[112:115], v[48:51]
    ds_read_b64_tr_b16 v[132:133], v170 offset:18592
    v_mfma_f32_16x16x32_bf16 v[16:19], v[152:155], v[116:119], v[16:19]
    ds_read_b64_tr_b16 v[134:135], v170 offset:20896
    v_mfma_f32_16x16x32_bf16 v[52:55], v[156:159], v[116:119], v[52:55]
    ds_read_b64_tr_b16 v[136:137], v170 offset:18624
    s_waitcnt lgkmcnt(7)
    v_mfma_f32_16x16x32_bf16 v[20:23], v[152:155], v[120:123], v[20:23]
    ds_read_b64_tr_b16 v[138:139], v170 offset:20928
    ds_read_b128 v[160:163], v169 offset:0
    v_mfma_f32_16x16x32_bf16 v[56:59], v[156:159], v[120:123], v[56:59]
    ds_read_b64_tr_b16 v[140:141], v170 offset:18656
    s_waitcnt lgkmcnt(8)
    v_mfma_f32_16x16x32_bf16 v[24:27], v[152:155], v[124:127], v[24:27]
    ds_read_b64_tr_b16 v[142:143], v170 offset:20960
    ds_read_b128 v[164:167], v169 offset:2048
    v_mfma_f32_16x16x32_bf16 v[60:63], v[156:159], v[124:127], v[60:63]
    ds_read_b64_tr_b16 v[144:145], v170 offset:18688
    s_waitcnt lgkmcnt(9)
    v_mfma_f32_16x16x32_bf16 v[28:31], v[152:155], v[128:131], v[28:31]
    ds_read_b64_tr_b16 v[146:147], v170 offset:20992
    s_barrier
    v_mfma_f32_16x16x32_bf16 v[64:67], v[156:159], v[128:131], v[64:67]
    ds_read_b64_tr_b16 v[112:113], v170 offset:27648
    s_waitcnt lgkmcnt(9)
    v_mfma_f32_16x16x32_bf16 v[32:35], v[152:155], v[132:135], v[32:35]
    ds_read_b64_tr_b16 v[114:115], v170 offset:29952
    v_mfma_f32_16x16x32_bf16 v[68:71], v[156:159], v[132:135], v[68:71]
    ds_read_b64_tr_b16 v[116:117], v170 offset:27680
    s_waitcnt lgkmcnt(9)
    v_mfma_f32_16x16x32_bf16 v[36:39], v[152:155], v[136:139], v[36:39]
    ds_read_b64_tr_b16 v[118:119], v170 offset:29984
    v_mfma_f32_16x16x32_bf16 v[72:75], v[156:159], v[136:139], v[72:75]
    ds_read_b64_tr_b16 v[120:121], v170 offset:27712
    s_waitcnt lgkmcnt(8)
    v_mfma_f32_16x16x32_bf16 v[40:43], v[152:155], v[140:143], v[40:43]
    ds_read_b64_tr_b16 v[122:123], v170 offset:30016
    v_mfma_f32_16x16x32_bf16 v[76:79], v[156:159], v[140:143], v[76:79]
    ds_read_b64_tr_b16 v[124:125], v170 offset:27744
    s_waitcnt lgkmcnt(7)
    v_mfma_f32_16x16x32_bf16 v[44:47], v[152:155], v[144:147], v[44:47]
    ds_read_b64_tr_b16 v[126:127], v170 offset:30048
    v_mfma_f32_16x16x32_bf16 v[80:83], v[156:159], v[144:147], v[80:83]
    ds_read_b64_tr_b16 v[128:129], v170 offset:27776
    s_waitcnt lgkmcnt(7)
    v_mfma_f32_16x16x32_bf16 v[12:15], v[160:163], v[112:115], v[12:15]
    ds_read_b64_tr_b16 v[130:131], v170 offset:30080
    v_mfma_f32_16x16x32_bf16 v[48:51], v[164:167], v[112:115], v[48:51]
    ds_read_b64_tr_b16 v[132:133], v170 offset:27808
    s_waitcnt lgkmcnt(7)
    v_mfma_f32_16x16x32_bf16 v[16:19], v[160:163], v[116:119], v[16:19]
    ds_read_b64_tr_b16 v[134:135], v170 offset:30112
    v_mfma_f32_16x16x32_bf16 v[52:55], v[164:167], v[116:119], v[52:55]
    ds_read_b64_tr_b16 v[136:137], v170 offset:27840
    s_waitcnt lgkmcnt(7)
    v_mfma_f32_16x16x32_bf16 v[20:23], v[160:163], v[120:123], v[20:23]
    ds_read_b64_tr_b16 v[138:139], v170 offset:30144
    v_mfma_f32_16x16x32_bf16 v[56:59], v[164:167], v[120:123], v[56:59]
    ds_read_b64_tr_b16 v[140:141], v170 offset:27872
    s_waitcnt lgkmcnt(7)
    v_mfma_f32_16x16x32_bf16 v[24:27], v[160:163], v[124:127], v[24:27]
    ds_read_b64_tr_b16 v[142:143], v170 offset:30176
    s_setprio 3
    v_mfma_f32_16x16x32_bf16 v[60:63], v[164:167], v[124:127], v[60:63]
    ds_read_b64_tr_b16 v[144:145], v170 offset:27904
    s_waitcnt lgkmcnt(7)
    v_mfma_f32_16x16x32_bf16 v[28:31], v[160:163], v[128:131], v[28:31]
    ds_read_b64_tr_b16 v[146:147], v170 offset:30208
    v_mfma_f32_16x16x32_bf16 v[64:67], v[164:167], v[128:131], v[64:67]
    s_waitcnt lgkmcnt(6)
    v_mfma_f32_16x16x32_bf16 v[32:35], v[160:163], v[132:135], v[32:35]
    v_mfma_f32_16x16x32_bf16 v[68:71], v[164:167], v[132:135], v[68:71]
    s_waitcnt lgkmcnt(4)
    v_mfma_f32_16x16x32_bf16 v[36:39], v[160:163], v[136:139], v[36:39]
    s_waitcnt lgkmcnt(0)
    s_barrier
    v_mfma_f32_16x16x32_bf16 v[72:75], v[164:167], v[136:139], v[72:75]
    v_mfma_f32_16x16x32_bf16 v[40:43], v[160:163], v[140:143], v[40:43]
    v_mfma_f32_16x16x32_bf16 v[76:79], v[164:167], v[140:143], v[76:79]
    v_mfma_f32_16x16x32_bf16 v[44:47], v[160:163], v[144:147], v[44:47]
    v_mfma_f32_16x16x32_bf16 v[80:83], v[164:167], v[144:147], v[80:83]
    s_waitcnt vmcnt(0)
    ds_write_b128 v201, v[216:219] offset:2304
    v_cvt_pk_bf16_f32 v172, v28, v29
    v_cvt_pk_bf16_f32 v173, v30, v31
    v_cvt_pk_bf16_f32 v174, v64, v65
    v_cvt_pk_bf16_f32 v175, v66, v67
    v_cvt_pk_bf16_f32 v132, v32, v33
    v_cvt_pk_bf16_f32 v133, v34, v35
    v_cvt_pk_bf16_f32 v134, v68, v69
    v_cvt_pk_bf16_f32 v135, v70, v71
    ds_write_b128 v200, v[132:135] offset:1280
    v_pk_fma_f32 v[176:177], v[12:13], s[74:75], v[8:9] op_sel_hi:[1,1,0]
    v_pk_fma_f32 v[178:179], v[14:15], s[74:75], v[8:9] op_sel_hi:[1,1,0]
    v_pk_fma_f32 v[180:181], v[48:49], s[74:75], v[8:9] op_sel_hi:[1,1,0]
    v_pk_fma_f32 v[182:183], v[50:51], s[74:75], v[8:9] op_sel_hi:[1,1,0]
    v_exp_f32_e64 v176, v176 clamp
    v_max_f32 v12, s68, v12
    v_exp_f32_e64 v177, v177 clamp
    v_max_f32 v13, s68, v13
    v_exp_f32_e64 v178, v178 clamp
    v_max_f32 v14, s68, v14
    v_exp_f32_e64 v179, v179 clamp
    v_max_f32 v15, s68, v15
    v_exp_f32_e64 v180, v180 clamp
    v_max_f32 v48, s68, v48
    v_exp_f32_e64 v181, v181 clamp
    v_max_f32 v49, s68, v49
    v_exp_f32_e64 v182, v182 clamp
    v_max_f32 v50, s68, v50
    v_exp_f32_e64 v183, v183 clamp
    v_max_f32 v51, s68, v51
    v_pk_add_f32 v[12:13], v[12:13], v[176:177]
    v_pk_add_f32 v[14:15], v[14:15], v[178:179]
    v_pk_add_f32 v[48:49], v[48:49], v[180:181]
    v_pk_add_f32 v[50:51], v[50:51], v[182:183]
    v_cvt_pk_bf16_f32 v112, v12, v13
    v_cvt_pk_bf16_f32 v113, v14, v15
    v_cvt_pk_bf16_f32 v114, v48, v49
    v_cvt_pk_bf16_f32 v115, v50, v51
    ds_write_b128 v200, v[112:115] offset:0
    v_cvt_pk_bf16_f32 v136, v36, v37
    v_cvt_pk_bf16_f32 v137, v38, v39
    v_cvt_pk_bf16_f32 v138, v72, v73
    v_cvt_pk_bf16_f32 v139, v74, v75
    ds_write_b128 v200, v[136:139] offset:1536
    v_pk_fma_f32 v[176:177], v[16:17], s[74:75], v[8:9] op_sel_hi:[1,1,0]
    v_pk_fma_f32 v[178:179], v[18:19], s[74:75], v[8:9] op_sel_hi:[1,1,0]
    v_pk_fma_f32 v[180:181], v[52:53], s[74:75], v[8:9] op_sel_hi:[1,1,0]
    v_pk_fma_f32 v[182:183], v[54:55], s[74:75], v[8:9] op_sel_hi:[1,1,0]
    v_exp_f32_e64 v176, v176 clamp
    v_max_f32 v16, s68, v16
    v_exp_f32_e64 v177, v177 clamp
    v_max_f32 v17, s68, v17
    v_exp_f32_e64 v178, v178 clamp
    v_max_f32 v18, s68, v18
    v_exp_f32_e64 v179, v179 clamp
    v_max_f32 v19, s68, v19
    v_exp_f32_e64 v180, v180 clamp
    v_max_f32 v52, s68, v52
    v_exp_f32_e64 v181, v181 clamp
    v_max_f32 v53, s68, v53
    v_exp_f32_e64 v182, v182 clamp
    v_max_f32 v54, s68, v54
    v_exp_f32_e64 v183, v183 clamp
    v_max_f32 v55, s68, v55
    v_pk_add_f32 v[16:17], v[16:17], v[176:177]
    v_pk_add_f32 v[18:19], v[18:19], v[178:179]
    v_pk_add_f32 v[52:53], v[52:53], v[180:181]
    v_pk_add_f32 v[54:55], v[54:55], v[182:183]
    v_cvt_pk_bf16_f32 v116, v16, v17
    v_cvt_pk_bf16_f32 v117, v18, v19
    v_cvt_pk_bf16_f32 v118, v52, v53
    v_cvt_pk_bf16_f32 v119, v54, v55
    ds_write_b128 v200, v[116:119] offset:256
    v_cvt_pk_bf16_f32 v140, v40, v41
    v_cvt_pk_bf16_f32 v141, v42, v43
    v_cvt_pk_bf16_f32 v142, v76, v77
    v_cvt_pk_bf16_f32 v143, v78, v79
    ds_write_b128 v200, v[140:143] offset:1792
    v_pk_fma_f32 v[176:177], v[20:21], s[74:75], v[8:9] op_sel_hi:[1,1,0]
    v_pk_fma_f32 v[178:179], v[22:23], s[74:75], v[8:9] op_sel_hi:[1,1,0]
    v_pk_fma_f32 v[180:181], v[56:57], s[74:75], v[8:9] op_sel_hi:[1,1,0]
    v_pk_fma_f32 v[182:183], v[58:59], s[74:75], v[8:9] op_sel_hi:[1,1,0]
    v_exp_f32_e64 v176, v176 clamp
    v_max_f32 v20, s68, v20
    v_exp_f32_e64 v177, v177 clamp
    v_max_f32 v21, s68, v21
    v_exp_f32_e64 v178, v178 clamp
    v_max_f32 v22, s68, v22
    v_exp_f32_e64 v179, v179 clamp
    v_max_f32 v23, s68, v23
    v_exp_f32_e64 v180, v180 clamp
    v_max_f32 v56, s68, v56
    v_exp_f32_e64 v181, v181 clamp
    v_max_f32 v57, s68, v57
    v_exp_f32_e64 v182, v182 clamp
    v_max_f32 v58, s68, v58
    v_exp_f32_e64 v183, v183 clamp
    v_max_f32 v59, s68, v59
    v_pk_add_f32 v[20:21], v[20:21], v[176:177]
    v_pk_add_f32 v[22:23], v[22:23], v[178:179]
    v_pk_add_f32 v[56:57], v[56:57], v[180:181]
    v_pk_add_f32 v[58:59], v[58:59], v[182:183]
    v_cvt_pk_bf16_f32 v120, v20, v21
    v_cvt_pk_bf16_f32 v121, v22, v23
    v_cvt_pk_bf16_f32 v122, v56, v57
    v_cvt_pk_bf16_f32 v123, v58, v59
    ds_write_b128 v200, v[120:123] offset:512
    ds_add_u32 v253, v254 offset:48
    v_cvt_pk_bf16_f32 v144, v44, v45
    v_cvt_pk_bf16_f32 v145, v46, v47
    v_cvt_pk_bf16_f32 v146, v80, v81
    v_cvt_pk_bf16_f32 v147, v82, v83
    ds_write_b128 v200, v[144:147] offset:2048
    v_pk_fma_f32 v[176:177], v[24:25], s[74:75], v[8:9] op_sel_hi:[1,1,0]
    v_pk_fma_f32 v[178:179], v[26:27], s[74:75], v[8:9] op_sel_hi:[1,1,0]
    v_pk_fma_f32 v[180:181], v[60:61], s[74:75], v[8:9] op_sel_hi:[1,1,0]
    v_pk_fma_f32 v[182:183], v[62:63], s[74:75], v[8:9] op_sel_hi:[1,1,0]
    v_exp_f32_e64 v176, v176 clamp
    v_max_f32 v24, s68, v24
    v_exp_f32_e64 v177, v177 clamp
    v_max_f32 v25, s68, v25
    v_exp_f32_e64 v178, v178 clamp
    v_max_f32 v26, s68, v26
    v_exp_f32_e64 v179, v179 clamp
    v_max_f32 v27, s68, v27
    v_exp_f32_e64 v180, v180 clamp
    v_max_f32 v60, s68, v60
    v_exp_f32_e64 v181, v181 clamp
    v_max_f32 v61, s68, v61
    v_exp_f32_e64 v182, v182 clamp
    v_max_f32 v62, s68, v62
    v_exp_f32_e64 v183, v183 clamp
    v_max_f32 v63, s68, v63
    v_pk_add_f32 v[24:25], v[24:25], v[176:177]
    v_pk_add_f32 v[26:27], v[26:27], v[178:179]
    v_pk_add_f32 v[60:61], v[60:61], v[180:181]
    v_pk_add_f32 v[62:63], v[62:63], v[182:183]
    v_cvt_pk_bf16_f32 v124, v24, v25
    v_cvt_pk_bf16_f32 v125, v26, v27
    v_cvt_pk_bf16_f32 v126, v60, v61
    v_cvt_pk_bf16_f32 v127, v62, v63
    ds_write_b128 v200, v[124:127] offset:768
    v_pk_fma_f32 v[176:177], v[28:29], s[74:75], v[8:9] op_sel_hi:[1,1,0]
    v_pk_fma_f32 v[178:179], v[30:31], s[74:75], v[8:9] op_sel_hi:[1,1,0]
    v_pk_fma_f32 v[180:181], v[64:65], s[74:75], v[8:9] op_sel_hi:[1,1,0]
    v_pk_fma_f32 v[182:183], v[66:67], s[74:75], v[8:9] op_sel_hi:[1,1,0]
    v_exp_f32_e64 v176, v176 clamp
    v_max_f32 v28, s68, v28
    v_exp_f32_e64 v177, v177 clamp
    v_max_f32 v29, s68, v29
    v_exp_f32_e64 v178, v178 clamp
    v_max_f32 v30, s68, v30
    v_exp_f32_e64 v179, v179 clamp
    v_max_f32 v31, s68, v31
    v_exp_f32_e64 v180, v180 clamp
    v_max_f32 v64, s68, v64
    v_exp_f32_e64 v181, v181 clamp
    v_max_f32 v65, s68, v65
    v_exp_f32_e64 v182, v182 clamp
    v_max_f32 v66, s68, v66
    v_exp_f32_e64 v183, v183 clamp
    v_max_f32 v67, s68, v67
    v_pk_add_f32 v[28:29], v[28:29], v[176:177]
    v_pk_add_f32 v[30:31], v[30:31], v[178:179]
    v_pk_add_f32 v[64:65], v[64:65], v[180:181]
    v_pk_add_f32 v[66:67], v[66:67], v[182:183]
    v_cvt_pk_bf16_f32 v128, v28, v29
    v_cvt_pk_bf16_f32 v129, v30, v31
    v_cvt_pk_bf16_f32 v130, v64, v65
    v_cvt_pk_bf16_f32 v131, v66, v67
    v_cndmask_b32 v128, v172, v128, s[72:73]
    v_cndmask_b32 v129, v173, v129, s[72:73]
    v_cndmask_b32 v130, v174, v130, s[72:73]
    v_cndmask_b32 v131, v175, v131, s[72:73]
    ds_write_b128 v200, v[128:131] offset:1024
    s_waitcnt lgkmcnt(0)
    ds_add_u32 v253, v254 offset:40
    s_mov_b32 s78, 0
L_sp_bx:
    ds_read_b32 v255, v253 offset:40
    s_add_u32 s78, s78, 0x100
    s_cbranch_scc1 L_ok_bx
    s_waitcnt lgkmcnt(0)
    v_readfirstlane_b32 s42, v255
    s_cmp_ge_u32 s42, 4
    s_cbranch_scc0 L_sp_bx
    L_ok_bx:
    ds_read_b128 v[112:115], v202 offset:0
    ds_read_b128 v[116:119], v203 offset:0
    ds_read_b128 v[120:123], v204 offset:0
    ds_read_b128 v[124:127], v202 offset:9344
    ds_read_b128 v[128:131], v203 offset:9344
    ds_read_b128 v[132:135], v204 offset:9344
    ds_read_b128 v[136:139], v202 offset:18688
    ds_read_b128 v[140:143], v203 offset:18688
    ds_read_b128 v[144:147], v204 offset:18688
    ds_read_b128 v[148:151], v202 offset:28032
    ds_read_b128 v[152:155], v203 offset:28032
    ds_read_b128 v[156:159], v204 offset:28032
    s_mov_b32 s4, 0xfffcfffc
    s_mov_b32 s5, 0xfffcfffc
    s_mov_b32 s72, 0xffe0ffe0
    s_mov_b32 s73, 0xffe0ffe0
    s_waitcnt lgkmcnt(9)
    v_mfma_f32_16x16x32_bf16 v[160:163], v[112:115], v[116:119], 0
    v_mfma_f32_16x16x32_bf16 v[164:167], v[116:119], v[120:123], 0
    v_mfma_f32_16x16x32_bf16 v[12:15], v[112:115], v[120:123], 0
    v_mfma_f32_16x16x32_bf16 v[16:19], v[120:123], v[120:123], 0
    s_waitcnt lgkmcnt(6)
    v_mfma_f32_16x16x32_bf16 v[160:163], v[124:127], v[128:131], v[160:163]
    v_mfma_f32_16x16x32_bf16 v[164:167], v[128:131], v[132:135], v[164:167]
    v_mfma_f32_16x16x32_bf16 v[12:15], v[124:127], v[132:135], v[12:15]
    v_mfma_f32_16x16x32_bf16 v[16:19], v[132:135], v[132:135], v[16:19]
    s_waitcnt lgkmcnt(3)
    v_mfma_f32_16x16x32_bf16 v[160:163], v[136:139], v[140:143], v[160:163]
    v_mfma_f32_16x16x32_bf16 v[164:167], v[140:143], v[144:147], v[164:167]
    v_mfma_f32_16x16x32_bf16 v[12:15], v[136:139], v[144:147], v[12:15]
    v_mfma_f32_16x16x32_bf16 v[16:19], v[144:147], v[144:147], v[16:19]
    s_waitcnt lgkmcnt(0)
    v_mfma_f32_16x16x32_bf16 v[160:163], v[148:151], v[152:155], v[160:163]
    v_mfma_f32_16x16x32_bf16 v[164:167], v[152:155], v[156:159], v[164:167]
    v_mfma_f32_16x16x32_bf16 v[12:15], v[148:151], v[156:159], v[12:15]
    v_mfma_f32_16x16x32_bf16 v[16:19], v[156:159], v[156:159], v[16:19]
    ds_add_u32 v253, v254 offset:52
    s_nop 3
    buffer_atomic_add_f32 v160, v208, s[24:27], s64 offen offset:0 sc1
    buffer_atomic_add_f32 v161, v208, s[24:27], s64 offen offset:256 sc1
    buffer_atomic_add_f32 v162, v208, s[24:27], s64 offen offset:512 sc1
    buffer_atomic_add_f32 v163, v208, s[24:27], s64 offen offset:768 sc1
    v_cndmask_b32 v164, v164, v12, s[4:5]
    v_cndmask_b32 v165, v165, v13, s[4:5]
    v_cndmask_b32 v166, v166, v14, s[4:5]
    v_cndmask_b32 v167, v167, v15, s[4:5]
    v_cndmask_b32 v164, v164, v16, s[72:73]
    v_cndmask_b32 v165, v165, v17, s[72:73]
    v_cndmask_b32 v166, v166, v18, s[72:73]
    v_cndmask_b32 v167, v167, v19, s[72:73]
    buffer_atomic_add_f32 v164, v209, s[24:27], s64 offen offset:1024 sc1
    buffer_atomic_add_f32 v165, v209, s[24:27], s64 offen offset:1152 sc1
    buffer_atomic_add_f32 v166, v209, s[24:27], s64 offen offset:1280 sc1
    buffer_atomic_add_f32 v167, v209, s[24:27], s64 offen offset:1408 sc1
    s_setprio 0
    s_add_u32 s42, s41, 0
    s_cmp_lt_u32 s41, 2
    s_cselect_b32 s43, 0, s6
    s_add_u32 s42, s42, s43
    s_cmp_ge_u32 s42, 16
    s_cselect_b32 s43, 14, 0
    s_sub_u32 s42, s42, s43
    s_lshl_b32 s43, s38, 1
    s_add_u32 s42, s42, s43
    s_and_b32 s42, s42, 15
    s_lshr_b32 s43, s42, 1
    s_mul_i32 s43, s43, 82944
    s_and_b32 s42, s42, 1
    s_mul_i32 s42, s42, 41472
    s_add_u32 s55, s42, s43
    s_mul_i32 s43, s41, 5120
    s_add_u32 m0, s43, 92160
    s_nop 0
    buffer_load_dwordx4 v240, s[16:19], s55 offen lds
    s_add_u32 m0, s43, 93184
    s_nop 0
    buffer_load_dwordx4 v241, s[16:19], s55 offen lds
    s_add_u32 m0, s43, 94208
    s_nop 0
    buffer_load_dwordx4 v242, s[16:19], s55 offen lds
    s_add_u32 m0, s43, 95232
    s_nop 0
    buffer_load_dwordx4 v243, s[16:19], s55 offen lds
    s_add_u32 m0, s43, 96256
    s_nop 0
    buffer_load_dwordx4 v244, s[16:19], s55 offen lds
    s_mov_b32 s78, 0
L_sp_b0:
    ds_read_b32 v255, v253 offset:52
    s_add_u32 s78, s78, 0x100
    s_cbranch_scc1 L_ok_b0
    s_waitcnt lgkmcnt(0)
    v_readfirstlane_b32 s42, v255
    s_cmp_ge_u32 s42, 4
    s_cbranch_scc0 L_sp_b0
    L_ok_b0:
    s_add_u32 s42, s41, 4
    s_add_u32 s42, s42, s6
    s_cmp_ge_u32 s42, 16
    s_cselect_b32 s43, 14, 0
    s_sub_u32 s42, s42, s43
    s_lshl_b32 s43, s38, 1
    s_add_u32 s42, s42, s43
    s_and_b32 s42, s42, 15
    s_lshr_b32 s43, s42, 1
    s_mul_i32 s43, s43, 82944
    s_and_b32 s42, s42, 1
    s_mul_i32 s42, s42, 41472
    s_add_u32 s55, s42, s43
    s_mul_i32 s43, s41, 5120
    s_add_u32 m0, s43, 112640
    s_nop 0
    buffer_load_dwordx4 v240, s[16:19], s55 offen lds
    s_add_u32 m0, s43, 113664
    s_nop 0
    buffer_load_dwordx4 v241, s[16:19], s55 offen lds
    s_add_u32 m0, s43, 114688
    s_nop 0
    buffer_load_dwordx4 v242, s[16:19], s55 offen lds
    s_add_u32 m0, s43, 115712
    s_nop 0
    buffer_load_dwordx4 v243, s[16:19], s55 offen lds
    s_add_u32 m0, s43, 116736
    s_nop 0
    buffer_load_dwordx4 v244, s[16:19], s55 offen lds
    s_waitcnt vmcnt(10)
    v_mov_b32 v6, 1
    s_mov_b64 exec, 1
    buffer_atomic_add v6, off, s[24:27], s79 sc0 sc1
    s_mov_b64 exec, -1
    s_mov_b32 s66, 0
    s_waitcnt vmcnt(0)
    v_readfirstlane_b32 s42, v6
    s_cmp_ge_u32 s42, 15
    s_cbranch_scc1 L_got_b1
    s_mov_b64 exec, 1
    L_poll_b1:
    s_sleep 4
    v_mov_b32 v6, 0
    buffer_atomic_add v6, off, s[24:27], s79 sc0 sc1
    s_add_u32 s66, s66, 1
    s_cmp_ge_u32 s66, 1000000
    s_cbranch_scc1 L_got_b1
    s_waitcnt vmcnt(0)
    v_readfirstlane_b32 s42, v6
    s_cmp_ge_u32 s42, 16
    s_cbranch_scc0 L_poll_b1
    L_got_b1:
    s_mov_b64 exec, -1
    buffer_load_dword v12, v208, s[24:27], s64 offen offset:0 sc1
    buffer_load_dword v13, v208, s[24:27], s64 offen offset:256 sc1
    buffer_load_dword v14, v208, s[24:27], s64 offen offset:512 sc1
    buffer_load_dword v15, v208, s[24:27], s64 offen offset:768 sc1
    buffer_load_dword v168, v210, s[24:27], s64 offen offset:1024 sc1
    buffer_load_dword v169, v210, s[24:27], s64 offen offset:1152 sc1
    buffer_load_dword v170, v210, s[24:27], s64 offen offset:1280 sc1
    buffer_load_dword v171, v210, s[24:27], s64 offen offset:1408 sc1
    s_setprio 3
    s_waitcnt vmcnt(4)
    v_cvt_pk_bf16_f32 v20, v12, v13
    v_cvt_pk_bf16_f32 v21, v14, v15
    ds_write_b32 v211, v20
    ds_write_b32 v212, v21
    s_waitcnt vmcnt(0)
    v_cvt_pk_bf16_f32 v22, v168, v169
    v_cvt_pk_bf16_f32 v23, v170, v171
    ds_write_b32 v213, v22
    ds_write_b32 v214, v23
    ds_write_b16 v215, v22
    ds_write_b16_d16_hi v215, v22 offset:80
    ds_write_b16 v215, v23 offset:160
    ds_write_b16_d16_hi v215, v23 offset:240
    s_waitcnt lgkmcnt(0)
    ds_add_u32 v253, v254 offset:44
    s_setprio 0
    s_mov_b32 s78, 0
    s_branch L_s0_b3
L_sp_b3:
    s_sleep 3
L_s0_b3:
    ds_read_b32 v255, v253 offset:20
    s_add_u32 s78, s78, 0x100
    s_cbranch_scc1 L_ok_b3
    s_waitcnt lgkmcnt(0)
    v_readfirstlane_b32 s42, v255
    s_cmp_ge_u32 s42, 4
    s_cbranch_scc0 L_sp_b3
    L_ok_b3:
    s_add_u32 s42, s41, 8
    s_add_u32 s42, s42, s6
    s_cmp_ge_u32 s42, 16
    s_cselect_b32 s43, 14, 0
    s_sub_u32 s42, s42, s43
    s_lshl_b32 s43, s38, 1
    s_add_u32 s42, s42, s43
    s_and_b32 s42, s42, 15
    s_lshr_b32 s43, s42, 1
    s_mul_i32 s43, s43, 82944
    s_and_b32 s42, s42, 1
    s_mul_i32 s42, s42, 41472
    s_add_u32 s55, s42, s43
    s_mul_i32 s43, s41, 5120
    s_add_u32 m0, s43, 0
    s_nop 0
    buffer_load_dwordx4 v240, s[16:19], s55 offen lds
    s_add_u32 m0, s43, 1024
    s_nop 0
    buffer_load_dwordx4 v241, s[16:19], s55 offen lds
    s_add_u32 m0, s43, 2048
    s_nop 0
    buffer_load_dwordx4 v242, s[16:19], s55 offen lds
    s_add_u32 m0, s43, 3072
    s_nop 0
    buffer_load_dwordx4 v243, s[16:19], s55 offen lds
    s_add_u32 m0, s43, 4096
    s_nop 0
    buffer_load_dwordx4 v244, s[16:19], s55 offen lds
    s_add_u32 s42, s41, 12
    s_add_u32 s42, s42, s6
    s_cmp_ge_u32 s42, 16
    s_cselect_b32 s43, 14, 0
    s_sub_u32 s42, s42, s43
    s_lshl_b32 s43, s38, 1
    s_add_u32 s42, s42, s43
    s_and_b32 s42, s42, 15
    s_lshr_b32 s43, s42, 1
    s_mul_i32 s43, s43, 82944
    s_and_b32 s42, s42, 1
    s_mul_i32 s42, s42, 41472
    s_add_u32 s55, s42, s43
    s_mul_i32 s43, s41, 5120
    s_add_u32 m0, s43, 20480
    s_nop 0
    buffer_load_dwordx4 v240, s[16:19], s55 offen lds
    s_add_u32 m0, s43, 21504
    s_nop 0
    buffer_load_dwordx4 v241, s[16:19], s55 offen lds
    s_add_u32 m0, s43, 22528
    s_nop 0
    buffer_load_dwordx4 v242, s[16:19], s55 offen lds
    s_add_u32 m0, s43, 23552
    s_nop 0
    buffer_load_dwordx4 v243, s[16:19], s55 offen lds
    s_add_u32 m0, s43, 24576
    s_nop 0
    buffer_load_dwordx4 v244, s[16:19], s55 offen lds
    s_mov_b32 s78, 0
    s_branch L_s0_b4
L_sp_b4:
    s_sleep 3
L_s0_b4:
    ds_read_b32 v255, v253 offset:24
    s_add_u32 s78, s78, 0x100
    s_cbranch_scc1 L_ok_b4
    s_waitcnt lgkmcnt(0)
    v_readfirstlane_b32 s42, v255
    s_cmp_ge_u32 s42, 4
    s_cbranch_scc0 L_sp_b4
    L_ok_b4:
    s_mov_b32 s55, 0
    s_cmp_eq_u32 s41, 0
    s_cbranch_scc0 L_wlb00
    s_mov_b32 m0, 133120
    s_nop 0
    buffer_load_dwordx4 v245, s[16:19], s55 offen lds
    s_mov_b32 m0, 137216
    s_nop 0
    buffer_load_dwordx4 v249, s[16:19], s55 offen lds
L_wlb00:
    s_cmp_eq_u32 s41, 1
    s_cbranch_scc0 L_wlb01
    s_mov_b32 m0, 134144
    s_nop 0
    buffer_load_dwordx4 v246, s[16:19], s55 offen lds
L_wlb01:
    s_cmp_eq_u32 s41, 2
    s_cbranch_scc0 L_wlb02
    s_mov_b32 m0, 135168
    s_nop 0
    buffer_load_dwordx4 v247, s[16:19], s55 offen lds
L_wlb02:
    s_cmp_eq_u32 s41, 3
    s_cbranch_scc0 L_wlb03
    s_mov_b32 m0, 136192
    s_nop 0
    buffer_load_dwordx4 v248, s[16:19], s55 offen lds
L_wlb03:
    s_mov_b32 s55, 331776
    s_cmp_eq_u32 s41, 0
    s_cbranch_scc0 L_wlb10
    s_mov_b32 m0, 40960
    s_nop 0
    buffer_load_dwordx4 v245, s[16:19], s55 offen lds
    s_mov_b32 m0, 45056
    s_nop 0
    buffer_load_dwordx4 v249, s[16:19], s55 offen lds
L_wlb10:
    s_cmp_eq_u32 s41, 1
    s_cbranch_scc0 L_wlb11
    s_mov_b32 m0, 41984
    s_nop 0
    buffer_load_dwordx4 v246, s[16:19], s55 offen lds
L_wlb11:
    s_cmp_eq_u32 s41, 2
    s_cbranch_scc0 L_wlb12
    s_mov_b32 m0, 43008
    s_nop 0
    buffer_load_dwordx4 v247, s[16:19], s55 offen lds
L_wlb12:
    s_cmp_eq_u32 s41, 3
    s_cbranch_scc0 L_wlb13
    s_mov_b32 m0, 44032
    s_nop 0
    buffer_load_dwordx4 v248, s[16:19], s55 offen lds
L_wlb13:
    s_waitcnt vmcnt(0)
    s_barrier
    s_branch L_end
L_main:
    v_lshrrev_b32 v1, 5, v0
    v_bfe_u32 v30, v0, 2, 3
    v_lshl_add_u32 v1, v1, 4, v30
    v_mul_u32_u24 v1, 160, v1
    v_and_b32 v30, 3, v0
    v_lshl_add_u32 v30, v30, 3, v1
    v_add_u32 v29, s76, v30
    v_add_u32 v30, s77, v30
    s_mul_i32 s43, s36, 45056
    s_mul_i32 s42, s41, 5632
    s_add_u32 s42, s42, 94208
    s_sub_u32 s42, s42, s43
    v_and_b32 v1, 15, v0
    v_lshrrev_b32 v2, 4, v0
    v_mul_u32_u24 v1, 176, v1
    v_lshl_add_u32 v1, v2, 3, v1
    v_add_u32 v12, s42, v1
    v_mov_b32 v9, 1073741824
    v_add_u32 v1, 0, v0
    v_mul_u32_u24 v2, 7282, v1
    v_lshrrev_b32 v2, 16, v2
    v_mul_u32_u24 v3, 9, v2
    v_sub_u32 v3, v1, v3
    v_mul_u32_u24 v4, 176, v2
    v_lshl_add_u32 v4, v3, 4, v4
    v_add_u32 v13, s42, v4
    v_mul_u32_u24 v4, 4608, v2
    v_lshl_add_u32 v18, v3, 4, v4
    v_add_u32 v1, 64, v0
    v_mul_u32_u24 v2, 7282, v1
    v_lshrrev_b32 v2, 16, v2
    v_mul_u32_u24 v3, 9, v2
    v_sub_u32 v3, v1, v3
    v_mul_u32_u24 v4, 176, v2
    v_lshl_add_u32 v4, v3, 4, v4
    v_add_u32 v14, s42, v4
    v_mul_u32_u24 v4, 4608, v2
    v_lshl_add_u32 v19, v3, 4, v4
    v_add_u32 v1, 128, v0
    v_mul_u32_u24 v2, 7282, v1
    v_lshrrev_b32 v2, 16, v2
    v_mul_u32_u24 v3, 9, v2
    v_sub_u32 v3, v1, v3
    v_mul_u32_u24 v4, 176, v2
    v_lshl_add_u32 v4, v3, 4, v4
    v_add_u32 v15, s42, v4
    v_mul_u32_u24 v4, 4608, v2
    v_lshl_add_u32 v20, v3, 4, v4
    v_add_u32 v1, 192, v0
    v_mul_u32_u24 v2, 7282, v1
    v_lshrrev_b32 v2, 16, v2
    v_mul_u32_u24 v3, 9, v2
    v_sub_u32 v3, v1, v3
    v_mul_u32_u24 v4, 176, v2
    v_lshl_add_u32 v4, v3, 4, v4
    v_add_u32 v16, s42, v4
    v_mul_u32_u24 v4, 4608, v2
    v_lshl_add_u32 v21, v3, 4, v4
    v_add_u32 v1, 256, v0
    v_mul_u32_u24 v2, 7282, v1
    v_lshrrev_b32 v2, 16, v2
    v_mul_u32_u24 v3, 9, v2
    v_sub_u32 v3, v1, v3
    v_mul_u32_u24 v4, 176, v2
    v_lshl_add_u32 v4, v3, 4, v4
    v_add_u32 v17, s42, v4
    v_mul_u32_u24 v4, 4608, v2
    v_lshl_add_u32 v22, v3, 4, v4
    v_cmp_gt_u32 vcc, 32, v0
    s_nop 1
    v_cndmask_b32 v22, v9, v22, vcc
    v_cndmask_b32 v17, v13, v17, vcc
    v_add_u32 v11, 18432, v10
    s_lshl_b32 s42, s37, 7
    s_lshr_b32 s43, s41, 1
    s_lshl_b32 s43, s43, 6
    s_add_u32 s42, s42, s43
    s_and_b32 s43, s41, 1
    s_add_u32 s42, s42, s43
    s_mul_i32 s68, s42, 2304
    s_mul_i32 s42, s36, 1152
    s_add_u32 s68, s68, s42
    s_mul_i32 s42, s38, 144
    s_add_u32 s68, s68, s42

    s_lshl_b32 s70, s38, 11
    s_lshl_b32 s65, s6, 10
    s_add_u32 s65, s65, 2048
    s_add_u32 s57, s54, 16384
    s_add_u32 s42, s65, s70
    s_and_b32 s42, s42, 16383
    s_add_u32 s50, s42, s54
    s_add_u32 s65, s65, 2048
    s_cmp_eq_u32 s65, 16384
    s_cselect_b32 s65, 2048, s65
    s_add_u32 s42, s65, s70
    s_and_b32 s42, s42, 16383
    s_add_u32 s51, s42, s54
    s_add_u32 s65, s65, 2048
    s_cmp_eq_u32 s65, 16384
    s_cselect_b32 s65, 2048, s65
    s_add_u32 s42, s65, s70
    s_and_b32 s42, s42, 16383
    s_add_u32 s4, s42, s54
    s_add_u32 s65, s65, 2048
    s_cmp_eq_u32 s65, 16384
    s_cselect_b32 s65, 2048, s65
    s_add_u32 s42, s65, s70
    s_and_b32 s42, s42, 16383
    s_add_u32 s5, s42, s54
    s_add_u32 s65, s65, 2048
    s_cmp_eq_u32 s65, 16384
    s_cselect_b32 s65, 2048, s65
    s_add_u32 s42, s65, s70
    s_and_b32 s42, s42, 16383
    s_add_u32 s58, s42, s54
    s_add_u32 s65, s65, 2048
    s_cmp_eq_u32 s65, 16384
    s_cselect_b32 s65, 2048, s65
    s_add_u32 s42, s65, s70
    s_and_b32 s42, s42, 16383
    s_add_u32 s59, s42, s54
    s_add_u32 s65, s65, 2048
    s_cmp_eq_u32 s65, 16384
    s_cselect_b32 s65, 2048, s65
    s_add_u32 s42, s65, s70
    s_and_b32 s42, s42, 16383
    s_add_u32 s60, s42, s54
    s_add_u32 s65, s65, 2048
    s_cmp_eq_u32 s65, 16384
    s_cselect_b32 s65, 2048, s65
    s_waitcnt vmcnt(0)
    v_mov_b32 v6, 1
    s_mov_b64 exec, 1
    buffer_atomic_add v6, off, s[24:27], s71 sc0 sc1
    s_mov_b64 exec, -1
    s_barrier
    ds_read_b64_tr_b16 v[72:73], v29 offset:0
    ds_read_b64_tr_b16 v[74:75], v29 offset:1280
    ds_read_b64_tr_b16 v[76:77], v29 offset:32
    ds_read_b64_tr_b16 v[78:79], v29 offset:1312
    ds_read_b64_tr_b16 v[80:81], v29 offset:64
    ds_read_b64_tr_b16 v[82:83], v29 offset:1344
    ds_read_b64_tr_b16 v[84:85], v29 offset:96
    ds_read_b64_tr_b16 v[86:87], v29 offset:1376
    ds_read_b64_tr_b16 v[88:89], v29 offset:128
    s_waitcnt lgkmcnt(7)
    v_mfma_f32_16x16x32_bf16 v[32:35], v[72:75], v[112:115], 0
    ds_read_b64_tr_b16 v[90:91], v29 offset:1408
    v_mfma_f32_16x16x32_bf16 v[52:55], v[72:75], v[116:119], 0
    ds_read_b64_tr_b16 v[72:73], v29 offset:5120
    s_waitcnt lgkmcnt(7)
    v_mfma_f32_16x16x32_bf16 v[36:39], v[76:79], v[112:115], 0
    ds_read_b64_tr_b16 v[74:75], v29 offset:6400
    v_mfma_f32_16x16x32_bf16 v[56:59], v[76:79], v[116:119], 0
    ds_read_b64_tr_b16 v[76:77], v29 offset:5152
    s_waitcnt lgkmcnt(7)
    v_mfma_f32_16x16x32_bf16 v[40:43], v[80:83], v[112:115], 0
    ds_read_b64_tr_b16 v[78:79], v29 offset:6432
    v_mfma_f32_16x16x32_bf16 v[60:63], v[80:83], v[116:119], 0
    ds_read_b64_tr_b16 v[80:81], v29 offset:5184
    s_waitcnt lgkmcnt(7)
    v_mfma_f32_16x16x32_bf16 v[44:47], v[84:87], v[112:115], 0
    ds_read_b64_tr_b16 v[82:83], v29 offset:6464
    v_mfma_f32_16x16x32_bf16 v[64:67], v[84:87], v[116:119], 0
    ds_read_b64_tr_b16 v[84:85], v29 offset:5216
    s_waitcnt lgkmcnt(7)
    v_mfma_f32_16x16x32_bf16 v[48:51], v[88:91], v[112:115], 0
    ds_read_b64_tr_b16 v[86:87], v29 offset:6496
    v_mfma_f32_16x16x32_bf16 v[68:71], v[88:91], v[116:119], 0
    ds_read_b64_tr_b16 v[88:89], v29 offset:5248
    s_waitcnt lgkmcnt(7)
    v_mfma_f32_16x16x32_bf16 v[32:35], v[72:75], v[120:123], v[32:35]
    ds_read_b64_tr_b16 v[90:91], v29 offset:6528
    v_mfma_f32_16x16x32_bf16 v[52:55], v[72:75], v[124:127], v[52:55]
    ds_read_b64_tr_b16 v[72:73], v29 offset:10240
    s_waitcnt lgkmcnt(7)
    v_mfma_f32_16x16x32_bf16 v[36:39], v[76:79], v[120:123], v[36:39]
    ds_read_b64_tr_b16 v[74:75], v29 offset:11520
    v_mfma_f32_16x16x32_bf16 v[56:59], v[76:79], v[124:127], v[56:59]
    ds_read_b64_tr_b16 v[76:77], v29 offset:10272
    s_waitcnt lgkmcnt(7)
    v_mfma_f32_16x16x32_bf16 v[40:43], v[80:83], v[120:123], v[40:43]
    ds_read_b64_tr_b16 v[78:79], v29 offset:11552
    v_mfma_f32_16x16x32_bf16 v[60:63], v[80:83], v[124:127], v[60:63]
    ds_read_b64_tr_b16 v[80:81], v29 offset:10304
    s_waitcnt lgkmcnt(7)
    v_mfma_f32_16x16x32_bf16 v[44:47], v[84:87], v[120:123], v[44:47]
    ds_read_b64_tr_b16 v[82:83], v29 offset:11584
    v_mfma_f32_16x16x32_bf16 v[64:67], v[84:87], v[124:127], v[64:67]
    ds_read_b64_tr_b16 v[84:85], v29 offset:10336
    s_waitcnt lgkmcnt(7)
    v_mfma_f32_16x16x32_bf16 v[48:51], v[88:91], v[120:123], v[48:51]
    ds_read_b64_tr_b16 v[86:87], v29 offset:11616
    v_mfma_f32_16x16x32_bf16 v[68:71], v[88:91], v[124:127], v[68:71]
    s_mov_b32 s66, 0
    s_waitcnt vmcnt(0)
    v_readfirstlane_b32 s42, v6
    s_cmp_ge_u32 s42, 7
    s_cbranch_scc1 L_got_o
    s_mov_b64 exec, 1
    L_poll_o:
    s_sleep 4
    v_mov_b32 v6, 0
    buffer_atomic_add v6, off, s[24:27], s71 sc0 sc1
    s_add_u32 s66, s66, 1
    s_cmp_ge_u32 s66, 1000000
    s_cbranch_scc1 L_got_o
    s_waitcnt vmcnt(0)
    v_readfirstlane_b32 s42, v6
    s_cmp_ge_u32 s42, 8
    s_cbranch_scc0 L_poll_o
    L_got_o:
    s_mov_b64 exec, -1
    buffer_load_dwordx4 v[128:131], v10, s[24:27], s50 offen offset:0 sc1
    buffer_load_dwordx4 v[132:135], v11, s[24:27], s50 offen offset:0 sc1
    buffer_load_dwordx4 v[136:139], v10, s[24:27], s50 offen offset:1024 sc1
    buffer_load_dwordx4 v[140:143], v11, s[24:27], s50 offen offset:1024 sc1
    buffer_load_dwordx4 v[144:147], v10, s[24:27], s51 offen offset:0 sc1
    buffer_load_dwordx4 v[148:151], v11, s[24:27], s51 offen offset:0 sc1
    buffer_load_dwordx4 v[152:155], v10, s[24:27], s51 offen offset:1024 sc1
    buffer_load_dwordx4 v[156:159], v11, s[24:27], s51 offen offset:1024 sc1
    buffer_load_dwordx4 v[160:163], v10, s[24:27], s4 offen offset:0 sc1
    buffer_load_dwordx4 v[164:167], v11, s[24:27], s4 offen offset:0 sc1
    ds_read_b64_tr_b16 v[88:89], v29 offset:10368
    s_waitcnt lgkmcnt(7) vmcnt(8)
    v_mfma_f32_16x16x32_bf16 v[32:35], v[72:75], v[128:131], v[32:35]
    ds_read_b64_tr_b16 v[90:91], v29 offset:11648
    v_mfma_f32_16x16x32_bf16 v[52:55], v[72:75], v[132:135], v[52:55]
    ds_read_b64_tr_b16 v[72:73], v29 offset:15360
    s_waitcnt lgkmcnt(7)
    v_mfma_f32_16x16x32_bf16 v[36:39], v[76:79], v[128:131], v[36:39]
    ds_read_b64_tr_b16 v[74:75], v29 offset:16640
    buffer_load_dwordx4 v[168:171], v10, s[24:27], s4 offen offset:1024 sc1
    v_mfma_f32_16x16x32_bf16 v[56:59], v[76:79], v[132:135], v[56:59]
    ds_read_b64_tr_b16 v[76:77], v29 offset:15392
    s_waitcnt lgkmcnt(7)
    v_mfma_f32_16x16x32_bf16 v[40:43], v[80:83], v[128:131], v[40:43]
    ds_read_b64_tr_b16 v[78:79], v29 offset:16672
    v_mfma_f32_16x16x32_bf16 v[60:63], v[80:83], v[132:135], v[60:63]
    ds_read_b64_tr_b16 v[80:81], v29 offset:15424
    s_waitcnt lgkmcnt(7)
    v_mfma_f32_16x16x32_bf16 v[44:47], v[84:87], v[128:131], v[44:47]
    ds_read_b64_tr_b16 v[82:83], v29 offset:16704
    buffer_load_dwordx4 v[172:175], v11, s[24:27], s4 offen offset:1024 sc1
    v_mfma_f32_16x16x32_bf16 v[64:67], v[84:87], v[132:135], v[64:67]
    ds_read_b64_tr_b16 v[84:85], v29 offset:15456
    s_waitcnt lgkmcnt(7)
    v_mfma_f32_16x16x32_bf16 v[48:51], v[88:91], v[128:131], v[48:51]
    ds_read_b64_tr_b16 v[86:87], v29 offset:16736
    v_mfma_f32_16x16x32_bf16 v[68:71], v[88:91], v[132:135], v[68:71]
    ds_read_b64_tr_b16 v[88:89], v29 offset:15488
    s_waitcnt lgkmcnt(7) vmcnt(8)
    v_mfma_f32_16x16x32_bf16 v[32:35], v[72:75], v[136:139], v[32:35]
    ds_read_b64_tr_b16 v[90:91], v29 offset:16768
    v_mfma_f32_16x16x32_bf16 v[52:55], v[72:75], v[140:143], v[52:55]
    ds_read_b64_tr_b16 v[72:73], v29 offset:20480
    s_waitcnt lgkmcnt(7)
    v_mfma_f32_16x16x32_bf16 v[36:39], v[76:79], v[136:139], v[36:39]
    ds_read_b64_tr_b16 v[74:75], v29 offset:21760
    buffer_load_dwordx4 v[176:179], v10, s[24:27], s5 offen offset:0 sc1
    v_mfma_f32_16x16x32_bf16 v[56:59], v[76:79], v[140:143], v[56:59]
    ds_read_b64_tr_b16 v[76:77], v29 offset:20512
    s_waitcnt lgkmcnt(7)
    v_mfma_f32_16x16x32_bf16 v[40:43], v[80:83], v[136:139], v[40:43]
    ds_read_b64_tr_b16 v[78:79], v29 offset:21792
    v_mfma_f32_16x16x32_bf16 v[60:63], v[80:83], v[140:143], v[60:63]
    ds_read_b64_tr_b16 v[80:81], v29 offset:20544
    s_waitcnt lgkmcnt(7)
    v_mfma_f32_16x16x32_bf16 v[44:47], v[84:87], v[136:139], v[44:47]
    ds_read_b64_tr_b16 v[82:83], v29 offset:21824
    buffer_load_dwordx4 v[180:183], v11, s[24:27], s5 offen offset:0 sc1
    v_mfma_f32_16x16x32_bf16 v[64:67], v[84:87], v[140:143], v[64:67]
    ds_read_b64_tr_b16 v[84:85], v29 offset:20576
    s_waitcnt lgkmcnt(7)
    v_mfma_f32_16x16x32_bf16 v[48:51], v[88:91], v[136:139], v[48:51]
    ds_read_b64_tr_b16 v[86:87], v29 offset:21856
    v_mfma_f32_16x16x32_bf16 v[68:71], v[88:91], v[140:143], v[68:71]
    ds_read_b64_tr_b16 v[88:89], v29 offset:20608
    s_waitcnt lgkmcnt(7) vmcnt(8)
    v_mfma_f32_16x16x32_bf16 v[32:35], v[72:75], v[144:147], v[32:35]
    ds_read_b64_tr_b16 v[90:91], v29 offset:21888
    v_mfma_f32_16x16x32_bf16 v[52:55], v[72:75], v[148:151], v[52:55]
    ds_read_b64_tr_b16 v[72:73], v29 offset:25600
    s_waitcnt lgkmcnt(7)
    v_mfma_f32_16x16x32_bf16 v[36:39], v[76:79], v[144:147], v[36:39]
    ds_read_b64_tr_b16 v[74:75], v29 offset:26880
    buffer_load_dwordx4 v[184:187], v10, s[24:27], s5 offen offset:1024 sc1
    v_mfma_f32_16x16x32_bf16 v[56:59], v[76:79], v[148:151], v[56:59]
    ds_read_b64_tr_b16 v[76:77], v29 offset:25632
    s_waitcnt lgkmcnt(7)
    v_mfma_f32_16x16x32_bf16 v[40:43], v[80:83], v[144:147], v[40:43]
    ds_read_b64_tr_b16 v[78:79], v29 offset:26912
    v_mfma_f32_16x16x32_bf16 v[60:63], v[80:83], v[148:151], v[60:63]
    ds_read_b64_tr_b16 v[80:81], v29 offset:25664
    s_waitcnt lgkmcnt(7)
    v_mfma_f32_16x16x32_bf16 v[44:47], v[84:87], v[144:147], v[44:47]
    ds_read_b64_tr_b16 v[82:83], v29 offset:26944
    buffer_load_dwordx4 v[188:191], v11, s[24:27], s5 offen offset:1024 sc1
    v_mfma_f32_16x16x32_bf16 v[64:67], v[84:87], v[148:151], v[64:67]
    ds_read_b64_tr_b16 v[84:85], v29 offset:25696
    s_waitcnt lgkmcnt(7)
    v_mfma_f32_16x16x32_bf16 v[48:51], v[88:91], v[144:147], v[48:51]
    ds_read_b64_tr_b16 v[86:87], v29 offset:26976
    v_mfma_f32_16x16x32_bf16 v[68:71], v[88:91], v[148:151], v[68:71]
    ds_read_b64_tr_b16 v[88:89], v29 offset:25728
    s_waitcnt lgkmcnt(7) vmcnt(8)
    v_mfma_f32_16x16x32_bf16 v[32:35], v[72:75], v[152:155], v[32:35]
    ds_read_b64_tr_b16 v[90:91], v29 offset:27008
    v_mfma_f32_16x16x32_bf16 v[52:55], v[72:75], v[156:159], v[52:55]
    ds_read_b64_tr_b16 v[72:73], v29 offset:30720
    s_waitcnt lgkmcnt(7)
    v_mfma_f32_16x16x32_bf16 v[36:39], v[76:79], v[152:155], v[36:39]
    ds_read_b64_tr_b16 v[74:75], v29 offset:32000
    buffer_load_dwordx4 v[192:195], v10, s[24:27], s58 offen offset:0 sc1
    v_mfma_f32_16x16x32_bf16 v[56:59], v[76:79], v[156:159], v[56:59]
    ds_read_b64_tr_b16 v[76:77], v29 offset:30752
    s_waitcnt lgkmcnt(7)
    v_mfma_f32_16x16x32_bf16 v[40:43], v[80:83], v[152:155], v[40:43]
    ds_read_b64_tr_b16 v[78:79], v29 offset:32032
    v_mfma_f32_16x16x32_bf16 v[60:63], v[80:83], v[156:159], v[60:63]
    ds_read_b64_tr_b16 v[80:81], v29 offset:30784
    s_waitcnt lgkmcnt(7)
    v_mfma_f32_16x16x32_bf16 v[44:47], v[84:87], v[152:155], v[44:47]
    ds_read_b64_tr_b16 v[82:83], v29 offset:32064
    buffer_load_dwordx4 v[196:199], v11, s[24:27], s58 offen offset:0 sc1
    v_mfma_f32_16x16x32_bf16 v[64:67], v[84:87], v[156:159], v[64:67]
    ds_read_b64_tr_b16 v[84:85], v29 offset:30816
    s_waitcnt lgkmcnt(7)
    v_mfma_f32_16x16x32_bf16 v[48:51], v[88:91], v[152:155], v[48:51]
    ds_read_b64_tr_b16 v[86:87], v29 offset:32096
    v_mfma_f32_16x16x32_bf16 v[68:71], v[88:91], v[156:159], v[68:71]
    ds_read_b64_tr_b16 v[88:89], v29 offset:30848
    s_waitcnt lgkmcnt(7) vmcnt(8)
    v_mfma_f32_16x16x32_bf16 v[32:35], v[72:75], v[160:163], v[32:35]
    ds_read_b64_tr_b16 v[90:91], v29 offset:32128
    v_mfma_f32_16x16x32_bf16 v[52:55], v[72:75], v[164:167], v[52:55]
    ds_read_b64_tr_b16 v[72:73], v29 offset:35840
    s_waitcnt lgkmcnt(7)
    v_mfma_f32_16x16x32_bf16 v[36:39], v[76:79], v[160:163], v[36:39]
    ds_read_b64_tr_b16 v[74:75], v29 offset:37120
    buffer_load_dwordx4 v[200:203], v10, s[24:27], s58 offen offset:1024 sc1
    v_mfma_f32_16x16x32_bf16 v[56:59], v[76:79], v[164:167], v[56:59]
    ds_read_b64_tr_b16 v[76:77], v29 offset:35872
    s_waitcnt lgkmcnt(7)
    v_mfma_f32_16x16x32_bf16 v[40:43], v[80:83], v[160:163], v[40:43]
    ds_read_b64_tr_b16 v[78:79], v29 offset:37152
    v_mfma_f32_16x16x32_bf16 v[60:63], v[80:83], v[164:167], v[60:63]
    ds_read_b64_tr_b16 v[80:81], v29 offset:35904
    s_waitcnt lgkmcnt(7)
    v_mfma_f32_16x16x32_bf16 v[44:47], v[84:87], v[160:163], v[44:47]
    ds_read_b64_tr_b16 v[82:83], v29 offset:37184
    buffer_load_dwordx4 v[204:207], v11, s[24:27], s58 offen offset:1024 sc1
    v_mfma_f32_16x16x32_bf16 v[64:67], v[84:87], v[164:167], v[64:67]
    ds_read_b64_tr_b16 v[84:85], v29 offset:35936
    s_waitcnt lgkmcnt(7)
    v_mfma_f32_16x16x32_bf16 v[48:51], v[88:91], v[160:163], v[48:51]
    ds_read_b64_tr_b16 v[86:87], v29 offset:37216
    v_mfma_f32_16x16x32_bf16 v[68:71], v[88:91], v[164:167], v[68:71]
    ds_read_b64_tr_b16 v[88:89], v29 offset:35968
    s_waitcnt lgkmcnt(7) vmcnt(8)
    v_mfma_f32_16x16x32_bf16 v[32:35], v[72:75], v[168:171], v[32:35]
    ds_read_b64_tr_b16 v[90:91], v29 offset:37248
    v_mfma_f32_16x16x32_bf16 v[52:55], v[72:75], v[172:175], v[52:55]
    ds_read_b64_tr_b16 v[72:73], v30 offset:0
    s_waitcnt lgkmcnt(7)
    v_mfma_f32_16x16x32_bf16 v[36:39], v[76:79], v[168:171], v[36:39]
    ds_read_b64_tr_b16 v[74:75], v30 offset:1280
    buffer_load_dwordx4 v[208:211], v10, s[24:27], s59 offen offset:0 sc1
    v_mfma_f32_16x16x32_bf16 v[56:59], v[76:79], v[172:175], v[56:59]
    ds_read_b64_tr_b16 v[76:77], v30 offset:32
    s_waitcnt lgkmcnt(7)
    v_mfma_f32_16x16x32_bf16 v[40:43], v[80:83], v[168:171], v[40:43]
    ds_read_b64_tr_b16 v[78:79], v30 offset:1312
    v_mfma_f32_16x16x32_bf16 v[60:63], v[80:83], v[172:175], v[60:63]
    ds_read_b64_tr_b16 v[80:81], v30 offset:64
    s_waitcnt lgkmcnt(7)
    v_mfma_f32_16x16x32_bf16 v[44:47], v[84:87], v[168:171], v[44:47]
    ds_read_b64_tr_b16 v[82:83], v30 offset:1344
    buffer_load_dwordx4 v[212:215], v11, s[24:27], s59 offen offset:0 sc1
    v_mfma_f32_16x16x32_bf16 v[64:67], v[84:87], v[172:175], v[64:67]
    ds_read_b64_tr_b16 v[84:85], v30 offset:96
    s_waitcnt lgkmcnt(7)
    v_mfma_f32_16x16x32_bf16 v[48:51], v[88:91], v[168:171], v[48:51]
    ds_read_b64_tr_b16 v[86:87], v30 offset:1376
    v_mfma_f32_16x16x32_bf16 v[68:71], v[88:91], v[172:175], v[68:71]
    ds_read_b64_tr_b16 v[88:89], v30 offset:128
    s_waitcnt lgkmcnt(7) vmcnt(8)
    v_mfma_f32_16x16x32_bf16 v[32:35], v[72:75], v[176:179], v[32:35]
    ds_read_b64_tr_b16 v[90:91], v30 offset:1408
    v_mfma_f32_16x16x32_bf16 v[52:55], v[72:75], v[180:183], v[52:55]
    ds_read_b64_tr_b16 v[72:73], v30 offset:5120
    s_waitcnt lgkmcnt(7)
    v_mfma_f32_16x16x32_bf16 v[36:39], v[76:79], v[176:179], v[36:39]
    ds_read_b64_tr_b16 v[74:75], v30 offset:6400
    buffer_load_dwordx4 v[216:219], v10, s[24:27], s59 offen offset:1024 sc1
    v_mfma_f32_16x16x32_bf16 v[56:59], v[76:79], v[180:183], v[56:59]
    ds_read_b64_tr_b16 v[76:77], v30 offset:5152
    s_waitcnt lgkmcnt(7)
    v_mfma_f32_16x16x32_bf16 v[40:43], v[80:83], v[176:179], v[40:43]
    ds_read_b64_tr_b16 v[78:79], v30 offset:6432
    v_mfma_f32_16x16x32_bf16 v[60:63], v[80:83], v[180:183], v[60:63]
    ds_read_b64_tr_b16 v[80:81], v30 offset:5184
    s_waitcnt lgkmcnt(7)
    v_mfma_f32_16x16x32_bf16 v[44:47], v[84:87], v[176:179], v[44:47]
    ds_read_b64_tr_b16 v[82:83], v30 offset:6464
    buffer_load_dwordx4 v[220:223], v11, s[24:27], s59 offen offset:1024 sc1
    v_mfma_f32_16x16x32_bf16 v[64:67], v[84:87], v[180:183], v[64:67]
    ds_read_b64_tr_b16 v[84:85], v30 offset:5216
    s_waitcnt lgkmcnt(7)
    v_mfma_f32_16x16x32_bf16 v[48:51], v[88:91], v[176:179], v[48:51]
    ds_read_b64_tr_b16 v[86:87], v30 offset:6496
    v_mfma_f32_16x16x32_bf16 v[68:71], v[88:91], v[180:183], v[68:71]
    ds_read_b64_tr_b16 v[88:89], v30 offset:5248
    s_waitcnt lgkmcnt(7) vmcnt(8)
    v_mfma_f32_16x16x32_bf16 v[32:35], v[72:75], v[184:187], v[32:35]
    ds_read_b64_tr_b16 v[90:91], v30 offset:6528
    v_mfma_f32_16x16x32_bf16 v[52:55], v[72:75], v[188:191], v[52:55]
    ds_read_b64_tr_b16 v[72:73], v30 offset:10240
    s_waitcnt lgkmcnt(7)
    v_mfma_f32_16x16x32_bf16 v[36:39], v[76:79], v[184:187], v[36:39]
    ds_read_b64_tr_b16 v[74:75], v30 offset:11520
    buffer_load_dwordx4 v[224:227], v10, s[24:27], s60 offen offset:0 sc1
    v_mfma_f32_16x16x32_bf16 v[56:59], v[76:79], v[188:191], v[56:59]
    ds_read_b64_tr_b16 v[76:77], v30 offset:10272
    s_waitcnt lgkmcnt(7)
    v_mfma_f32_16x16x32_bf16 v[40:43], v[80:83], v[184:187], v[40:43]
    ds_read_b64_tr_b16 v[78:79], v30 offset:11552
    v_mfma_f32_16x16x32_bf16 v[60:63], v[80:83], v[188:191], v[60:63]
    ds_read_b64_tr_b16 v[80:81], v30 offset:10304
    s_waitcnt lgkmcnt(7)
    v_mfma_f32_16x16x32_bf16 v[44:47], v[84:87], v[184:187], v[44:47]
    ds_read_b64_tr_b16 v[82:83], v30 offset:11584
    buffer_load_dwordx4 v[228:231], v11, s[24:27], s60 offen offset:0 sc1
    v_mfma_f32_16x16x32_bf16 v[64:67], v[84:87], v[188:191], v[64:67]
    ds_read_b64_tr_b16 v[84:85], v30 offset:10336
    s_waitcnt lgkmcnt(7)
    v_mfma_f32_16x16x32_bf16 v[48:51], v[88:91], v[184:187], v[48:51]
    ds_read_b64_tr_b16 v[86:87], v30 offset:11616
    v_mfma_f32_16x16x32_bf16 v[68:71], v[88:91], v[188:191], v[68:71]
    ds_read_b64_tr_b16 v[88:89], v30 offset:10368
    s_waitcnt lgkmcnt(7) vmcnt(8)
    v_mfma_f32_16x16x32_bf16 v[32:35], v[72:75], v[192:195], v[32:35]
    ds_read_b64_tr_b16 v[90:91], v30 offset:11648
    v_mfma_f32_16x16x32_bf16 v[52:55], v[72:75], v[196:199], v[52:55]
    ds_read_b64_tr_b16 v[72:73], v30 offset:15360
    s_waitcnt lgkmcnt(7)
    v_mfma_f32_16x16x32_bf16 v[36:39], v[76:79], v[192:195], v[36:39]
    ds_read_b64_tr_b16 v[74:75], v30 offset:16640
    buffer_load_dwordx4 v[232:235], v10, s[24:27], s60 offen offset:1024 sc1
    v_mfma_f32_16x16x32_bf16 v[56:59], v[76:79], v[196:199], v[56:59]
    ds_read_b64_tr_b16 v[76:77], v30 offset:15392
    s_waitcnt lgkmcnt(7)
    v_mfma_f32_16x16x32_bf16 v[40:43], v[80:83], v[192:195], v[40:43]
    ds_read_b64_tr_b16 v[78:79], v30 offset:16672
    v_mfma_f32_16x16x32_bf16 v[60:63], v[80:83], v[196:199], v[60:63]
    ds_read_b64_tr_b16 v[80:81], v30 offset:15424
    s_waitcnt lgkmcnt(7)
    v_mfma_f32_16x16x32_bf16 v[44:47], v[84:87], v[192:195], v[44:47]
    ds_read_b64_tr_b16 v[82:83], v30 offset:16704
    buffer_load_dwordx4 v[236:239], v11, s[24:27], s60 offen offset:1024 sc1
    v_mfma_f32_16x16x32_bf16 v[64:67], v[84:87], v[196:199], v[64:67]
    ds_read_b64_tr_b16 v[84:85], v30 offset:15456
    s_waitcnt lgkmcnt(7)
    v_mfma_f32_16x16x32_bf16 v[48:51], v[88:91], v[192:195], v[48:51]
    ds_read_b64_tr_b16 v[86:87], v30 offset:16736
    v_mfma_f32_16x16x32_bf16 v[68:71], v[88:91], v[196:199], v[68:71]
    ds_read_b64_tr_b16 v[88:89], v30 offset:15488
    s_waitcnt lgkmcnt(7) vmcnt(8)
    v_mfma_f32_16x16x32_bf16 v[32:35], v[72:75], v[200:203], v[32:35]
    ds_read_b64_tr_b16 v[90:91], v30 offset:16768
    v_mfma_f32_16x16x32_bf16 v[52:55], v[72:75], v[204:207], v[52:55]
    ds_read_b64_tr_b16 v[72:73], v30 offset:20480
    s_waitcnt lgkmcnt(7)
    v_mfma_f32_16x16x32_bf16 v[36:39], v[76:79], v[200:203], v[36:39]
    ds_read_b64_tr_b16 v[74:75], v30 offset:21760
    buffer_load_dwordx4 v[240:243], v10, s[24:27], s57 offen offset:0 sc1
    v_mfma_f32_16x16x32_bf16 v[56:59], v[76:79], v[204:207], v[56:59]
    ds_read_b64_tr_b16 v[76:77], v30 offset:20512
    s_waitcnt lgkmcnt(7)
    v_mfma_f32_16x16x32_bf16 v[40:43], v[80:83], v[200:203], v[40:43]
    ds_read_b64_tr_b16 v[78:79], v30 offset:21792
    v_mfma_f32_16x16x32_bf16 v[60:63], v[80:83], v[204:207], v[60:63]
    ds_read_b64_tr_b16 v[80:81], v30 offset:20544
    s_waitcnt lgkmcnt(7)
    v_mfma_f32_16x16x32_bf16 v[44:47], v[84:87], v[200:203], v[44:47]
    ds_read_b64_tr_b16 v[82:83], v30 offset:21824
    buffer_load_dwordx4 v[244:247], v11, s[24:27], s57 offen offset:0 sc1
    v_mfma_f32_16x16x32_bf16 v[64:67], v[84:87], v[204:207], v[64:67]
    ds_read_b64_tr_b16 v[84:85], v30 offset:20576
    s_waitcnt lgkmcnt(7)
    v_mfma_f32_16x16x32_bf16 v[48:51], v[88:91], v[200:203], v[48:51]
    ds_read_b64_tr_b16 v[86:87], v30 offset:21856
    v_mfma_f32_16x16x32_bf16 v[68:71], v[88:91], v[204:207], v[68:71]
    ds_read_b64_tr_b16 v[88:89], v30 offset:20608
    s_waitcnt lgkmcnt(7) vmcnt(8)
    v_mfma_f32_16x16x32_bf16 v[32:35], v[72:75], v[208:211], v[32:35]
    ds_read_b64_tr_b16 v[90:91], v30 offset:21888
    v_mfma_f32_16x16x32_bf16 v[52:55], v[72:75], v[212:215], v[52:55]
    ds_read_b64_tr_b16 v[72:73], v30 offset:25600
    s_waitcnt lgkmcnt(7)
    v_mfma_f32_16x16x32_bf16 v[36:39], v[76:79], v[208:211], v[36:39]
    ds_read_b64_tr_b16 v[74:75], v30 offset:26880
    buffer_load_dwordx4 v[248:251], v10, s[24:27], s57 offen offset:1024 sc1
    v_mfma_f32_16x16x32_bf16 v[56:59], v[76:79], v[212:215], v[56:59]
    ds_read_b64_tr_b16 v[76:77], v30 offset:25632
    s_waitcnt lgkmcnt(7)
    v_mfma_f32_16x16x32_bf16 v[40:43], v[80:83], v[208:211], v[40:43]
    ds_read_b64_tr_b16 v[78:79], v30 offset:26912
    v_mfma_f32_16x16x32_bf16 v[60:63], v[80:83], v[212:215], v[60:63]
    ds_read_b64_tr_b16 v[80:81], v30 offset:25664
    s_waitcnt lgkmcnt(7)
    v_mfma_f32_16x16x32_bf16 v[44:47], v[84:87], v[208:211], v[44:47]
    ds_read_b64_tr_b16 v[82:83], v30 offset:26944
    buffer_load_dwordx4 v[252:255], v11, s[24:27], s57 offen offset:1024 sc1
    v_mfma_f32_16x16x32_bf16 v[64:67], v[84:87], v[212:215], v[64:67]
    ds_read_b64_tr_b16 v[84:85], v30 offset:25696
    s_waitcnt lgkmcnt(7)
    v_mfma_f32_16x16x32_bf16 v[48:51], v[88:91], v[208:211], v[48:51]
    ds_read_b64_tr_b16 v[86:87], v30 offset:26976
    v_mfma_f32_16x16x32_bf16 v[68:71], v[88:91], v[212:215], v[68:71]
    ds_read_b64_tr_b16 v[88:89], v30 offset:25728
    s_waitcnt lgkmcnt(7) vmcnt(8)
    v_mfma_f32_16x16x32_bf16 v[32:35], v[72:75], v[216:219], v[32:35]
    ds_read_b64_tr_b16 v[90:91], v30 offset:27008
    v_mfma_f32_16x16x32_bf16 v[52:55], v[72:75], v[220:223], v[52:55]
    ds_read_b64_tr_b16 v[72:73], v30 offset:30720
    s_waitcnt lgkmcnt(7)
    v_mfma_f32_16x16x32_bf16 v[36:39], v[76:79], v[216:219], v[36:39]
    ds_read_b64_tr_b16 v[74:75], v30 offset:32000
    v_mfma_f32_16x16x32_bf16 v[56:59], v[76:79], v[220:223], v[56:59]
    ds_read_b64_tr_b16 v[76:77], v30 offset:30752
    s_waitcnt lgkmcnt(7)
    v_mfma_f32_16x16x32_bf16 v[40:43], v[80:83], v[216:219], v[40:43]
    ds_read_b64_tr_b16 v[78:79], v30 offset:32032
    v_mfma_f32_16x16x32_bf16 v[60:63], v[80:83], v[220:223], v[60:63]
    ds_read_b64_tr_b16 v[80:81], v30 offset:30784
    s_waitcnt lgkmcnt(7)
    v_mfma_f32_16x16x32_bf16 v[44:47], v[84:87], v[216:219], v[44:47]
    ds_read_b64_tr_b16 v[82:83], v30 offset:32064
    v_mfma_f32_16x16x32_bf16 v[64:67], v[84:87], v[220:223], v[64:67]
    ds_read_b64_tr_b16 v[84:85], v30 offset:30816
    s_waitcnt lgkmcnt(7)
    v_mfma_f32_16x16x32_bf16 v[48:51], v[88:91], v[216:219], v[48:51]
    ds_read_b64_tr_b16 v[86:87], v30 offset:32096
    v_mfma_f32_16x16x32_bf16 v[68:71], v[88:91], v[220:223], v[68:71]
    ds_read_b64_tr_b16 v[88:89], v30 offset:30848
    s_waitcnt lgkmcnt(7) vmcnt(6)
    v_mfma_f32_16x16x32_bf16 v[32:35], v[72:75], v[224:227], v[32:35]
    ds_read_b64_tr_b16 v[90:91], v30 offset:32128
    v_mfma_f32_16x16x32_bf16 v[52:55], v[72:75], v[228:231], v[52:55]
    ds_read_b64_tr_b16 v[72:73], v30 offset:35840
    s_waitcnt lgkmcnt(7)
    v_mfma_f32_16x16x32_bf16 v[36:39], v[76:79], v[224:227], v[36:39]
    ds_read_b64_tr_b16 v[74:75], v30 offset:37120
    v_mfma_f32_16x16x32_bf16 v[56:59], v[76:79], v[228:231], v[56:59]
    ds_read_b64_tr_b16 v[76:77], v30 offset:35872
    s_waitcnt lgkmcnt(7)
    v_mfma_f32_16x16x32_bf16 v[40:43], v[80:83], v[224:227], v[40:43]
    ds_read_b64_tr_b16 v[78:79], v30 offset:37152
    v_mfma_f32_16x16x32_bf16 v[60:63], v[80:83], v[228:231], v[60:63]
    ds_read_b64_tr_b16 v[80:81], v30 offset:35904
    s_waitcnt lgkmcnt(7)
    v_mfma_f32_16x16x32_bf16 v[44:47], v[84:87], v[224:227], v[44:47]
    ds_read_b64_tr_b16 v[82:83], v30 offset:37184
    v_mfma_f32_16x16x32_bf16 v[64:67], v[84:87], v[228:231], v[64:67]
    ds_read_b64_tr_b16 v[84:85], v30 offset:35936
    s_waitcnt lgkmcnt(7)
    v_mfma_f32_16x16x32_bf16 v[48:51], v[88:91], v[224:227], v[48:51]
    ds_read_b64_tr_b16 v[86:87], v30 offset:37216
    v_mfma_f32_16x16x32_bf16 v[68:71], v[88:91], v[228:231], v[68:71]
    ds_read_b64_tr_b16 v[88:89], v30 offset:35968
    s_waitcnt lgkmcnt(7) vmcnt(4)
    v_mfma_f32_16x16x32_bf16 v[32:35], v[72:75], v[232:235], v[32:35]
    ds_read_b64_tr_b16 v[90:91], v30 offset:37248
    v_mfma_f32_16x16x32_bf16 v[52:55], v[72:75], v[236:239], v[52:55]
    ds_read_b64_tr_b16 v[72:73], v29 offset:40960
    s_waitcnt lgkmcnt(7)
    v_mfma_f32_16x16x32_bf16 v[36:39], v[76:79], v[232:235], v[36:39]
    ds_read_b64_tr_b16 v[74:75], v29 offset:42240
    v_mfma_f32_16x16x32_bf16 v[56:59], v[76:79], v[236:239], v[56:59]
    ds_read_b64_tr_b16 v[76:77], v29 offset:40992
    s_waitcnt lgkmcnt(7)
    v_mfma_f32_16x16x32_bf16 v[40:43], v[80:83], v[232:235], v[40:43]
    ds_read_b64_tr_b16 v[78:79], v29 offset:42272
    v_mfma_f32_16x16x32_bf16 v[60:63], v[80:83], v[236:239], v[60:63]
    ds_read_b64_tr_b16 v[80:81], v29 offset:41024
    s_waitcnt lgkmcnt(7)
    v_mfma_f32_16x16x32_bf16 v[44:47], v[84:87], v[232:235], v[44:47]
    ds_read_b64_tr_b16 v[82:83], v29 offset:42304
    v_mfma_f32_16x16x32_bf16 v[64:67], v[84:87], v[236:239], v[64:67]
    ds_read_b64_tr_b16 v[84:85], v29 offset:41056
    s_waitcnt lgkmcnt(7)
    v_mfma_f32_16x16x32_bf16 v[48:51], v[88:91], v[232:235], v[48:51]
    ds_read_b64_tr_b16 v[86:87], v29 offset:42336
    v_mfma_f32_16x16x32_bf16 v[68:71], v[88:91], v[236:239], v[68:71]
    ds_read_b64_tr_b16 v[88:89], v29 offset:41088
    s_waitcnt lgkmcnt(7) vmcnt(2)
    v_mfma_f32_16x16x32_bf16 v[32:35], v[72:75], v[240:243], v[32:35]
    ds_read_b64_tr_b16 v[90:91], v29 offset:42368
    v_mfma_f32_16x16x32_bf16 v[52:55], v[72:75], v[244:247], v[52:55]
    ds_read_b64_tr_b16 v[72:73], v30 offset:40960
    s_waitcnt lgkmcnt(7)
    v_mfma_f32_16x16x32_bf16 v[36:39], v[76:79], v[240:243], v[36:39]
    ds_read_b64_tr_b16 v[74:75], v30 offset:42240
    v_mfma_f32_16x16x32_bf16 v[56:59], v[76:79], v[244:247], v[56:59]
    ds_read_b64_tr_b16 v[76:77], v30 offset:40992
    s_waitcnt lgkmcnt(7)
    v_mfma_f32_16x16x32_bf16 v[40:43], v[80:83], v[240:243], v[40:43]
    ds_read_b64_tr_b16 v[78:79], v30 offset:42272
    v_mfma_f32_16x16x32_bf16 v[60:63], v[80:83], v[244:247], v[60:63]
    ds_read_b64_tr_b16 v[80:81], v30 offset:41024
    s_waitcnt lgkmcnt(7)
    v_mfma_f32_16x16x32_bf16 v[44:47], v[84:87], v[240:243], v[44:47]
    ds_read_b64_tr_b16 v[82:83], v30 offset:42304
    v_mfma_f32_16x16x32_bf16 v[64:67], v[84:87], v[244:247], v[64:67]
    ds_read_b64_tr_b16 v[84:85], v30 offset:41056
    s_waitcnt lgkmcnt(7)
    v_mfma_f32_16x16x32_bf16 v[48:51], v[88:91], v[240:243], v[48:51]
    ds_read_b64_tr_b16 v[86:87], v30 offset:42336
    v_mfma_f32_16x16x32_bf16 v[68:71], v[88:91], v[244:247], v[68:71]
    ds_read_b64_tr_b16 v[88:89], v30 offset:41088
    s_waitcnt lgkmcnt(7) vmcnt(0)
    v_mfma_f32_16x16x32_bf16 v[32:35], v[72:75], v[248:251], v[32:35]
    ds_read_b64_tr_b16 v[90:91], v30 offset:42368
    v_mfma_f32_16x16x32_bf16 v[52:55], v[72:75], v[252:255], v[52:55]
    s_waitcnt lgkmcnt(6)
    v_mfma_f32_16x16x32_bf16 v[36:39], v[76:79], v[248:251], v[36:39]
    v_mfma_f32_16x16x32_bf16 v[56:59], v[76:79], v[252:255], v[56:59]
    s_waitcnt lgkmcnt(4)
    v_mfma_f32_16x16x32_bf16 v[40:43], v[80:83], v[248:251], v[40:43]
    v_mfma_f32_16x16x32_bf16 v[60:63], v[80:83], v[252:255], v[60:63]
    s_waitcnt lgkmcnt(2)
    v_mfma_f32_16x16x32_bf16 v[44:47], v[84:87], v[248:251], v[44:47]
    v_cvt_pk_bf16_f32 v92, v32, v33
    v_cvt_pk_bf16_f32 v93, v34, v35
    ds_write_b64 v12, v[92:93] offset:0
    v_mfma_f32_16x16x32_bf16 v[64:67], v[84:87], v[252:255], v[64:67]
    s_waitcnt lgkmcnt(0)
    v_mfma_f32_16x16x32_bf16 v[48:51], v[88:91], v[248:251], v[48:51]
    v_cvt_pk_bf16_f32 v94, v36, v37
    v_cvt_pk_bf16_f32 v95, v38, v39
    ds_write_b64 v12, v[94:95] offset:32
    v_mfma_f32_16x16x32_bf16 v[68:71], v[88:91], v[252:255], v[68:71]
    v_cvt_pk_bf16_f32 v102, v52, v53
    v_cvt_pk_bf16_f32 v103, v54, v55
    ds_write_b64 v12, v[102:103] offset:2816
    v_cvt_pk_bf16_f32 v104, v56, v57
    v_cvt_pk_bf16_f32 v105, v58, v59
    ds_write_b64 v12, v[104:105] offset:2848
    v_cvt_pk_bf16_f32 v96, v40, v41
    v_cvt_pk_bf16_f32 v97, v42, v43
    ds_write_b64 v12, v[96:97] offset:64
    v_cvt_pk_bf16_f32 v106, v60, v61
    v_cvt_pk_bf16_f32 v107, v62, v63
    ds_write_b64 v12, v[106:107] offset:2880
    v_cvt_pk_bf16_f32 v98, v44, v45
    v_cvt_pk_bf16_f32 v99, v46, v47
    ds_write_b64 v12, v[98:99] offset:96
    v_cvt_pk_bf16_f32 v108, v64, v65
    v_cvt_pk_bf16_f32 v109, v66, v67
    ds_write_b64 v12, v[108:109] offset:2912
    v_cvt_pk_bf16_f32 v100, v48, v49
    v_cvt_pk_bf16_f32 v101, v50, v51
    ds_write_b64 v12, v[100:101] offset:128
    v_cvt_pk_bf16_f32 v110, v68, v69
    v_cvt_pk_bf16_f32 v111, v70, v71
    ds_write_b64 v12, v[110:111] offset:2944
    s_waitcnt lgkmcnt(0)
    ds_read_b128 v[112:115], v13
    ds_read_b128 v[116:119], v14
    ds_read_b128 v[120:123], v15
    ds_read_b128 v[124:127], v16
    ds_read_b128 v[128:131], v17
    s_waitcnt lgkmcnt(4)
    buffer_store_dwordx4 v[112:115], v18, s[20:23], s68 offen
    s_waitcnt lgkmcnt(3)
    buffer_store_dwordx4 v[116:119], v19, s[20:23], s68 offen
    s_waitcnt lgkmcnt(2)
    buffer_store_dwordx4 v[120:123], v20, s[20:23], s68 offen
    s_waitcnt lgkmcnt(1)
    buffer_store_dwordx4 v[124:127], v21, s[20:23], s68 offen
    s_waitcnt lgkmcnt(0)
    buffer_store_dwordx4 v[128:131], v22, s[20:23], s68 offen
L_end:
    s_endpgm
L_id_a0:
    v_mov_b32 v1, 1
    s_mov_b64 vcc, 0
    s_waitcnt vmcnt(0)
    s_mov_b64 exec, 1
    buffer_atomic_add v1, off, s[28:31], 0 sc1
    s_mov_b64 exec, -1
    s_branch L_ir_a0
L_id_a1:
    v_mov_b32 v1, 1
    s_mov_b64 vcc, 0
    s_waitcnt vmcnt(0)
    s_mov_b64 exec, 1
    buffer_atomic_add v1, off, s[28:31], 0 sc1
    s_mov_b64 exec, -1
    s_branch L_ir_a1
L_id_a2:
    v_mov_b32 v1, 1
    s_mov_b64 vcc, 0
    s_waitcnt vmcnt(0)
    s_mov_b64 exec, 1
    buffer_atomic_add v1, off, s[28:31], 0 sc1
    s_mov_b64 exec, -1
    s_branch L_ir_a2
L_id_a3:
    v_mov_b32 v1, 1
    s_mov_b64 vcc, 0
    s_waitcnt vmcnt(0)
    s_mov_b64 exec, 1
    buffer_atomic_add v1, off, s[28:31], 0 sc1
    s_mov_b64 exec, -1
    s_branch L_ir_a3
L_id_b:
    v_mov_b32 v1, 1
    s_mov_b64 vcc, 0
    s_waitcnt vmcnt(0)
    s_mov_b64 exec, 1
    buffer_atomic_add v1, off, s[28:31], 0 sc1
    s_mov_b64 exec, -1
    s_branch L_ir_b
L_last:
.section .rodata,"a"
.p2align 6
.amdhsa_kernel concat_heads__sliding_local_dilated__linear_attn_block__prompt_kernel
  .amdhsa_next_free_vgpr 256
  .amdhsa_next_free_sgpr 102
  .amdhsa_accum_offset 256
  .amdhsa_group_segment_fixed_size 0
  .amdhsa_kernarg_size 72
  .amdhsa_user_sgpr_count 2
  .amdhsa_user_sgpr_kernarg_segment_ptr 1
  .amdhsa_system_sgpr_workgroup_id_x 1
.end_amdhsa_kernel
```
